```python
import torch

def _softmax(x, axis=-1):
    return torch.softmax(x, dim=axis)
def _gelu(x):
    return torch.nn.functional.gelu(x, approximate="tanh")
def _silu(x):
    return torch.nn.functional.silu(x)
def _sigmoid(x):
    return torch.sigmoid(x)
def _layernorm(x, axis=-1, eps=1e-5):
    m = x.mean(dim=axis, keepdim=True)
    v = x.var(dim=axis, keepdim=True, unbiased=False)
    return (x - m) / torch.sqrt(v + eps)
def _scatter_add(tgt, idx, src, axis=0):
    return tgt.clone().index_add_(axis, idx, src)
def _segment_sum(src, seg, n):
    out = torch.zeros((n,) + src.shape[1:], dtype=src.dtype)
    return out.index_add_(0, seg, src)
def _pad(x, pw):
    flat = tuple(v for pair in reversed(pw) for v in pair)
    return torch.nn.functional.pad(x, flat)

kernel_name = 'sequential_preLN__sliding_local_dilated__dense_activation_squared_relu__prompt'

def setup_inputs():

    _w = (lambda a: (lambda t: t.to(torch.bfloat16) if t.is_floating_point() else t)(torch.as_tensor(a)))
    def _A_setup():
        B, S, D = 1, 2048, 576
        return {
            "x": _w((lambda *s: torch.randn(*s, dtype=torch.bfloat16) * 0.05)(B, S, D)),
            "wqkv": _w((lambda *s: torch.randn(*s, dtype=torch.bfloat16) * 0.05)(D, 3 * D)),
            "wo": _w((lambda *s: torch.randn(*s, dtype=torch.bfloat16) * 0.05)(D, D)),
        }
    _A_in = _A_setup()

    def _B_setup():
        B, S, D, F = 1, 2048, 576, 4608
        return {
            "x": _w((lambda *s: torch.randn(*s, dtype=torch.bfloat16) * 0.05)(B, S, D)),
            "w1": _w((lambda *s: torch.randn(*s, dtype=torch.bfloat16) * 0.05)(D, F)),
            "b1": _w((lambda *s: torch.randn(*s, dtype=torch.bfloat16) * 0.2)(F)),
            "w2": _w((lambda *s: torch.randn(*s, dtype=torch.bfloat16) * 0.05)(F, D)),
            "b2": _w((lambda *s: torch.randn(*s, dtype=torch.bfloat16) * 1.6)(D)),
        }
    _B_in = _B_setup()

    return {
        "A_x": _A_in["x"],
        "A_wqkv": _A_in["wqkv"],
        "A_wo": _A_in["wo"],
        "B_x": _B_in["x"],
        "B_w1": _B_in["w1"],
        "B_b1": _B_in["b1"],
        "B_w2": _B_in["w2"],
        "B_b2": _B_in["b2"],
    }

def reference(A_x, A_wqkv, A_wo, B_x, B_w1, B_b1, B_w2, B_b2):
    def _A_ref(x, wqkv, wo):
        B, S, D = x.shape
        H = 32; Dh = D // H
        W, dil = 8, 2
        qkv = (lambda x, *d: x.permute(*d))((x @ wqkv).reshape(B, S, 3, H, Dh), 2, 0, 3, 1, 4)
        q, k, v = qkv[0], qkv[1], qkv[2]
        scale = Dh ** -0.5
        pos = torch.arange(S)
        off = torch.arange(W) * dil
        idx = pos[:, None] - off[None, :]
        mask = idx >= 0
        idx_c = torch.where(mask, idx, 0).reshape(-1)
        kg = k[:, :, idx_c, :].reshape(B, H, S, W, Dh)
        vg = v[:, :, idx_c, :].reshape(B, H, S, W, Dh)
        logits = torch.einsum("bhsd,bhswd->bhsw", q, kg) * scale
        logits = torch.where(mask[None, None, :, :], logits, -1e9)
        attn = _softmax(logits, axis=-1)
        o = torch.einsum("bhsw,bhswd->bhsd", attn, vg)
        return (lambda x, *d: x.permute(*d))(o, 0, 2, 1, 3).reshape(B, S, D) @ wo

    def _B_ref(x, w1, b1, w2, b2):
        h = torch.einsum("bsd,df->bsf", x, w1) + b1
        zero = torch.zeros_like(h)
        r = torch.where(h > zero, h, zero)
        h = r * r
        out = torch.einsum("bsf,fd->bsd", h, w2) + b2
        return out

    x = A_x
    h = x + _A_ref(_layernorm(x, axis=-1), A_wqkv, A_wo)
    h2 = h + _B_ref(_layernorm(h, axis=-1), B_w1, B_b1, B_w2, B_b2)
    return h2
```

```asm
; @launch grid=(256,1,1) block=(256,1,1) lds=163840
.amdgcn_target "amdgcn-amd-amdhsa--gfx950"
.text
.globl sequential_preLN__sliding_local_dilated__dense_activation_squared_relu__prompt_kernel
.p2align 8
.type sequential_preLN__sliding_local_dilated__dense_activation_squared_relu__prompt_kernel,@function
sequential_preLN__sliding_local_dilated__dense_activation_squared_relu__prompt_kernel:
  s_cmp_ge_u32 s2, 256
  s_cbranch_scc1 L_end
  s_load_dwordx16 s[4:19], s[0:1], 0
  s_load_dwordx2 s[20:21], s[0:1], 64
  s_load_dwordx2 s[24:25], s[0:1], 80
  s_getpc_b64 s[92:93]
L_pc0:
  s_and_b32 s93, s93, 0xffff
  s_mov_b32 s94, L_code_end - L_pc0
  s_mov_b32 s95, 0x00020000
  s_lshr_b32 s84, s2, 3
  s_lshl_b32 s84, s84, 2
  v_lshrrev_b32 v62, 6, v0
  v_and_b32 v63, 63, v0
  v_lshlrev_b32 v63, 7, v63
  v_add3_u32 v63, v63, v62, s84
  v_lshlrev_b32 v63, 7, v63
  buffer_load_dword v63, v63, s[92:95], 0 offen
  v_lshrrev_b32 v5, 6, v0
  v_and_b32 v1, 63, v0
  v_readfirstlane_b32 s68, v5
  v_and_b32 v2, 15, v0
  v_lshrrev_b32 v3, 4, v1
  v_lshlrev_b32 v4, 4, v1
  s_and_b32 s74, s2, 7
  s_lshr_b32 s75, s2, 3
  s_lshl_b32 s69, s74, 2
  s_lshr_b32 s76, s75, 3
  s_add_u32 s69, s69, s76
  s_and_b32 s70, s75, 7
  s_lshr_b32 s71, s74, 2
  s_lshl_b32 s71, s71, 4
  s_lshr_b32 s76, s75, 1
  s_add_u32 s71, s71, s76
  s_and_b32 s72, s74, 3
  s_lshl_b32 s72, s72, 1
  s_and_b32 s76, s75, 1
  s_add_u32 s72, s72, s76
  s_lshr_b32 s22, s74, 1
  s_lshl_b32 s22, s22, 3
  s_lshr_b32 s76, s75, 2
  s_add_u32 s22, s22, s76
  s_and_b32 s23, s74, 1
  s_lshl_b32 s23, s23, 2
  s_and_b32 s76, s75, 3
  s_add_u32 s23, s23, s76
  s_lshl_b32 s77, s68, 5
  s_add_u32 s77, s77, s22
  s_mul_i32 s78, s23, 144
  s_cmp_lt_u32 s77, 72
  s_cbranch_scc0 L_r0_wo
  v_mul_u32_u24 v6, 2428, v1
  v_lshrrev_b32 v6, 16, v6
  v_mul_u32_u24 v7, 27, v6
  v_sub_u32 v7, v1, v7
  v_mul_u32_u24 v8, 7282, v7
  v_lshrrev_b32 v8, 16, v8
  v_mul_u32_u24 v9, 9, v8
  v_sub_u32 v9, v7, v9
  v_mul_u32_u24 v6, 3456, v6
  v_mul_u32_u24 v8, 1152, v8
  v_lshlrev_b32 v9, 4, v9
  v_add3_u32 v5, v6, v8, v9
  v_cmp_gt_u32 vcc, 54, v1
  s_mul_i32 s80, s77, 27648
  s_add_u32 s80, s80, s78
  s_add_u32 s81, s80, 5888
  s_add_u32 s82, s81, 5888
  s_add_u32 s83, s82, 5888
  s_branch L_r0_join
L_r0_wo:
  v_mul_u32_u24 v6, 7282, v1
  v_lshrrev_b32 v6, 16, v6
  v_mul_u32_u24 v7, 9, v6
  v_sub_u32 v7, v1, v7
  v_mul_u32_u24 v6, 1152, v6
  v_lshl_add_u32 v5, v7, 4, v6
  v_cmp_gt_u32 vcc, 36, v1
  s_sub_u32 s79, s77, 72
  s_lshr_b32 s84, s79, 2
  s_mul_i32 s84, s84, 36
  s_bfe_u32 s85, s79, 0x10001
  s_mul_i32 s85, s85, 20
  s_add_u32 s84, s84, s85
  s_and_b32 s85, s79, 1
  s_lshl_b32 s85, s85, 3
  s_add_u32 s84, s84, s85
  s_add_u32 s85, s84, 4
  s_sub_u32 s86, s79, 64
  s_mul_i32 s86, s86, 72
  s_add_u32 s86, s86, 16
  s_add_u32 s87, s86, 36
  s_cmp_lt_u32 s79, 64
  s_cselect_b32 s84, s84, s86
  s_cselect_b32 s85, s85, s87
  s_mul_i32 s84, s84, 1152
  s_mul_i32 s85, s85, 1152
  s_add_u32 s84, s84, s78
  s_add_u32 s85, s85, s78
  s_sub_u32 s80, s84, 0
  s_sub_u32 s81, s85, 1024
  s_add_u32 s79, s79, 36
  s_lshr_b32 s84, s79, 2
  s_mul_i32 s84, s84, 36
  s_bfe_u32 s85, s79, 0x10001
  s_mul_i32 s85, s85, 20
  s_add_u32 s84, s84, s85
  s_and_b32 s85, s79, 1
  s_lshl_b32 s85, s85, 3
  s_add_u32 s84, s84, s85
  s_add_u32 s85, s84, 4
  s_sub_u32 s86, s79, 64
  s_mul_i32 s86, s86, 72
  s_add_u32 s86, s86, 16
  s_add_u32 s87, s86, 36
  s_cmp_lt_u32 s79, 64
  s_cselect_b32 s84, s84, s86
  s_cselect_b32 s85, s85, s87
  s_mul_i32 s84, s84, 1152
  s_mul_i32 s85, s85, 1152
  s_add_u32 s84, s84, s78
  s_add_u32 s85, s85, s78
  s_sub_u32 s82, s84, 2048
  s_sub_u32 s83, s85, 3072
  s_cmp_lt_u32 s77, 108
  s_cselect_b32 s80, s80, 1073741824
  s_cselect_b32 s81, s81, 1073741824
  s_cselect_b32 s82, s82, 1073741824
  s_cselect_b32 s83, s83, 1073741824
L_r0_join:
  s_nop 1
  v_mov_b32 v6, 1073741824
  v_cndmask_b32 v5, v6, v5, vcc
  s_lshl_b32 s84, s68, 12
  s_add_u32 s84, s84, 49152
  s_mov_b32 m0, s84
  s_waitcnt lgkmcnt(0)
  s_cmp_lt_u32 s77, 72
  s_cselect_b32 s88, s6, s8
  s_cselect_b32 s89, s7, s9
  s_mov_b32 s85, 663552
  s_cselect_b32 s90, 1990656, s85
  s_and_b32 s89, s89, 0xffff
  s_mov_b32 s91, 0x00020000
  buffer_load_dwordx4 v5, s[88:91], s80 offen offset:0 nt lds
  buffer_load_dwordx4 v5, s[88:91], s81 offen offset:1024 nt lds
  buffer_load_dwordx4 v5, s[88:91], s82 offen offset:2048 nt lds
  buffer_load_dwordx4 v5, s[88:91], s83 offen offset:3072 nt lds
  s_mov_b32 s28, s4
  s_and_b32 s29, s5, 0xffff
  s_mov_b32 s30, 2359296
  s_mov_b32 s31, 0x00020000
  s_load_dword s73, s[24:25], 0
  s_lshl_b32 s84, s22, 6
  s_and_b32 s85, s68, 1
  s_lshl_b32 s85, s85, 5
  s_add_u32 s85, s85, s84
  s_lshr_b32 s86, s68, 1
  s_add_u32 s85, s85, s86
  s_mul_i32 s85, s85, 1152
  v_lshrrev_b32 v8, 3, v1
  v_and_b32 v9, 7, v1
  v_mul_u32_u24 v6, 2304, v8
  v_lshl_add_u32 v6, v9, 4, v6
  v_add_u32 v6, s85, v6
  v_add_u32 v7, 18432, v6
  s_and_b32 s86, s69, 3
  s_mul_i32 s86, s86, 9
  s_add_u32 s86, s86, 2
  s_lshr_b32 s86, s86, 2
  s_add_u32 s86, s86, s70
  s_sub_u32 s87, s86, 9
  s_cmp_ge_u32 s86, 9
  s_cselect_b32 s0, s87, s86
  s_lshl_b32 s86, s69, 1
  s_add_u32 s86, s86, s70
  s_and_b32 s3, s86, 7
  s_and_b32 s86, s72, 1
  s_mul_i32 s86, s86, 9
  s_and_b32 s87, s71, 15
  s_add_u32 s86, s86, s87
  s_sub_u32 s87, s86, 18
  s_cmp_ge_u32 s86, 18
  s_cselect_b32 s1, s87, s86
  s_and_b32 s86, s23, 3
  s_mul_i32 s86, s86, 9
  s_add_u32 s86, s86, 2
  s_lshr_b32 s86, s86, 2
  s_and_b32 s87, s22, 7
  s_add_u32 s86, s86, s87
  s_sub_u32 s87, s86, 9
  s_cmp_ge_u32 s86, 9
  s_cselect_b32 s0, s87, s86
  s_lshl_b32 s88, s0, 7
  s_add_u32 s89, s88, 128
  s_cmp_eq_u32 s89, 1152
  s_cselect_b32 s89, 0, s89
  s_add_u32 s90, s89, 128
  s_cmp_eq_u32 s90, 1152
  s_cselect_b32 s90, 0, s90
  s_add_u32 s91, s90, 128
  s_cmp_eq_u32 s91, 1152
  s_cselect_b32 s91, 0, s91
  s_add_u32 s92, s91, 128
  s_cmp_eq_u32 s92, 1152
  s_cselect_b32 s92, 0, s92
  s_add_u32 s93, s92, 128
  s_cmp_eq_u32 s93, 1152
  s_cselect_b32 s93, 0, s93
  s_add_u32 s94, s93, 128
  s_cmp_eq_u32 s94, 1152
  s_cselect_b32 s94, 0, s94
  s_add_u32 s95, s94, 128
  s_cmp_eq_u32 s95, 1152
  s_cselect_b32 s95, 0, s95
  s_add_u32 s96, s95, 128
  s_cmp_eq_u32 s96, 1152
  s_cselect_b32 s96, 0, s96
  buffer_load_dwordx4 v[160:163], v6, s[28:31], s88 offen
  buffer_load_dwordx4 v[164:167], v7, s[28:31], s88 offen
  buffer_load_dwordx4 v[168:171], v6, s[28:31], s89 offen
  buffer_load_dwordx4 v[172:175], v7, s[28:31], s89 offen
  buffer_load_dwordx4 v[176:179], v6, s[28:31], s90 offen
  buffer_load_dwordx4 v[180:183], v7, s[28:31], s90 offen
  buffer_load_dwordx4 v[184:187], v6, s[28:31], s91 offen
  buffer_load_dwordx4 v[188:191], v7, s[28:31], s91 offen
  s_mov_b32 s60, s24
  s_and_b32 s61, s25, 0xffff
  s_mov_b32 s62, 67108864
  s_mov_b32 s63, 0x00020000
  s_lshl_b32 s85, s68, 2
  v_add_u32 v10, s85, v3
  v_and_b32 v11, 7, v10
  v_lshrrev_b32 v12, 3, v10
  v_lshl_add_u32 v11, v11, 1, v12
  v_add_u32 v11, s84, v11
  v_subrev_u32 v11, 16, v11
  v_mul_u32_u24 v11, 1152, v11
  s_cmp_eq_u32 s22, 0
  s_cselect_b32 s85, 1073741824, 0
  s_cselect_b32 s86, 0, -1
  v_and_b32 v11, s86, v11
  v_or_b32 v11, s85, v11
  v_mov_b32 v13, 1073741824
  s_lshl_b32 s85, s0, 3
  v_add_u32 v12, s85, v2
  v_add_u32 v84, 0, v12
  v_subrev_u32 v89, 72, v84
  v_min_u32 v84, v84, v89
  v_lshl_add_u32 v84, v84, 4, v11
  v_add_u32 v85, 16, v12
  v_subrev_u32 v89, 72, v85
  v_min_u32 v85, v85, v89
  v_lshl_add_u32 v85, v85, 4, v11
  v_add_u32 v86, 32, v12
  v_subrev_u32 v89, 72, v86
  v_min_u32 v86, v86, v89
  v_lshl_add_u32 v86, v86, 4, v11
  v_add_u32 v87, 48, v12
  v_subrev_u32 v89, 72, v87
  v_min_u32 v87, v87, v89
  v_lshl_add_u32 v87, v87, 4, v11
  v_add_u32 v88, 64, v12
  v_subrev_u32 v89, 72, v88
  v_min_u32 v88, v88, v89
  v_lshl_add_u32 v88, v88, 4, v11
  v_cmp_gt_u32 vcc, 8, v2
  s_nop 1
  v_cndmask_b32 v88, v13, v88, vcc
  v_bfe_u32 v14, v1, 2, 2
  v_and_b32 v15, 3, v1
  s_lshl_b32 s84, s68, 12
  s_add_u32 s84, s84, 49152
  s_cmp_lt_u32 s77, 72
  s_cbranch_scc0 L_r1_wo
  v_lshrrev_b32 v16, 1, v14
  v_lshlrev_b32 v16, 10, v16
  v_and_b32 v17, 1, v14
  v_mul_u32_u24 v17, 432, v17
  v_add3_u32 v16, v16, v17, s84
  v_mul_u32_u24 v17, 36, v3
  v_and_b32 v18, 1, v3
  v_lshl_add_u32 v17, v18, 2, v17
  v_lshl_add_u32 v17, v15, 3, v17
  v_add_u32 v32, v16, v17
  v_add_u32 v34, 144, v32
  v_add_u32 v36, 288, v32
  v_min_u32 v17, 2, v15
  v_mul_u32_u24 v17, 144, v17
  v_mul_u32_u24 v18, 72, v18
  v_add3_u32 v38, v16, v17, v18
  v_add_u32 v38, 32, v38
  s_mov_b32 s85, 2048
  s_lshr_b32 s86, s77, 2
  s_mul_i32 s87, s23, 72
  s_add_u32 s86, s86, s87
  s_mul_i32 s86, s86, 3584
  s_add_u32 s86, s86, 1048576
  s_and_b32 s87, s77, 3
  v_mul_u32_u24 v16, 64512, v3
  v_lshl_add_u32 v16, v2, 4, v16
  s_lshl_b32 s79, s87, 8
  s_add_u32 s79, s79, s86
  v_add_u32 v40, s79, v16
  v_add_u32 v41, 1024, v40
  v_add_u32 v42, 2048, v40
  v_lshrrev_b32 v16, 1, v15
  v_lshl_add_u32 v16, v3, 1, v16
  v_mul_u32_u24 v16, 64512, v16
  v_and_b32 v17, 1, v15
  v_lshl_add_u32 v17, v14, 1, v17
  v_lshl_add_u32 v16, v17, 4, v16
  s_lshl_b32 s79, s87, 7
  s_add_u32 s79, s79, s86
  s_add_u32 s79, s79, 3072
  v_add_u32 v16, s79, v16
  v_cmp_gt_u32 vcc, 32, v1
  s_nop 1
  v_cndmask_b32 v43, v13, v16, vcc
  s_branch L_r1_join
L_r1_wo:
  v_mul_u32_u24 v16, 144, v14
  v_add_u32 v16, s84, v16
  v_lshrrev_b32 v17, 1, v3
  v_lshlrev_b32 v17, 6, v17
  v_and_b32 v18, 1, v3
  v_lshl_add_u32 v17, v18, 3, v17
  v_lshl_add_u32 v17, v15, 4, v17
  v_add_u32 v32, v16, v17
  v_and_b32 v17, 1, v15
  v_lshl_add_u32 v34, v17, 3, v16
  v_add_u32 v34, 128, v34
  v_add_u32 v36, 2048, v32
  v_add_u32 v38, 2048, v34
  s_mov_b32 s85, 1024
  v_lshlrev_b32 v16, 10, v3
  v_lshl_add_u32 v16, v2, 4, v16
  v_cmp_gt_u32 vcc, 8, v1
  s_nop 1
  v_cndmask_b32 v17, v13, v4, vcc
  s_sub_u32 s79, s77, 72
  s_lshr_b32 s86, s79, 2
  s_mul_i32 s87, s23, 18
  s_add_u32 s86, s86, s87
  s_mul_i32 s86, s86, 4608
  s_add_u32 s86, s86, 3145728
  s_cmp_lt_u32 s77, 108
  s_cselect_b32 s86, s86, 1073741824
  s_and_b32 s87, s79, 3
  s_lshl_b32 s76, s87, 8
  s_add_u32 s76, s76, s86
  v_add_u32 v40, s76, v16
  s_lshl_b32 s76, s87, 7
  s_add_u32 s76, s76, s86
  s_add_u32 s76, s76, 4096
  v_add_u32 v41, s76, v17
  s_add_u32 s79, s79, 36
  s_lshr_b32 s86, s79, 2
  s_mul_i32 s87, s23, 18
  s_add_u32 s86, s86, s87
  s_mul_i32 s86, s86, 4608
  s_add_u32 s86, s86, 3145728
  s_cmp_lt_u32 s77, 108
  s_cselect_b32 s86, s86, 1073741824
  s_and_b32 s87, s79, 3
  s_lshl_b32 s76, s87, 8
  s_add_u32 s76, s76, s86
  v_add_u32 v42, s76, v16
  s_lshl_b32 s76, s87, 7
  s_add_u32 s76, s76, s86
  s_add_u32 s76, s76, 4096
  v_add_u32 v43, s76, v17
L_r1_join:
  s_nop 1
  v_add_u32 v33, s85, v32
  v_add_u32 v35, s85, v34
  v_add_u32 v37, s85, v36
  v_add_u32 v39, s85, v38
  s_mov_b32 s40, s12
  s_and_b32 s41, s13, 0xffff
  s_mov_b32 s42, 5308416
  s_mov_b32 s43, 0x00020000
  s_mov_b32 s44, s16
  s_and_b32 s45, s17, 0xffff
  s_mov_b32 s46, 5308416
  s_mov_b32 s47, 0x00020000
  s_mov_b32 s48, s14
  s_and_b32 s49, s15, 0xffff
  s_mov_b32 s50, 9216
  s_mov_b32 s51, 0x00020000
  s_mov_b32 s52, s18
  s_and_b32 s53, s19, 0xffff
  s_mov_b32 s54, 1152
  s_mov_b32 s55, 0x00020000
  s_mov_b32 s56, s20
  s_and_b32 s57, s21, 0xffff
  s_mov_b32 s58, 2359296
  s_mov_b32 s59, 0x00020000
  s_mov_b32 s99, 0x3f803f80
  s_mov_b32 s98, 0xffff0000
  s_add_u32 s84, s77, 0
  s_mul_i32 s85, s84, 7282
  s_lshr_b32 s85, s85, 16
  s_mul_i32 s86, s85, 9
  s_sub_u32 s86, s84, s86
  s_lshl_b32 s76, s86, 7
  s_mul_i32 s87, s85, 294912
  s_add_u32 s87, s87, s76
  s_mul_i32 s75, s23, 1152
  s_add_u32 s32, s87, s75
  s_mul_i32 s87, s85, 36864
  s_add_u32 s87, s87, s76
  s_mul_i32 s75, s23, 663552
  s_add_u32 s24, s87, s75
  s_lshr_b32 s79, s85, 2
  s_lshl_b32 s79, s79, 1
  s_and_b32 s75, s85, 1
  s_add_u32 s79, s79, s75
  s_add_u32 s75, s79, 10
  s_bitcmp1_b32 s85, 1
  s_cselect_b32 s79, s75, s79
  s_lshr_b32 s87, s86, 1
  s_mul_i32 s87, s87, 162
  s_and_b32 s76, s86, 1
  s_lshl_b32 s76, s76, 2
  s_add_u32 s87, s87, s76
  s_cmp_eq_u32 s86, 8
  s_cselect_b32 s87, 8, s87
  s_cselect_b32 s34, 162, 1
  s_lshl_b32 s34, s34, 10
  s_mul_i32 s76, s23, 648
  s_add_u32 s87, s87, s76
  s_mul_i32 s75, s85, 9
  s_add_u32 s75, s75, s87
  s_lshl_b32 s75, s75, 10
  s_add_u32 s33, s75, 10485760
  s_mul_i32 s75, s79, 9
  s_add_u32 s75, s75, s87
  s_lshl_b32 s75, s75, 10
  s_add_u32 s25, s75, 16777216
  s_add_u32 s84, s77, 128
  s_mul_i32 s85, s84, 7282
  s_lshr_b32 s85, s85, 16
  s_mul_i32 s86, s85, 9
  s_sub_u32 s86, s84, s86
  s_lshl_b32 s76, s86, 7
  s_mul_i32 s87, s85, 294912
  s_add_u32 s87, s87, s76
  s_mul_i32 s75, s23, 1152
  s_add_u32 s35, s87, s75
  s_mul_i32 s87, s85, 36864
  s_add_u32 s87, s87, s76
  s_mul_i32 s75, s23, 663552
  s_add_u32 s26, s87, s75
  s_lshr_b32 s79, s85, 2
  s_lshl_b32 s79, s79, 1
  s_and_b32 s75, s85, 1
  s_add_u32 s79, s79, s75
  s_add_u32 s75, s79, 10
  s_bitcmp1_b32 s85, 1
  s_cselect_b32 s79, s75, s79
  s_lshr_b32 s87, s86, 1
  s_mul_i32 s87, s87, 162
  s_and_b32 s76, s86, 1
  s_lshl_b32 s76, s76, 2
  s_add_u32 s87, s87, s76
  s_cmp_eq_u32 s86, 8
  s_cselect_b32 s87, 8, s87
  s_cselect_b32 s37, 162, 1
  s_lshl_b32 s37, s37, 10
  s_mul_i32 s76, s23, 648
  s_add_u32 s87, s87, s76
  s_mul_i32 s75, s85, 9
  s_add_u32 s75, s75, s87
  s_lshl_b32 s75, s75, 10
  s_add_u32 s36, s75, 10485760
  s_mul_i32 s75, s79, 9
  s_add_u32 s75, s75, s87
  s_lshl_b32 s75, s75, 10
  s_add_u32 s27, s75, 16777216
  s_cmp_lt_u32 s84, 162
  s_cselect_b32 s35, s35, 1073741824
  s_cselect_b32 s36, s36, 1073741824
  s_cselect_b32 s26, s26, 1073741824
  s_cselect_b32 s27, s27, 1073741824
  v_mul_u32_u24 v92, 9216, v8
  v_lshl_add_u32 v92, v9, 4, v92
  v_mul_u32_u24 v93, 1152, v8
  v_lshl_add_u32 v93, v9, 4, v93
  v_lshl_add_u32 v94, v3, 3, v14
  v_lshlrev_b32 v94, 7, v94
  v_lshl_add_u32 v94, v15, 4, v94
  s_lshl_b32 s84, s68, 13
  v_add_u32 v94, s84, v94
  v_mov_b32 v66, 0xf149f2ca
  v_lshlrev_b32 v64, 2, v3
  v_sub_u32 v64, v64, v2
  s_cmp_eq_u32 s22, 0
  s_cselect_b32 s84, 100, 0
  v_cmp_gt_u32 s[80:81], 2, v3
  v_add_u32 v65, 7, v64
  v_cmp_gt_u32 vcc, 8, v65
  v_add_u32 v65, 0, v64
  v_subrev_u32 v67, s84, v65
  v_cndmask_b32 v96, v66, 0, vcc
  v_cmp_lt_i32 vcc, 8, v65
  v_cmp_lt_i32 s[82:83], 8, v67
  v_cmp_lt_i32 s[86:87], 0, v67
  v_cndmask_b32 v100, v66, 0, vcc
  s_and_b64 s[86:87], s[86:87], s[80:81]
  v_cndmask_b32 v108, v66, 0, s[82:83]
  v_cndmask_b32 v104, v66, 0, s[86:87]
  v_add_u32 v65, 8, v64
  v_cmp_gt_u32 vcc, 8, v65
  v_add_u32 v65, 1, v64
  v_subrev_u32 v67, s84, v65
  v_cndmask_b32 v97, v66, 0, vcc
  v_cmp_lt_i32 vcc, 8, v65
  v_cmp_lt_i32 s[82:83], 8, v67
  v_cmp_lt_i32 s[86:87], 0, v67
  v_cndmask_b32 v101, v66, 0, vcc
  s_and_b64 s[86:87], s[86:87], s[80:81]
  v_cndmask_b32 v109, v66, 0, s[82:83]
  v_cndmask_b32 v105, v66, 0, s[86:87]
  v_add_u32 v65, 9, v64
  v_cmp_gt_u32 vcc, 8, v65
  v_add_u32 v65, 2, v64
  v_subrev_u32 v67, s84, v65
  v_cndmask_b32 v98, v66, 0, vcc
  v_cmp_lt_i32 vcc, 8, v65
  v_cmp_lt_i32 s[82:83], 8, v67
  v_cmp_lt_i32 s[86:87], 0, v67
  v_cndmask_b32 v102, v66, 0, vcc
  s_and_b64 s[86:87], s[86:87], s[80:81]
  v_cndmask_b32 v110, v66, 0, s[82:83]
  v_cndmask_b32 v106, v66, 0, s[86:87]
  v_add_u32 v65, 10, v64
  v_cmp_gt_u32 vcc, 8, v65
  v_add_u32 v65, 3, v64
  v_subrev_u32 v67, s84, v65
  v_cndmask_b32 v99, v66, 0, vcc
  v_cmp_lt_i32 vcc, 8, v65
  v_cmp_lt_i32 s[82:83], 8, v67
  v_cmp_lt_i32 s[86:87], 0, v67
  v_cndmask_b32 v103, v66, 0, vcc
  s_and_b64 s[86:87], s[86:87], s[80:81]
  v_cndmask_b32 v111, v66, 0, s[82:83]
  v_cndmask_b32 v107, v66, 0, s[86:87]
  s_waitcnt vmcnt(8)
  ds_read_b64_tr_b16 v[16:17], v32
  ds_read_b64_tr_b16 v[18:19], v33
  ds_read_b64_tr_b16 v[20:21], v34
  ds_read_b64_tr_b16 v[22:23], v35
  ds_read_b64_tr_b16 v[24:25], v36
  ds_read_b64_tr_b16 v[26:27], v37
  ds_read_b64_tr_b16 v[28:29], v38
  ds_read_b64_tr_b16 v[30:31], v39
  s_waitcnt lgkmcnt(0)
  buffer_store_dwordx4 v[16:19], v40, s[60:63], 0 offen sc1
  buffer_store_dwordx4 v[20:23], v41, s[60:63], 0 offen sc1
  buffer_store_dwordx4 v[24:27], v42, s[60:63], 0 offen sc1
  buffer_store_dwordx4 v[28:31], v43, s[60:63], 0 offen sc1
  s_add_u32 s73, s73, 0x9E3779B9
  s_lshl_b32 s84, s23, 12
  s_add_u32 s84, s84, 65536
  s_lshl_b32 s85, s22, 2
  s_add_u32 s85, s85, s84
  v_mov_b32 v44, s85
  v_cmp_gt_u32 vcc, 1, v0
  s_nop 1
  v_cndmask_b32 v44, v13, v44, vcc
  v_and_b32 v45, 31, v1
  v_lshl_add_u32 v45, v45, 2, s84
  s_lshl_b32 s84, s70, 12
  s_add_u32 s84, s84, 65408
  v_lshl_add_u32 v5, v1, 2, s84
  v_cmp_gt_u32 vcc, 32, v1
  s_nop 1
  v_cndmask_b32 v45, v5, v45, vcc
  buffer_load_dwordx4 v[192:195], v6, s[28:31], s92 offen
  buffer_load_dwordx4 v[196:199], v7, s[28:31], s92 offen
  buffer_load_dwordx4 v[200:203], v6, s[28:31], s93 offen
  buffer_load_dwordx4 v[204:207], v7, s[28:31], s93 offen
  buffer_load_dwordx4 v[208:211], v6, s[28:31], s94 offen
  buffer_load_dwordx4 v[212:215], v7, s[28:31], s94 offen
  buffer_load_dwordx4 v[216:219], v6, s[28:31], s95 offen
  buffer_load_dwordx4 v[220:223], v7, s[28:31], s95 offen
  buffer_load_dwordx4 v[224:227], v6, s[28:31], s96 offen
  buffer_load_dwordx4 v[228:231], v7, s[28:31], s96 offen
  buffer_load_dwordx4 v[232:235], v84, s[28:31], 0 offen
  buffer_load_dwordx4 v[236:239], v85, s[28:31], 0 offen
  buffer_load_dwordx4 v[240:243], v86, s[28:31], 0 offen
  s_waitcnt vmcnt(24)
  v_dot2_f32_bf16 v144, v160, s99, 0
  v_dot2_f32_bf16 v145, v160, v160, 0
  v_dot2_f32_bf16 v146, v161, s99, 0
  v_dot2_f32_bf16 v147, v161, v161, 0
  v_dot2_f32_bf16 v144, v162, s99, v144
  v_dot2_f32_bf16 v145, v162, v162, v145
  v_dot2_f32_bf16 v146, v163, s99, v146
  v_dot2_f32_bf16 v147, v163, v163, v147
  buffer_load_dwordx4 v[244:247], v87, s[28:31], 0 offen
  s_waitcnt vmcnt(24)
  v_dot2_f32_bf16 v148, v164, s99, 0
  v_dot2_f32_bf16 v149, v164, v164, 0
  v_dot2_f32_bf16 v150, v165, s99, 0
  v_dot2_f32_bf16 v151, v165, v165, 0
  v_dot2_f32_bf16 v148, v166, s99, v148
  v_dot2_f32_bf16 v149, v166, v166, v149
  v_dot2_f32_bf16 v150, v167, s99, v150
  v_dot2_f32_bf16 v151, v167, v167, v151
  buffer_load_dwordx4 v[248:251], v88, s[28:31], 0 offen
  s_waitcnt vmcnt(24)
  v_dot2_f32_bf16 v144, v168, s99, v144
  v_dot2_f32_bf16 v145, v168, v168, v145
  v_dot2_f32_bf16 v146, v169, s99, v146
  v_dot2_f32_bf16 v147, v169, v169, v147
  v_dot2_f32_bf16 v144, v170, s99, v144
  v_dot2_f32_bf16 v145, v170, v170, v145
  v_dot2_f32_bf16 v146, v171, s99, v146
  v_dot2_f32_bf16 v147, v171, v171, v147
  s_waitcnt vmcnt(23)
  v_dot2_f32_bf16 v148, v172, s99, v148
  v_dot2_f32_bf16 v149, v172, v172, v149
  v_dot2_f32_bf16 v150, v173, s99, v150
  v_dot2_f32_bf16 v151, v173, v173, v151
  v_dot2_f32_bf16 v148, v174, s99, v148
  v_dot2_f32_bf16 v149, v174, v174, v149
  v_dot2_f32_bf16 v150, v175, s99, v150
  v_dot2_f32_bf16 v151, v175, v175, v151
  s_waitcnt vmcnt(22)
  v_dot2_f32_bf16 v144, v176, s99, v144
  v_dot2_f32_bf16 v145, v176, v176, v145
  v_dot2_f32_bf16 v146, v177, s99, v146
  v_dot2_f32_bf16 v147, v177, v177, v147
  v_dot2_f32_bf16 v144, v178, s99, v144
  v_dot2_f32_bf16 v145, v178, v178, v145
  v_dot2_f32_bf16 v146, v179, s99, v146
  v_dot2_f32_bf16 v147, v179, v179, v147
  s_waitcnt vmcnt(21)
  v_dot2_f32_bf16 v148, v180, s99, v148
  v_dot2_f32_bf16 v149, v180, v180, v149
  v_dot2_f32_bf16 v150, v181, s99, v150
  v_dot2_f32_bf16 v151, v181, v181, v151
  v_dot2_f32_bf16 v148, v182, s99, v148
  v_dot2_f32_bf16 v149, v182, v182, v149
  v_dot2_f32_bf16 v150, v183, s99, v150
  v_dot2_f32_bf16 v151, v183, v183, v151
  s_waitcnt vmcnt(20)
  v_dot2_f32_bf16 v144, v184, s99, v144
  v_dot2_f32_bf16 v145, v184, v184, v145
  v_dot2_f32_bf16 v146, v185, s99, v146
  v_dot2_f32_bf16 v147, v185, v185, v147
  v_dot2_f32_bf16 v144, v186, s99, v144
  v_dot2_f32_bf16 v145, v186, v186, v145
  v_dot2_f32_bf16 v146, v187, s99, v146
  v_dot2_f32_bf16 v147, v187, v187, v147
  s_waitcnt vmcnt(19)
  v_dot2_f32_bf16 v148, v188, s99, v148
  v_dot2_f32_bf16 v149, v188, v188, v149
  v_dot2_f32_bf16 v150, v189, s99, v150
  v_dot2_f32_bf16 v151, v189, v189, v151
  v_dot2_f32_bf16 v148, v190, s99, v148
  v_dot2_f32_bf16 v149, v190, v190, v149
  v_dot2_f32_bf16 v150, v191, s99, v150
  v_dot2_f32_bf16 v151, v191, v191, v151
  s_waitcnt vmcnt(15)
  s_barrier
  v_mov_b32 v5, s73
  buffer_store_dword v5, v44, s[60:63], 0 offen sc1
  s_lshl_b32 s84, s68, 13
  s_add_u32 s84, s84, 0
  s_mov_b32 m0, s84
  s_nop 0
  buffer_load_dwordx4 v92, s[40:43], s32 offen offset:0 nt lds
  s_add_u32 s32, s32, 72704
  buffer_load_dwordx4 v92, s[40:43], s32 offen offset:1024 nt lds
  s_add_u32 s32, s32, 72704
  buffer_load_dwordx4 v92, s[40:43], s32 offen offset:2048 nt lds
  s_add_u32 s32, s32, 72704
  buffer_load_dwordx4 v92, s[40:43], s32 offen offset:3072 nt lds
  s_lshl_b32 s84, s68, 13
  s_add_u32 s84, s84, 4096
  s_mov_b32 m0, s84
  s_nop 0
  buffer_load_dwordx4 v92, s[40:43], s35 offen offset:0 nt lds
  s_add_u32 s35, s35, 72704
  buffer_load_dwordx4 v92, s[40:43], s35 offen offset:1024 nt lds
  s_add_u32 s35, s35, 72704
  buffer_load_dwordx4 v92, s[40:43], s35 offen offset:2048 nt lds
  s_add_u32 s35, s35, 72704
  buffer_load_dwordx4 v92, s[40:43], s35 offen offset:3072 nt lds
  s_mul_i32 s84, s72, 1152
  v_lshlrev_b32 v5, 7, v2
  buffer_load_dword v252, v5, s[48:51], s84 offen
  buffer_load_dword v253, v5, s[52:55], 0 offen
  s_waitcnt vmcnt(25)
  v_dot2_f32_bf16 v144, v192, s99, v144
  v_dot2_f32_bf16 v145, v192, v192, v145
  v_dot2_f32_bf16 v146, v193, s99, v146
  v_dot2_f32_bf16 v147, v193, v193, v147
  v_dot2_f32_bf16 v144, v194, s99, v144
  v_dot2_f32_bf16 v145, v194, v194, v145
  v_dot2_f32_bf16 v146, v195, s99, v146
  v_dot2_f32_bf16 v147, v195, v195, v147
  s_waitcnt vmcnt(24)
  v_dot2_f32_bf16 v148, v196, s99, v148
  v_dot2_f32_bf16 v149, v196, v196, v149
  v_dot2_f32_bf16 v150, v197, s99, v150
  v_dot2_f32_bf16 v151, v197, v197, v151
  v_dot2_f32_bf16 v148, v198, s99, v148
  v_dot2_f32_bf16 v149, v198, v198, v149
  v_dot2_f32_bf16 v150, v199, s99, v150
  v_dot2_f32_bf16 v151, v199, v199, v151
  s_waitcnt vmcnt(23)
  v_dot2_f32_bf16 v144, v200, s99, v144
  v_dot2_f32_bf16 v145, v200, v200, v145
  v_dot2_f32_bf16 v146, v201, s99, v146
  v_dot2_f32_bf16 v147, v201, v201, v147
  v_dot2_f32_bf16 v144, v202, s99, v144
  v_dot2_f32_bf16 v145, v202, v202, v145
  v_dot2_f32_bf16 v146, v203, s99, v146
  v_dot2_f32_bf16 v147, v203, v203, v147
  s_waitcnt vmcnt(22)
  v_dot2_f32_bf16 v148, v204, s99, v148
  v_dot2_f32_bf16 v149, v204, v204, v149
  v_dot2_f32_bf16 v150, v205, s99, v150
  v_dot2_f32_bf16 v151, v205, v205, v151
  v_dot2_f32_bf16 v148, v206, s99, v148
  v_dot2_f32_bf16 v149, v206, v206, v149
  v_dot2_f32_bf16 v150, v207, s99, v150
  v_dot2_f32_bf16 v151, v207, v207, v151
  s_waitcnt vmcnt(21)
  v_dot2_f32_bf16 v144, v208, s99, v144
  v_dot2_f32_bf16 v145, v208, v208, v145
  v_dot2_f32_bf16 v146, v209, s99, v146
  v_dot2_f32_bf16 v147, v209, v209, v147
  v_dot2_f32_bf16 v144, v210, s99, v144
  v_dot2_f32_bf16 v145, v210, v210, v145
  v_dot2_f32_bf16 v146, v211, s99, v146
  v_dot2_f32_bf16 v147, v211, v211, v147
  s_waitcnt vmcnt(20)
  v_dot2_f32_bf16 v148, v212, s99, v148
  v_dot2_f32_bf16 v149, v212, v212, v149
  v_dot2_f32_bf16 v150, v213, s99, v150
  v_dot2_f32_bf16 v151, v213, v213, v151
  v_dot2_f32_bf16 v148, v214, s99, v148
  v_dot2_f32_bf16 v149, v214, v214, v149
  v_dot2_f32_bf16 v150, v215, s99, v150
  v_dot2_f32_bf16 v151, v215, v215, v151
  s_waitcnt vmcnt(19)
  v_dot2_f32_bf16 v144, v216, s99, v144
  v_dot2_f32_bf16 v145, v216, v216, v145
  v_dot2_f32_bf16 v146, v217, s99, v146
  v_dot2_f32_bf16 v147, v217, v217, v147
  v_dot2_f32_bf16 v144, v218, s99, v144
  v_dot2_f32_bf16 v145, v218, v218, v145
  v_dot2_f32_bf16 v146, v219, s99, v146
  v_dot2_f32_bf16 v147, v219, v219, v147
  s_waitcnt vmcnt(18)
  v_dot2_f32_bf16 v148, v220, s99, v148
  v_dot2_f32_bf16 v149, v220, v220, v149
  v_dot2_f32_bf16 v150, v221, s99, v150
  v_dot2_f32_bf16 v151, v221, v221, v151
  v_dot2_f32_bf16 v148, v222, s99, v148
  v_dot2_f32_bf16 v149, v222, v222, v149
  v_dot2_f32_bf16 v150, v223, s99, v150
  v_dot2_f32_bf16 v151, v223, v223, v151
  s_waitcnt vmcnt(17)
  v_dot2_f32_bf16 v144, v224, s99, v144
  v_dot2_f32_bf16 v145, v224, v224, v145
  v_dot2_f32_bf16 v146, v225, s99, v146
  v_dot2_f32_bf16 v147, v225, v225, v147
  v_dot2_f32_bf16 v144, v226, s99, v144
  v_dot2_f32_bf16 v145, v226, v226, v145
  v_dot2_f32_bf16 v146, v227, s99, v146
  v_dot2_f32_bf16 v147, v227, v227, v147
  s_waitcnt vmcnt(16)
  v_dot2_f32_bf16 v148, v228, s99, v148
  v_dot2_f32_bf16 v149, v228, v228, v149
  v_dot2_f32_bf16 v150, v229, s99, v150
  v_dot2_f32_bf16 v151, v229, v229, v151
  v_dot2_f32_bf16 v148, v230, s99, v148
  v_dot2_f32_bf16 v149, v230, v230, v149
  v_dot2_f32_bf16 v150, v231, s99, v150
  v_dot2_f32_bf16 v151, v231, v231, v151
  s_waitcnt vmcnt(15)
  v_dot2_f32_bf16 v152, v232, s99, 0
  v_dot2_f32_bf16 v153, v232, v232, 0
  v_dot2_f32_bf16 v154, v233, s99, 0
  v_dot2_f32_bf16 v155, v233, v233, 0
  v_dot2_f32_bf16 v152, v234, s99, v152
  v_dot2_f32_bf16 v153, v234, v234, v153
  v_dot2_f32_bf16 v154, v235, s99, v154
  v_dot2_f32_bf16 v155, v235, v235, v155
  s_waitcnt vmcnt(14)
  v_dot2_f32_bf16 v152, v236, s99, v152
  v_dot2_f32_bf16 v153, v236, v236, v153
  v_dot2_f32_bf16 v154, v237, s99, v154
  v_dot2_f32_bf16 v155, v237, v237, v155
  v_dot2_f32_bf16 v152, v238, s99, v152
  v_dot2_f32_bf16 v153, v238, v238, v153
  v_dot2_f32_bf16 v154, v239, s99, v154
  v_dot2_f32_bf16 v155, v239, v239, v155
  s_waitcnt vmcnt(13)
  v_dot2_f32_bf16 v152, v240, s99, v152
  v_dot2_f32_bf16 v153, v240, v240, v153
  v_dot2_f32_bf16 v154, v241, s99, v154
  v_dot2_f32_bf16 v155, v241, v241, v155
  v_dot2_f32_bf16 v152, v242, s99, v152
  v_dot2_f32_bf16 v153, v242, v242, v153
  v_dot2_f32_bf16 v154, v243, s99, v154
  v_dot2_f32_bf16 v155, v243, v243, v155
  s_waitcnt vmcnt(12)
  v_dot2_f32_bf16 v152, v244, s99, v152
  v_dot2_f32_bf16 v153, v244, v244, v153
  v_dot2_f32_bf16 v154, v245, s99, v154
  v_dot2_f32_bf16 v155, v245, v245, v155
  v_dot2_f32_bf16 v152, v246, s99, v152
  v_dot2_f32_bf16 v153, v246, v246, v153
  v_dot2_f32_bf16 v154, v247, s99, v154
  v_dot2_f32_bf16 v155, v247, v247, v155
  s_waitcnt vmcnt(11)
  v_dot2_f32_bf16 v152, v248, s99, v152
  v_dot2_f32_bf16 v153, v248, v248, v153
  v_dot2_f32_bf16 v154, v249, s99, v154
  v_dot2_f32_bf16 v155, v249, v249, v155
  v_dot2_f32_bf16 v152, v250, s99, v152
  v_dot2_f32_bf16 v153, v250, v250, v153
  v_dot2_f32_bf16 v154, v251, s99, v154
  v_dot2_f32_bf16 v155, v251, v251, v155
  v_add_f32 v144, v144, v146
  v_add_f32 v145, v145, v147
  v_add_f32 v148, v148, v150
  v_add_f32 v149, v149, v151
  v_add_f32 v152, v152, v154
  v_add_f32 v153, v153, v155
  v_add_f32_dpp v144, v144, v144 quad_perm:[1,0,3,2] row_mask:0xf bank_mask:0xf
  v_add_f32_dpp v145, v145, v145 quad_perm:[1,0,3,2] row_mask:0xf bank_mask:0xf
  v_add_f32_dpp v148, v148, v148 quad_perm:[1,0,3,2] row_mask:0xf bank_mask:0xf
  v_add_f32_dpp v149, v149, v149 quad_perm:[1,0,3,2] row_mask:0xf bank_mask:0xf
  v_add_f32_dpp v152, v152, v152 quad_perm:[1,0,3,2] row_mask:0xf bank_mask:0xf
  v_add_f32_dpp v153, v153, v153 quad_perm:[1,0,3,2] row_mask:0xf bank_mask:0xf
  v_add_f32_dpp v144, v144, v144 quad_perm:[2,3,0,1] row_mask:0xf bank_mask:0xf
  v_add_f32_dpp v145, v145, v145 quad_perm:[2,3,0,1] row_mask:0xf bank_mask:0xf
  v_add_f32_dpp v148, v148, v148 quad_perm:[2,3,0,1] row_mask:0xf bank_mask:0xf
  v_add_f32_dpp v149, v149, v149 quad_perm:[2,3,0,1] row_mask:0xf bank_mask:0xf
  v_add_f32_dpp v152, v152, v152 quad_perm:[2,3,0,1] row_mask:0xf bank_mask:0xf
  v_add_f32_dpp v153, v153, v153 quad_perm:[2,3,0,1] row_mask:0xf bank_mask:0xf
  v_add_f32_dpp v144, v144, v144 row_half_mirror row_mask:0xf bank_mask:0xf
  v_add_f32_dpp v145, v145, v145 row_half_mirror row_mask:0xf bank_mask:0xf
  v_add_f32_dpp v148, v148, v148 row_half_mirror row_mask:0xf bank_mask:0xf
  v_add_f32_dpp v149, v149, v149 row_half_mirror row_mask:0xf bank_mask:0xf
  v_add_f32_dpp v152, v152, v152 row_half_mirror row_mask:0xf bank_mask:0xf
  v_add_f32_dpp v153, v153, v153 row_half_mirror row_mask:0xf bank_mask:0xf
  s_nop 0
  v_add_f32_dpp v152, v152, v152 row_mirror row_mask:0xf bank_mask:0xf
  v_add_f32_dpp v153, v153, v153 row_mirror row_mask:0xf bank_mask:0xf
  v_mul_f32 v144, 0x3ae38e39, v144
  v_mul_f32 v148, 0x3ae38e39, v148
  v_mul_f32 v152, 0x3ae38e39, v152
  v_mul_f32 v146, v144, v144
  v_mul_f32 v150, v148, v148
  v_mul_f32 v154, v152, v152
  v_mul_f32 v145, 0x3ae38e39, v145
  v_mul_f32 v149, 0x3ae38e39, v149
  v_mul_f32 v153, 0x3ae38e39, v153
  v_sub_f32 v145, v145, v146
  v_sub_f32 v149, v149, v150
  v_sub_f32 v153, v153, v154
  v_max_f32 v145, 0, v145
  v_max_f32 v149, 0, v149
  v_max_f32 v153, 0, v153
  v_add_f32 v145, 0x3727c5ac, v145
  v_add_f32 v149, 0x3727c5ac, v149
  v_add_f32 v153, 0x3727c5ac, v153
  v_rsq_f32 v145, v145
  v_rsq_f32 v149, v149
  v_rsq_f32 v153, v153
  v_mul_f32 v146, v144, -v145
  v_mul_f32 v150, v148, -v149
  v_mul_f32 v154, v152, -v153
  v_mov_b32 v144, v145
  v_mov_b32 v148, v149
  v_mov_b32 v152, v153
  v_mov_b32 v147, v146
  v_mov_b32 v151, v150
  v_mov_b32 v155, v154
  v_lshrrev_b32 v156, 2, v9
  v_mul_u32_u24 v156, 5120, v156
  v_and_b32 v157, 3, v9
  v_lshl_add_u32 v156, v157, 8, v156
  v_xor_b32 v157, v8, v9
  v_lshl_add_u32 v156, v157, 4, v156
  s_lshl_b32 s84, s68, 10
  s_add_u32 s84, s84, 71680
  v_add_u32 v156, s84, v156
  v_add_u32 v157, 51200, v156
  v_lshrrev_b32 v158, 2, v2
  v_mul_u32_u24 v158, 5120, v158
  v_lshl_add_u32 v158, v15, 8, v158
  v_xor_b32 v159, v10, v9
  v_lshl_add_u32 v158, v159, 4, v158
  v_add_u32 v158, 75776, v158
  v_add_u32 v159, 61440, v158
  v_lshlrev_b32 v112, 16, v160
  v_and_b32 v113, s98, v160
  v_lshlrev_b32 v114, 16, v161
  v_and_b32 v115, s98, v161
  v_lshlrev_b32 v116, 16, v162
  v_and_b32 v117, s98, v162
  v_lshlrev_b32 v118, 16, v163
  v_and_b32 v119, s98, v163
  v_pk_fma_f32 v[112:113], v[112:113], v[144:145], v[146:147]
  v_pk_fma_f32 v[114:115], v[114:115], v[144:145], v[146:147]
  v_pk_fma_f32 v[116:117], v[116:117], v[144:145], v[146:147]
  v_pk_fma_f32 v[118:119], v[118:119], v[144:145], v[146:147]
  v_cvt_pk_bf16_f32 v160, v112, v113
  v_cvt_pk_bf16_f32 v161, v114, v115
  v_cvt_pk_bf16_f32 v162, v116, v117
  v_cvt_pk_bf16_f32 v163, v118, v119
  ds_write_b128 v156, v[160:163] offset:0
  v_lshlrev_b32 v120, 16, v164
  v_and_b32 v121, s98, v164
  v_lshlrev_b32 v122, 16, v165
  v_and_b32 v123, s98, v165
  v_lshlrev_b32 v124, 16, v166
  v_and_b32 v125, s98, v166
  v_lshlrev_b32 v126, 16, v167
  v_and_b32 v127, s98, v167
  v_pk_fma_f32 v[120:121], v[120:121], v[148:149], v[150:151]
  v_pk_fma_f32 v[122:123], v[122:123], v[148:149], v[150:151]
  v_pk_fma_f32 v[124:125], v[124:125], v[148:149], v[150:151]
  v_pk_fma_f32 v[126:127], v[126:127], v[148:149], v[150:151]
  v_cvt_pk_bf16_f32 v164, v120, v121
  v_cvt_pk_bf16_f32 v165, v122, v123
  v_cvt_pk_bf16_f32 v166, v124, v125
  v_cvt_pk_bf16_f32 v167, v126, v127
  ds_write_b128 v156, v[164:167] offset:128
  v_lshlrev_b32 v112, 16, v168
  v_and_b32 v113, s98, v168
  v_lshlrev_b32 v114, 16, v169
  v_and_b32 v115, s98, v169
  v_lshlrev_b32 v116, 16, v170
  v_and_b32 v117, s98, v170
  v_lshlrev_b32 v118, 16, v171
  v_and_b32 v119, s98, v171
  v_pk_fma_f32 v[112:113], v[112:113], v[144:145], v[146:147]
  v_pk_fma_f32 v[114:115], v[114:115], v[144:145], v[146:147]
  v_pk_fma_f32 v[116:117], v[116:117], v[144:145], v[146:147]
  v_pk_fma_f32 v[118:119], v[118:119], v[144:145], v[146:147]
  v_cvt_pk_bf16_f32 v168, v112, v113
  v_cvt_pk_bf16_f32 v169, v114, v115
  v_cvt_pk_bf16_f32 v170, v116, v117
  v_cvt_pk_bf16_f32 v171, v118, v119
  ds_write_b128 v156, v[168:171] offset:10240
  v_lshlrev_b32 v120, 16, v172
  v_and_b32 v121, s98, v172
  v_lshlrev_b32 v122, 16, v173
  v_and_b32 v123, s98, v173
  v_lshlrev_b32 v124, 16, v174
  v_and_b32 v125, s98, v174
  v_lshlrev_b32 v126, 16, v175
  v_and_b32 v127, s98, v175
  v_pk_fma_f32 v[120:121], v[120:121], v[148:149], v[150:151]
  v_pk_fma_f32 v[122:123], v[122:123], v[148:149], v[150:151]
  v_pk_fma_f32 v[124:125], v[124:125], v[148:149], v[150:151]
  v_pk_fma_f32 v[126:127], v[126:127], v[148:149], v[150:151]
  v_cvt_pk_bf16_f32 v172, v120, v121
  v_cvt_pk_bf16_f32 v173, v122, v123
  v_cvt_pk_bf16_f32 v174, v124, v125
  v_cvt_pk_bf16_f32 v175, v126, v127
  ds_write_b128 v156, v[172:175] offset:10368
  v_lshlrev_b32 v112, 16, v232
  v_and_b32 v113, s98, v232
  v_lshlrev_b32 v114, 16, v233
  v_and_b32 v115, s98, v233
  v_lshlrev_b32 v116, 16, v234
  v_and_b32 v117, s98, v234
  v_lshlrev_b32 v118, 16, v235
  v_and_b32 v119, s98, v235
  v_pk_fma_f32 v[112:113], v[112:113], v[152:153], v[154:155]
  v_pk_fma_f32 v[114:115], v[114:115], v[152:153], v[154:155]
  v_pk_fma_f32 v[116:117], v[116:117], v[152:153], v[154:155]
  v_pk_fma_f32 v[118:119], v[118:119], v[152:153], v[154:155]
  v_cvt_pk_bf16_f32 v232, v112, v113
  v_cvt_pk_bf16_f32 v233, v114, v115
  v_cvt_pk_bf16_f32 v234, v116, v117
  v_cvt_pk_bf16_f32 v235, v118, v119
  ds_write_b128 v158, v[232:235] offset:0
  s_lshl_b32 s74, s23, 2
  s_add_u32 s74, s74, s68
  s_mul_i32 s74, s74, 64512
  s_add_u32 s74, s74, 1048576
  s_add_u32 s75, s74, 64512
  s_mul_i32 s78, s0, 7168
  s_add_u32 s78, s78, s74
  v_lshlrev_b32 v7, 7, v3
  v_lshl_add_u32 v7, v2, 4, v7
  v_cmp_gt_u32 vcc, 6, v2
  s_nop 1
  v_cndmask_b32 v7, v13, v7, vcc
  v_xor_b32 v8, v2, v3
  v_lshlrev_b32 v8, 4, v8
  v_lshl_add_u32 v8, v3, 8, v8
  v_add_u32 v8, 71680, v8
  v_xor_b32 v9, 64, v8
  v_add_u32 v10, 46080, v8
  v_add_u32 v11, 46080, v9
  s_mov_b32 s97, 0
L_poll0:
  buffer_load_dword v5, v45, s[60:63], 0 offen sc1
  s_add_u32 s97, s97, 1
  s_waitcnt vmcnt(0)
  v_cmp_ne_u32 vcc, s73, v5
  s_cmp_gt_u32 s97, 400000
  s_cbranch_scc1 L_pdone0
  s_cbranch_vccnz L_poll0
L_pdone0:
  buffer_load_dwordx4 a[64:67], v4, s[60:63], s78 offen offset:0 sc1
  buffer_load_dwordx4 a[68:71], v4, s[60:63], s78 offen offset:1024 sc1
  buffer_load_dwordx4 a[72:75], v4, s[60:63], s78 offen offset:2048 sc1
  buffer_load_dwordx4 a[76:79], v7, s[60:63], s78 offen offset:3072 sc1
  s_add_u32 s78, s78, 3584
  s_cmp_eq_u32 s78, s75
  s_cselect_b32 s78, s74, s78
  buffer_load_dwordx4 a[80:83], v4, s[60:63], s78 offen offset:0 sc1
  buffer_load_dwordx4 a[84:87], v4, s[60:63], s78 offen offset:1024 sc1
  buffer_load_dwordx4 a[88:91], v4, s[60:63], s78 offen offset:2048 sc1
  buffer_load_dwordx4 a[92:95], v7, s[60:63], s78 offen offset:3072 sc1
  s_add_u32 s78, s78, 3584
  s_cmp_eq_u32 s78, s75
  s_cselect_b32 s78, s74, s78
  buffer_load_dwordx4 a[96:99], v4, s[60:63], s78 offen offset:0 sc1
  buffer_load_dwordx4 a[100:103], v4, s[60:63], s78 offen offset:1024 sc1
  buffer_load_dwordx4 a[104:107], v4, s[60:63], s78 offen offset:2048 sc1
  buffer_load_dwordx4 a[108:111], v7, s[60:63], s78 offen offset:3072 sc1
  s_add_u32 s78, s78, 3584
  s_cmp_eq_u32 s78, s75
  s_cselect_b32 s78, s74, s78
  v_lshlrev_b32 v120, 16, v176
  v_and_b32 v121, s98, v176
  v_lshlrev_b32 v122, 16, v177
  v_and_b32 v123, s98, v177
  v_lshlrev_b32 v124, 16, v178
  v_and_b32 v125, s98, v178
  v_lshlrev_b32 v126, 16, v179
  v_and_b32 v127, s98, v179
  v_pk_fma_f32 v[120:121], v[120:121], v[144:145], v[146:147]
  v_pk_fma_f32 v[122:123], v[122:123], v[144:145], v[146:147]
  v_pk_fma_f32 v[124:125], v[124:125], v[144:145], v[146:147]
  v_pk_fma_f32 v[126:127], v[126:127], v[144:145], v[146:147]
  v_cvt_pk_bf16_f32 v176, v120, v121
  v_cvt_pk_bf16_f32 v177, v122, v123
  v_cvt_pk_bf16_f32 v178, v124, v125
  v_cvt_pk_bf16_f32 v179, v126, v127
  ds_write_b128 v156, v[176:179] offset:20480
  v_lshlrev_b32 v112, 16, v180
  v_and_b32 v113, s98, v180
  v_lshlrev_b32 v114, 16, v181
  v_and_b32 v115, s98, v181
  v_lshlrev_b32 v116, 16, v182
  v_and_b32 v117, s98, v182
  v_lshlrev_b32 v118, 16, v183
  v_and_b32 v119, s98, v183
  v_pk_fma_f32 v[112:113], v[112:113], v[148:149], v[150:151]
  v_pk_fma_f32 v[114:115], v[114:115], v[148:149], v[150:151]
  v_pk_fma_f32 v[116:117], v[116:117], v[148:149], v[150:151]
  v_pk_fma_f32 v[118:119], v[118:119], v[148:149], v[150:151]
  v_cvt_pk_bf16_f32 v180, v112, v113
  v_cvt_pk_bf16_f32 v181, v114, v115
  v_cvt_pk_bf16_f32 v182, v116, v117
  v_cvt_pk_bf16_f32 v183, v118, v119
  ds_write_b128 v156, v[180:183] offset:20608
  v_lshlrev_b32 v120, 16, v184
  v_and_b32 v121, s98, v184
  v_lshlrev_b32 v122, 16, v185
  v_and_b32 v123, s98, v185
  v_lshlrev_b32 v124, 16, v186
  v_and_b32 v125, s98, v186
  v_lshlrev_b32 v126, 16, v187
  v_and_b32 v127, s98, v187
  v_pk_fma_f32 v[120:121], v[120:121], v[144:145], v[146:147]
  v_pk_fma_f32 v[122:123], v[122:123], v[144:145], v[146:147]
  v_pk_fma_f32 v[124:125], v[124:125], v[144:145], v[146:147]
  v_pk_fma_f32 v[126:127], v[126:127], v[144:145], v[146:147]
  v_cvt_pk_bf16_f32 v184, v120, v121
  v_cvt_pk_bf16_f32 v185, v122, v123
  v_cvt_pk_bf16_f32 v186, v124, v125
  v_cvt_pk_bf16_f32 v187, v126, v127
  ds_write_b128 v156, v[184:187] offset:30720
  v_lshlrev_b32 v112, 16, v188
  v_and_b32 v113, s98, v188
  v_lshlrev_b32 v114, 16, v189
  v_and_b32 v115, s98, v189
  v_lshlrev_b32 v116, 16, v190
  v_and_b32 v117, s98, v190
  v_lshlrev_b32 v118, 16, v191
  v_and_b32 v119, s98, v191
  v_pk_fma_f32 v[112:113], v[112:113], v[148:149], v[150:151]
  v_pk_fma_f32 v[114:115], v[114:115], v[148:149], v[150:151]
  v_pk_fma_f32 v[116:117], v[116:117], v[148:149], v[150:151]
  v_pk_fma_f32 v[118:119], v[118:119], v[148:149], v[150:151]
  v_cvt_pk_bf16_f32 v188, v112, v113
  v_cvt_pk_bf16_f32 v189, v114, v115
  v_cvt_pk_bf16_f32 v190, v116, v117
  v_cvt_pk_bf16_f32 v191, v118, v119
  ds_write_b128 v156, v[188:191] offset:30848
  v_lshlrev_b32 v120, 16, v236
  v_and_b32 v121, s98, v236
  v_lshlrev_b32 v122, 16, v237
  v_and_b32 v123, s98, v237
  v_lshlrev_b32 v124, 16, v238
  v_and_b32 v125, s98, v238
  v_lshlrev_b32 v126, 16, v239
  v_and_b32 v127, s98, v239
  v_pk_fma_f32 v[120:121], v[120:121], v[152:153], v[154:155]
  v_pk_fma_f32 v[122:123], v[122:123], v[152:153], v[154:155]
  v_pk_fma_f32 v[124:125], v[124:125], v[152:153], v[154:155]
  v_pk_fma_f32 v[126:127], v[126:127], v[152:153], v[154:155]
  v_cvt_pk_bf16_f32 v236, v120, v121
  v_cvt_pk_bf16_f32 v237, v122, v123
  v_cvt_pk_bf16_f32 v238, v124, v125
  v_cvt_pk_bf16_f32 v239, v126, v127
  ds_write_b128 v158, v[236:239] offset:20480
  s_waitcnt lgkmcnt(0)
  s_barrier
  ds_read_b128 a[0:3], v8 offset:0
  ds_read_b128 a[4:7], v8 offset:1024
  ds_read_b128 a[8:11], v8 offset:2048
  ds_read_b128 a[12:15], v8 offset:3072
  ds_read_b128 a[16:19], v8 offset:4096
L_markA:
  s_waitcnt vmcnt(10) lgkmcnt(4)
  v_mfma_f32_16x16x32_bf16 v[32:35], a[68:71], a[0:3], 0
  v_lshlrev_b32 v112, 16, v192
  v_and_b32 v113, s98, v192
  s_waitcnt vmcnt(9)
  v_mfma_f32_16x16x32_bf16 v[72:75], a[0:3], a[72:75], 0
  ds_read_b128 a[20:23], v9 offset:5120
  v_lshlrev_b32 v114, 16, v193
  s_waitcnt vmcnt(8)
  v_mfma_f32_16x16x32_bf16 v[52:55], a[76:79], a[0:3], 0
  buffer_load_dwordx4 a[112:115], v4, s[60:63], s78 offen offset:0 sc1
  v_and_b32 v115, s98, v193
  v_mfma_f32_16x16x32_bf16 v[16:19], a[64:67], a[0:3], 0
  ds_read_b128 a[24:27], v9 offset:6144
  v_lshlrev_b32 v116, 16, v194
  s_waitcnt lgkmcnt(5)
  v_mfma_f32_16x16x32_bf16 v[36:39], a[68:71], a[4:7], 0
  v_and_b32 v117, s98, v194
  v_lshlrev_b32 v118, 16, v195
  v_mfma_f32_16x16x32_bf16 v[76:79], a[4:7], a[72:75], 0
  ds_read_b128 a[28:31], v9 offset:7168
  v_and_b32 v119, s98, v195
  v_mfma_f32_16x16x32_bf16 v[56:59], a[76:79], a[4:7], 0
  buffer_load_dwordx4 a[116:119], v4, s[60:63], s78 offen offset:1024 sc1
  v_fma_f32 v112, v112, v144, v146
  v_mfma_f32_16x16x32_bf16 v[20:23], a[64:67], a[4:7], 0
  ds_read_b128 a[32:35], v9 offset:8192
  v_fma_f32 v113, v113, v144, v146
  s_waitcnt lgkmcnt(6)
  v_mfma_f32_16x16x32_bf16 v[40:43], a[68:71], a[8:11], 0
  v_fma_f32 v114, v114, v144, v146
  v_fma_f32 v115, v115, v144, v146
  v_mfma_f32_16x16x32_bf16 v[80:83], a[8:11], a[72:75], 0
  ds_read_b128 a[36:39], v9 offset:9216
  v_fma_f32 v116, v116, v144, v146
  v_mfma_f32_16x16x32_bf16 v[60:63], a[76:79], a[8:11], 0
  buffer_load_dwordx4 a[120:123], v4, s[60:63], s78 offen offset:2048 sc1
  v_fma_f32 v117, v117, v144, v146
  v_mfma_f32_16x16x32_bf16 v[24:27], a[64:67], a[8:11], 0
  v_fma_f32 v118, v118, v144, v146
  v_fma_f32 v119, v119, v144, v146
  s_waitcnt lgkmcnt(6)
  v_mfma_f32_16x16x32_bf16 v[44:47], a[68:71], a[12:15], 0
  buffer_load_dwordx4 a[124:127], v7, s[60:63], s78 offen offset:3072 sc1
  v_cvt_pk_bf16_f32 v192, v112, v113
  v_mfma_f32_16x16x32_bf16 v[84:87], a[12:15], a[72:75], 0
  v_cvt_pk_bf16_f32 v193, v114, v115
  v_cvt_pk_bf16_f32 v194, v116, v117
  v_mfma_f32_16x16x32_bf16 v[64:67], a[76:79], a[12:15], 0
  s_add_u32 s78, s78, 3584
  s_cmp_eq_u32 s78, s75
  s_cselect_b32 s78, s74, s78
  v_mfma_f32_16x16x32_bf16 v[28:31], a[64:67], a[12:15], 0
  v_cvt_pk_bf16_f32 v195, v118, v119
  s_waitcnt lgkmcnt(5)
  v_mfma_f32_16x16x32_bf16 v[48:51], a[68:71], a[16:19], 0
  ds_write_b128 v156, v[192:195] offset:40960
  v_mfma_f32_16x16x32_bf16 v[88:91], a[16:19], a[72:75], 0
  v_lshlrev_b32 v120, 16, v196
  v_and_b32 v121, s98, v196
  v_mfma_f32_16x16x32_bf16 v[68:71], a[76:79], a[16:19], 0
  s_waitcnt vmcnt(8) lgkmcnt(1)
  v_lshlrev_b32 v122, 16, v197
  v_and_b32 v123, s98, v197
  v_mfma_f32_16x16x32_bf16 v[32:35], a[84:87], a[20:23], v[32:35]
  v_lshlrev_b32 v124, 16, v198
  v_and_b32 v125, s98, v198
  v_mfma_f32_16x16x32_bf16 v[72:75], a[20:23], a[88:91], v[72:75]
  ds_read_b128 a[0:3], v8 offset:10240
  v_lshlrev_b32 v126, 16, v199
  v_mfma_f32_16x16x32_bf16 v[52:55], a[92:95], a[20:23], v[52:55]
  buffer_load_dwordx4 a[64:67], v4, s[60:63], s78 offen offset:0 sc1
  v_and_b32 v127, s98, v199
  v_mfma_f32_16x16x32_bf16 v[16:19], a[80:83], a[20:23], v[16:19]
  ds_read_b128 a[4:7], v8 offset:11264
  v_fma_f32 v120, v120, v148, v150
  v_mfma_f32_16x16x32_bf16 v[36:39], a[84:87], a[24:27], v[36:39]
  v_fma_f32 v121, v121, v148, v150
  v_fma_f32 v122, v122, v148, v150
  v_mfma_f32_16x16x32_bf16 v[76:79], a[24:27], a[88:91], v[76:79]
  ds_read_b128 a[8:11], v8 offset:12288
  v_fma_f32 v123, v123, v148, v150
  v_mfma_f32_16x16x32_bf16 v[56:59], a[92:95], a[24:27], v[56:59]
  buffer_load_dwordx4 a[68:71], v4, s[60:63], s78 offen offset:1024 sc1
  v_fma_f32 v124, v124, v148, v150
  v_mfma_f32_16x16x32_bf16 v[20:23], a[80:83], a[24:27], v[20:23]
  ds_read_b128 a[12:15], v8 offset:13312
  v_fma_f32 v125, v125, v148, v150
  v_mfma_f32_16x16x32_bf16 v[40:43], a[84:87], a[28:31], v[40:43]
  v_fma_f32 v126, v126, v148, v150
  v_fma_f32 v127, v127, v148, v150
  v_mfma_f32_16x16x32_bf16 v[80:83], a[28:31], a[88:91], v[80:83]
  ds_read_b128 a[16:19], v8 offset:14336
  v_cvt_pk_bf16_f32 v196, v120, v121
  v_mfma_f32_16x16x32_bf16 v[60:63], a[92:95], a[28:31], v[60:63]
  buffer_load_dwordx4 a[72:75], v4, s[60:63], s78 offen offset:2048 sc1
  v_cvt_pk_bf16_f32 v197, v122, v123
  v_mfma_f32_16x16x32_bf16 v[24:27], a[80:83], a[28:31], v[24:27]
  v_cvt_pk_bf16_f32 v198, v124, v125
  v_cvt_pk_bf16_f32 v199, v126, v127
  v_mfma_f32_16x16x32_bf16 v[44:47], a[84:87], a[32:35], v[44:47]
  buffer_load_dwordx4 a[76:79], v7, s[60:63], s78 offen offset:3072 sc1
  v_mfma_f32_16x16x32_bf16 v[84:87], a[32:35], a[88:91], v[84:87]
  ds_write_b128 v156, v[196:199] offset:41088
  v_mfma_f32_16x16x32_bf16 v[64:67], a[92:95], a[32:35], v[64:67]
  s_add_u32 s78, s78, 3584
  s_cmp_eq_u32 s78, s75
  s_cselect_b32 s78, s74, s78
  v_mfma_f32_16x16x32_bf16 v[28:31], a[80:83], a[32:35], v[28:31]
  v_lshlrev_b32 v112, 16, v200
  v_and_b32 v113, s98, v200
  v_mfma_f32_16x16x32_bf16 v[48:51], a[84:87], a[36:39], v[48:51]
  v_lshlrev_b32 v114, 16, v201
  v_and_b32 v115, s98, v201
  v_mfma_f32_16x16x32_bf16 v[88:91], a[36:39], a[88:91], v[88:91]
  v_lshlrev_b32 v116, 16, v202
  v_and_b32 v117, s98, v202
  v_mfma_f32_16x16x32_bf16 v[68:71], a[92:95], a[36:39], v[68:71]
  s_waitcnt vmcnt(8) lgkmcnt(1)
  v_lshlrev_b32 v118, 16, v203
  v_and_b32 v119, s98, v203
  v_mfma_f32_16x16x32_bf16 v[32:35], a[100:103], a[0:3], v[32:35]
  v_fma_f32 v112, v112, v144, v146
  v_fma_f32 v113, v113, v144, v146
  v_mfma_f32_16x16x32_bf16 v[72:75], a[0:3], a[104:107], v[72:75]
  ds_read_b128 a[20:23], v9 offset:15360
  v_fma_f32 v114, v114, v144, v146
  v_mfma_f32_16x16x32_bf16 v[52:55], a[108:111], a[0:3], v[52:55]
  buffer_load_dwordx4 a[80:83], v4, s[60:63], s78 offen offset:0 sc1
  v_fma_f32 v115, v115, v144, v146
  v_mfma_f32_16x16x32_bf16 v[16:19], a[96:99], a[0:3], v[16:19]
  ds_read_b128 a[24:27], v9 offset:16384
  v_fma_f32 v116, v116, v144, v146
  v_mfma_f32_16x16x32_bf16 v[36:39], a[100:103], a[4:7], v[36:39]
  v_fma_f32 v117, v117, v144, v146
  v_fma_f32 v118, v118, v144, v146
  v_mfma_f32_16x16x32_bf16 v[76:79], a[4:7], a[104:107], v[76:79]
  ds_read_b128 a[28:31], v9 offset:17408
  v_fma_f32 v119, v119, v144, v146
  v_mfma_f32_16x16x32_bf16 v[56:59], a[108:111], a[4:7], v[56:59]
  buffer_load_dwordx4 a[84:87], v4, s[60:63], s78 offen offset:1024 sc1
  v_cvt_pk_bf16_f32 v200, v112, v113
  v_mfma_f32_16x16x32_bf16 v[20:23], a[96:99], a[4:7], v[20:23]
  ds_read_b128 a[32:35], v9 offset:18432
  v_cvt_pk_bf16_f32 v201, v114, v115
  v_mfma_f32_16x16x32_bf16 v[40:43], a[100:103], a[8:11], v[40:43]
  v_cvt_pk_bf16_f32 v202, v116, v117
  v_cvt_pk_bf16_f32 v203, v118, v119
  v_mfma_f32_16x16x32_bf16 v[80:83], a[8:11], a[104:107], v[80:83]
  ds_read_b128 a[36:39], v9 offset:19456
  v_mfma_f32_16x16x32_bf16 v[60:63], a[108:111], a[8:11], v[60:63]
  buffer_load_dwordx4 a[88:91], v4, s[60:63], s78 offen offset:2048 sc1
  v_mfma_f32_16x16x32_bf16 v[24:27], a[96:99], a[8:11], v[24:27]
  ds_write_b128 v157, v[200:203] offset:0
  v_mfma_f32_16x16x32_bf16 v[44:47], a[100:103], a[12:15], v[44:47]
  buffer_load_dwordx4 a[92:95], v7, s[60:63], s78 offen offset:3072 sc1
  v_lshlrev_b32 v120, 16, v204
  v_mfma_f32_16x16x32_bf16 v[84:87], a[12:15], a[104:107], v[84:87]
  v_and_b32 v121, s98, v204
  v_lshlrev_b32 v122, 16, v205
  v_mfma_f32_16x16x32_bf16 v[64:67], a[108:111], a[12:15], v[64:67]
  s_add_u32 s78, s78, 3584
  s_cmp_eq_u32 s78, s75
  s_cselect_b32 s78, s74, s78
  v_mfma_f32_16x16x32_bf16 v[28:31], a[96:99], a[12:15], v[28:31]
  v_and_b32 v123, s98, v205
  v_lshlrev_b32 v124, 16, v206
  v_mfma_f32_16x16x32_bf16 v[48:51], a[100:103], a[16:19], v[48:51]
  v_and_b32 v125, s98, v206
  v_lshlrev_b32 v126, 16, v207
  v_mfma_f32_16x16x32_bf16 v[88:91], a[16:19], a[104:107], v[88:91]
  v_and_b32 v127, s98, v207
  v_fma_f32 v120, v120, v148, v150
  v_mfma_f32_16x16x32_bf16 v[68:71], a[108:111], a[16:19], v[68:71]
  s_waitcnt vmcnt(8) lgkmcnt(1)
  v_fma_f32 v121, v121, v148, v150
  v_fma_f32 v122, v122, v148, v150
  v_mfma_f32_16x16x32_bf16 v[32:35], a[116:119], a[20:23], v[32:35]
  ds_read_b64_tr_b16 v[128:129], v94 offset:0
  ds_read_b64_tr_b16 v[130:131], v94 offset:512
  v_mfma_f32_16x16x32_bf16 v[72:75], a[20:23], a[120:123], v[72:75]
  ds_read_b128 a[0:3], v8 offset:20480
  ds_read_b64_tr_b16 v[132:133], v94 offset:8
  v_mfma_f32_16x16x32_bf16 v[52:55], a[124:127], a[20:23], v[52:55]
  buffer_load_dwordx4 a[96:99], v4, s[60:63], s78 offen offset:0 sc1
  ds_read_b64_tr_b16 v[134:135], v94 offset:520
  v_mfma_f32_16x16x32_bf16 v[16:19], a[112:115], a[20:23], v[16:19]
  ds_read_b128 a[4:7], v8 offset:21504
  ds_read_b64_tr_b16 v[136:137], v94 offset:64
  v_mfma_f32_16x16x32_bf16 v[36:39], a[116:119], a[24:27], v[36:39]
  ds_read_b64_tr_b16 v[138:139], v94 offset:576
  ds_read_b64_tr_b16 v[140:141], v94 offset:72
  v_mfma_f32_16x16x32_bf16 v[76:79], a[24:27], a[120:123], v[76:79]
  ds_read_b128 a[8:11], v8 offset:22528
  ds_read_b64_tr_b16 v[142:143], v94 offset:584
  v_mfma_f32_16x16x32_bf16 v[56:59], a[124:127], a[24:27], v[56:59]
  buffer_load_dwordx4 a[100:103], v4, s[60:63], s78 offen offset:1024 sc1
  v_fma_f32 v123, v123, v148, v150
  v_mfma_f32_16x16x32_bf16 v[20:23], a[112:115], a[24:27], v[20:23]
  ds_read_b128 a[12:15], v8 offset:23552
  v_fma_f32 v124, v124, v148, v150
  v_mfma_f32_16x16x32_bf16 v[40:43], a[116:119], a[28:31], v[40:43]
  s_waitcnt lgkmcnt(10)
  buffer_store_dwordx4 v[128:131], v4, s[60:63], s33 offen sc1
  v_fma_f32 v125, v125, v148, v150
  v_mfma_f32_16x16x32_bf16 v[80:83], a[28:31], a[120:123], v[80:83]
  ds_read_b128 a[16:19], v8 offset:24576
  v_fma_f32 v126, v126, v148, v150
  v_mfma_f32_16x16x32_bf16 v[60:63], a[124:127], a[28:31], v[60:63]
  buffer_load_dwordx4 a[104:107], v4, s[60:63], s78 offen offset:2048 sc1
  v_fma_f32 v127, v127, v148, v150
  v_mfma_f32_16x16x32_bf16 v[24:27], a[112:115], a[28:31], v[24:27]
  v_cvt_pk_bf16_f32 v204, v120, v121
  v_cvt_pk_bf16_f32 v205, v122, v123
  v_mfma_f32_16x16x32_bf16 v[44:47], a[116:119], a[32:35], v[44:47]
  buffer_load_dwordx4 a[108:111], v7, s[60:63], s78 offen offset:3072 sc1
  v_cvt_pk_bf16_f32 v206, v124, v125
  v_mfma_f32_16x16x32_bf16 v[84:87], a[32:35], a[120:123], v[84:87]
  s_add_u32 s33, s33, s34
  s_waitcnt lgkmcnt(8)
  buffer_store_dwordx4 v[132:135], v4, s[60:63], s33 offen sc1
  v_mfma_f32_16x16x32_bf16 v[64:67], a[124:127], a[32:35], v[64:67]
  s_add_u32 s78, s78, 3584
  s_cmp_eq_u32 s78, s75
  s_cselect_b32 s78, s74, s78
  v_mfma_f32_16x16x32_bf16 v[28:31], a[112:115], a[32:35], v[28:31]
  v_cvt_pk_bf16_f32 v207, v126, v127
  v_mfma_f32_16x16x32_bf16 v[48:51], a[116:119], a[36:39], v[48:51]
  s_add_u32 s33, s33, s34
  s_waitcnt lgkmcnt(5)
  buffer_store_dwordx4 v[136:139], v4, s[60:63], s33 offen sc1
  v_mfma_f32_16x16x32_bf16 v[88:91], a[36:39], a[120:123], v[88:91]
  ds_write_b128 v157, v[204:207] offset:128
  v_mfma_f32_16x16x32_bf16 v[68:71], a[124:127], a[36:39], v[68:71]
  s_waitcnt vmcnt(11) lgkmcnt(1)
  v_lshlrev_b32 v112, 16, v240
  v_and_b32 v113, s98, v240
  v_mfma_f32_16x16x32_bf16 v[32:35], a[68:71], a[0:3], v[32:35]
  v_lshlrev_b32 v114, 16, v241
  v_and_b32 v115, s98, v241
  v_mfma_f32_16x16x32_bf16 v[72:75], a[0:3], a[72:75], v[72:75]
  ds_read_b128 a[20:23], v9 offset:25600
  v_lshlrev_b32 v116, 16, v242
  v_mfma_f32_16x16x32_bf16 v[52:55], a[76:79], a[0:3], v[52:55]
  buffer_load_dwordx4 a[112:115], v4, s[60:63], s78 offen offset:0 sc1
  v_and_b32 v117, s98, v242
  v_mfma_f32_16x16x32_bf16 v[16:19], a[64:67], a[0:3], v[16:19]
  ds_read_b128 a[24:27], v9 offset:26624
  v_lshlrev_b32 v118, 16, v243
  v_mfma_f32_16x16x32_bf16 v[36:39], a[68:71], a[4:7], v[36:39]
  s_add_u32 s33, s33, s34
  buffer_store_dwordx4 v[140:143], v4, s[60:63], s33 offen sc1
  v_mfma_f32_16x16x32_bf16 v[76:79], a[4:7], a[72:75], v[76:79]
  ds_read_b128 a[28:31], v9 offset:27648
  ds_read_b64_tr_b16 v[128:129], v94 offset:4096
  v_mfma_f32_16x16x32_bf16 v[56:59], a[76:79], a[4:7], v[56:59]
  buffer_load_dwordx4 a[116:119], v4, s[60:63], s78 offen offset:1024 sc1
  ds_read_b64_tr_b16 v[130:131], v94 offset:4608
  v_mfma_f32_16x16x32_bf16 v[20:23], a[64:67], a[4:7], v[20:23]
  ds_read_b128 a[32:35], v9 offset:28672
  ds_read_b64_tr_b16 v[132:133], v94 offset:4104
  v_mfma_f32_16x16x32_bf16 v[40:43], a[68:71], a[8:11], v[40:43]
  ds_read_b64_tr_b16 v[134:135], v94 offset:4616
  ds_read_b64_tr_b16 v[136:137], v94 offset:4160
  v_mfma_f32_16x16x32_bf16 v[80:83], a[8:11], a[72:75], v[80:83]
  ds_read_b128 a[36:39], v9 offset:29696
  ds_read_b64_tr_b16 v[138:139], v94 offset:4672
  v_mfma_f32_16x16x32_bf16 v[60:63], a[76:79], a[8:11], v[60:63]
  buffer_load_dwordx4 a[120:123], v4, s[60:63], s78 offen offset:2048 sc1
  ds_read_b64_tr_b16 v[140:141], v94 offset:4168
  v_mfma_f32_16x16x32_bf16 v[24:27], a[64:67], a[8:11], v[24:27]
  ds_read_b64_tr_b16 v[142:143], v94 offset:4680
  v_and_b32 v119, s98, v243
  v_mfma_f32_16x16x32_bf16 v[44:47], a[68:71], a[12:15], v[44:47]
  buffer_load_dwordx4 a[124:127], v7, s[60:63], s78 offen offset:3072 sc1
  v_fma_f32 v112, v112, v152, v154
  v_mfma_f32_16x16x32_bf16 v[84:87], a[12:15], a[72:75], v[84:87]
  s_waitcnt lgkmcnt(8)
  buffer_store_dwordx4 v[128:131], v4, s[60:63], s36 offen sc1
  v_fma_f32 v113, v113, v152, v154
  v_mfma_f32_16x16x32_bf16 v[64:67], a[76:79], a[12:15], v[64:67]
  s_add_u32 s78, s78, 3584
  s_cmp_eq_u32 s78, s75
  s_cselect_b32 s78, s74, s78
  v_mfma_f32_16x16x32_bf16 v[28:31], a[64:67], a[12:15], v[28:31]
  v_fma_f32 v114, v114, v152, v154
  v_fma_f32 v115, v115, v152, v154
  v_mfma_f32_16x16x32_bf16 v[48:51], a[68:71], a[16:19], v[48:51]
  v_fma_f32 v116, v116, v152, v154
  v_fma_f32 v117, v117, v152, v154
  v_mfma_f32_16x16x32_bf16 v[88:91], a[16:19], a[72:75], v[88:91]
  s_add_u32 s36, s36, s37
  s_waitcnt lgkmcnt(5)
  buffer_store_dwordx4 v[132:135], v4, s[60:63], s36 offen sc1
  v_mfma_f32_16x16x32_bf16 v[68:71], a[76:79], a[16:19], v[68:71]
  s_waitcnt vmcnt(14) lgkmcnt(3)
  v_fma_f32 v118, v118, v152, v154
  v_fma_f32 v119, v119, v152, v154
  v_mfma_f32_16x16x32_bf16 v[32:35], a[84:87], a[20:23], v[32:35]
  v_cvt_pk_bf16_f32 v240, v112, v113
  v_cvt_pk_bf16_f32 v241, v114, v115
  v_mfma_f32_16x16x32_bf16 v[72:75], a[20:23], a[88:91], v[72:75]
  ds_read_b128 a[0:3], v8 offset:30720
  v_cvt_pk_bf16_f32 v242, v116, v117
  v_mfma_f32_16x16x32_bf16 v[52:55], a[92:95], a[20:23], v[52:55]
  buffer_load_dwordx4 a[64:67], v4, s[60:63], s78 offen offset:0 sc1
  v_cvt_pk_bf16_f32 v243, v118, v119
  v_mfma_f32_16x16x32_bf16 v[16:19], a[80:83], a[20:23], v[16:19]
  ds_read_b128 a[4:7], v8 offset:31744
  v_mfma_f32_16x16x32_bf16 v[36:39], a[84:87], a[24:27], v[36:39]
  s_add_u32 s36, s36, s37
  s_waitcnt lgkmcnt(4)
  buffer_store_dwordx4 v[136:139], v4, s[60:63], s36 offen sc1
  v_mfma_f32_16x16x32_bf16 v[76:79], a[24:27], a[88:91], v[76:79]
  ds_read_b128 a[8:11], v8 offset:32768
  v_mfma_f32_16x16x32_bf16 v[56:59], a[92:95], a[24:27], v[56:59]
  buffer_load_dwordx4 a[68:71], v4, s[60:63], s78 offen offset:1024 sc1
  v_mfma_f32_16x16x32_bf16 v[20:23], a[80:83], a[24:27], v[20:23]
  ds_read_b128 a[12:15], v8 offset:33792
  v_mfma_f32_16x16x32_bf16 v[40:43], a[84:87], a[28:31], v[40:43]
  s_add_u32 s36, s36, s37
  s_waitcnt lgkmcnt(4)
  buffer_store_dwordx4 v[140:143], v4, s[60:63], s36 offen sc1
  v_mfma_f32_16x16x32_bf16 v[80:83], a[28:31], a[88:91], v[80:83]
  ds_read_b128 a[16:19], v8 offset:34816
  v_mfma_f32_16x16x32_bf16 v[60:63], a[92:95], a[28:31], v[60:63]
  buffer_load_dwordx4 a[72:75], v4, s[60:63], s78 offen offset:2048 sc1
  v_mfma_f32_16x16x32_bf16 v[24:27], a[80:83], a[28:31], v[24:27]
  ds_write_b128 v158, v[240:243] offset:40960
  v_mfma_f32_16x16x32_bf16 v[44:47], a[84:87], a[32:35], v[44:47]
  buffer_load_dwordx4 a[76:79], v7, s[60:63], s78 offen offset:3072 sc1
  v_lshlrev_b32 v120, 16, v208
  v_mfma_f32_16x16x32_bf16 v[84:87], a[32:35], a[88:91], v[84:87]
  v_and_b32 v121, s98, v208
  v_lshlrev_b32 v122, 16, v209
  v_mfma_f32_16x16x32_bf16 v[64:67], a[92:95], a[32:35], v[64:67]
  s_add_u32 s78, s78, 3584
  s_cmp_eq_u32 s78, s75
  s_cselect_b32 s78, s74, s78
  v_mfma_f32_16x16x32_bf16 v[28:31], a[80:83], a[32:35], v[28:31]
  v_and_b32 v123, s98, v209
  v_lshlrev_b32 v124, 16, v210
  v_mfma_f32_16x16x32_bf16 v[48:51], a[84:87], a[36:39], v[48:51]
  v_and_b32 v125, s98, v210
  v_lshlrev_b32 v126, 16, v211
  v_mfma_f32_16x16x32_bf16 v[88:91], a[36:39], a[88:91], v[88:91]
  v_and_b32 v127, s98, v211
  v_fma_f32 v120, v120, v144, v146
  v_mfma_f32_16x16x32_bf16 v[68:71], a[92:95], a[36:39], v[68:71]
  s_waitcnt vmcnt(15) lgkmcnt(1)
  v_fma_f32 v121, v121, v144, v146
  v_fma_f32 v122, v122, v144, v146
  v_mfma_f32_16x16x32_bf16 v[32:35], a[100:103], a[0:3], v[32:35]
  v_fma_f32 v123, v123, v144, v146
  v_fma_f32 v124, v124, v144, v146
  v_mfma_f32_16x16x32_bf16 v[72:75], a[0:3], a[104:107], v[72:75]
  ds_read_b128 a[20:23], v9 offset:35840
  v_fma_f32 v125, v125, v144, v146
  v_mfma_f32_16x16x32_bf16 v[52:55], a[108:111], a[0:3], v[52:55]
  buffer_load_dwordx4 a[80:83], v4, s[60:63], s78 offen offset:0 sc1
  v_fma_f32 v126, v126, v144, v146
  v_mfma_f32_16x16x32_bf16 v[16:19], a[96:99], a[0:3], v[16:19]
  ds_read_b128 a[24:27], v9 offset:36864
  v_fma_f32 v127, v127, v144, v146
  v_mfma_f32_16x16x32_bf16 v[36:39], a[100:103], a[4:7], v[36:39]
  v_cvt_pk_bf16_f32 v208, v120, v121
  v_cvt_pk_bf16_f32 v209, v122, v123
  v_mfma_f32_16x16x32_bf16 v[76:79], a[4:7], a[104:107], v[76:79]
  ds_read_b128 a[28:31], v9 offset:37888
  v_cvt_pk_bf16_f32 v210, v124, v125
  v_mfma_f32_16x16x32_bf16 v[56:59], a[108:111], a[4:7], v[56:59]
  buffer_load_dwordx4 a[84:87], v4, s[60:63], s78 offen offset:1024 sc1
  v_cvt_pk_bf16_f32 v211, v126, v127
  v_mfma_f32_16x16x32_bf16 v[20:23], a[96:99], a[4:7], v[20:23]
  ds_read_b128 a[32:35], v9 offset:38912
  v_mfma_f32_16x16x32_bf16 v[40:43], a[100:103], a[8:11], v[40:43]
  ds_write_b128 v157, v[208:211] offset:10240
  v_mfma_f32_16x16x32_bf16 v[80:83], a[8:11], a[104:107], v[80:83]
  ds_read_b128 a[36:39], v9 offset:39936
  v_lshlrev_b32 v112, 16, v212
  v_mfma_f32_16x16x32_bf16 v[60:63], a[108:111], a[8:11], v[60:63]
  buffer_load_dwordx4 a[88:91], v4, s[60:63], s78 offen offset:2048 sc1
  v_and_b32 v113, s98, v212
  v_mfma_f32_16x16x32_bf16 v[24:27], a[96:99], a[8:11], v[24:27]
  v_lshlrev_b32 v114, 16, v213
  v_and_b32 v115, s98, v213
  v_mfma_f32_16x16x32_bf16 v[44:47], a[100:103], a[12:15], v[44:47]
  buffer_load_dwordx4 a[92:95], v7, s[60:63], s78 offen offset:3072 sc1
  v_lshlrev_b32 v116, 16, v214
  v_mfma_f32_16x16x32_bf16 v[84:87], a[12:15], a[104:107], v[84:87]
  v_and_b32 v117, s98, v214
  v_lshlrev_b32 v118, 16, v215
  v_mfma_f32_16x16x32_bf16 v[64:67], a[108:111], a[12:15], v[64:67]
  s_add_u32 s78, s78, 3584
  s_cmp_eq_u32 s78, s75
  s_cselect_b32 s78, s74, s78
  v_mfma_f32_16x16x32_bf16 v[28:31], a[96:99], a[12:15], v[28:31]
  v_and_b32 v119, s98, v215
  v_fma_f32 v112, v112, v148, v150
  v_mfma_f32_16x16x32_bf16 v[48:51], a[100:103], a[16:19], v[48:51]
  v_fma_f32 v113, v113, v148, v150
  v_fma_f32 v114, v114, v148, v150
  v_mfma_f32_16x16x32_bf16 v[88:91], a[16:19], a[104:107], v[88:91]
  v_fma_f32 v115, v115, v148, v150
  v_fma_f32 v116, v116, v148, v150
  v_mfma_f32_16x16x32_bf16 v[68:71], a[108:111], a[16:19], v[68:71]
  s_waitcnt vmcnt(12) lgkmcnt(0)
  v_fma_f32 v117, v117, v148, v150
  v_fma_f32 v118, v118, v148, v150
  v_mfma_f32_16x16x32_bf16 v[32:35], a[116:119], a[20:23], v[32:35]
  s_barrier
  v_fma_f32 v119, v119, v148, v150
  v_mfma_f32_16x16x32_bf16 v[72:75], a[20:23], a[120:123], v[72:75]
  ds_read_b128 a[0:3], v8 offset:40960
  v_cvt_pk_bf16_f32 v212, v112, v113
  v_mfma_f32_16x16x32_bf16 v[52:55], a[124:127], a[20:23], v[52:55]
  buffer_load_dwordx4 a[96:99], v4, s[60:63], s78 offen offset:0 sc1
  v_cvt_pk_bf16_f32 v213, v114, v115
  v_mfma_f32_16x16x32_bf16 v[16:19], a[112:115], a[20:23], v[16:19]
  ds_read_b128 a[4:7], v8 offset:41984
  v_cvt_pk_bf16_f32 v214, v116, v117
  v_mfma_f32_16x16x32_bf16 v[36:39], a[116:119], a[24:27], v[36:39]
  v_cvt_pk_bf16_f32 v215, v118, v119
  v_mfma_f32_16x16x32_bf16 v[76:79], a[24:27], a[120:123], v[76:79]
  ds_read_b128 a[8:11], v8 offset:43008
  v_mfma_f32_16x16x32_bf16 v[56:59], a[124:127], a[24:27], v[56:59]
  buffer_load_dwordx4 a[100:103], v4, s[60:63], s78 offen offset:1024 sc1
  v_mfma_f32_16x16x32_bf16 v[20:23], a[112:115], a[24:27], v[20:23]
  ds_read_b128 a[12:15], v8 offset:44032
  v_mfma_f32_16x16x32_bf16 v[40:43], a[116:119], a[28:31], v[40:43]
  ds_write_b128 v157, v[212:215] offset:10368
  v_mfma_f32_16x16x32_bf16 v[80:83], a[28:31], a[120:123], v[80:83]
  ds_read_b128 a[16:19], v8 offset:45056
  v_lshlrev_b32 v120, 16, v216
  v_mfma_f32_16x16x32_bf16 v[60:63], a[124:127], a[28:31], v[60:63]
  buffer_load_dwordx4 a[104:107], v4, s[60:63], s78 offen offset:2048 sc1
  v_and_b32 v121, s98, v216
  v_mfma_f32_16x16x32_bf16 v[24:27], a[112:115], a[28:31], v[24:27]
  v_lshlrev_b32 v122, 16, v217
  v_and_b32 v123, s98, v217
  v_mfma_f32_16x16x32_bf16 v[44:47], a[116:119], a[32:35], v[44:47]
  buffer_load_dwordx4 a[108:111], v7, s[60:63], s78 offen offset:3072 sc1
  v_lshlrev_b32 v124, 16, v218
  v_mfma_f32_16x16x32_bf16 v[84:87], a[32:35], a[120:123], v[84:87]
  v_and_b32 v125, s98, v218
  v_lshlrev_b32 v126, 16, v219
  v_mfma_f32_16x16x32_bf16 v[64:67], a[124:127], a[32:35], v[64:67]
  s_add_u32 s78, s78, 3584
  s_cmp_eq_u32 s78, s75
  s_cselect_b32 s78, s74, s78
  v_mfma_f32_16x16x32_bf16 v[28:31], a[112:115], a[32:35], v[28:31]
  v_and_b32 v127, s98, v219
  v_fma_f32 v120, v120, v144, v146
  v_mfma_f32_16x16x32_bf16 v[48:51], a[116:119], a[36:39], v[48:51]
  v_fma_f32 v121, v121, v144, v146
  v_fma_f32 v122, v122, v144, v146
  v_mfma_f32_16x16x32_bf16 v[88:91], a[36:39], a[120:123], v[88:91]
  v_fma_f32 v123, v123, v144, v146
  v_fma_f32 v124, v124, v144, v146
  v_mfma_f32_16x16x32_bf16 v[68:71], a[124:127], a[36:39], v[68:71]
  s_waitcnt vmcnt(8) lgkmcnt(0)
  v_fma_f32 v125, v125, v144, v146
  v_fma_f32 v126, v126, v144, v146
  v_mfma_f32_16x16x32_bf16 v[32:35], a[68:71], a[0:3], v[32:35]
  v_fma_f32 v127, v127, v144, v146
  v_cvt_pk_bf16_f32 v216, v120, v121
  v_mfma_f32_16x16x32_bf16 v[72:75], a[0:3], a[72:75], v[72:75]
  ds_read_b128 a[20:23], v11 offset:0
  v_cvt_pk_bf16_f32 v217, v122, v123
  v_mfma_f32_16x16x32_bf16 v[52:55], a[76:79], a[0:3], v[52:55]
  buffer_load_dwordx4 a[112:115], v4, s[60:63], s78 offen offset:0 sc1
  v_cvt_pk_bf16_f32 v218, v124, v125
  v_mfma_f32_16x16x32_bf16 v[16:19], a[64:67], a[0:3], v[16:19]
  ds_read_b128 a[24:27], v11 offset:1024
  v_cvt_pk_bf16_f32 v219, v126, v127
  v_mfma_f32_16x16x32_bf16 v[36:39], a[68:71], a[4:7], v[36:39]
  ds_write_b128 v157, v[216:219] offset:20480
  v_mfma_f32_16x16x32_bf16 v[76:79], a[4:7], a[72:75], v[76:79]
  ds_read_b128 a[28:31], v11 offset:2048
  v_lshlrev_b32 v112, 16, v220
  v_mfma_f32_16x16x32_bf16 v[56:59], a[76:79], a[4:7], v[56:59]
  buffer_load_dwordx4 a[116:119], v4, s[60:63], s78 offen offset:1024 sc1
  v_and_b32 v113, s98, v220
  v_mfma_f32_16x16x32_bf16 v[20:23], a[64:67], a[4:7], v[20:23]
  ds_read_b128 a[32:35], v11 offset:3072
  v_lshlrev_b32 v114, 16, v221
  v_mfma_f32_16x16x32_bf16 v[40:43], a[68:71], a[8:11], v[40:43]
  v_and_b32 v115, s98, v221
  v_lshlrev_b32 v116, 16, v222
  v_mfma_f32_16x16x32_bf16 v[80:83], a[8:11], a[72:75], v[80:83]
  ds_read_b128 a[36:39], v11 offset:4096
  v_and_b32 v117, s98, v222
  v_mfma_f32_16x16x32_bf16 v[60:63], a[76:79], a[8:11], v[60:63]
  buffer_load_dwordx4 a[120:123], v4, s[60:63], s78 offen offset:2048 sc1
  v_lshlrev_b32 v118, 16, v223
  v_mfma_f32_16x16x32_bf16 v[24:27], a[64:67], a[8:11], v[24:27]
  v_and_b32 v119, s98, v223
  v_fma_f32 v112, v112, v148, v150
  v_mfma_f32_16x16x32_bf16 v[44:47], a[68:71], a[12:15], v[44:47]
  buffer_load_dwordx4 a[124:127], v7, s[60:63], s78 offen offset:3072 sc1
  v_fma_f32 v113, v113, v148, v150
  v_mfma_f32_16x16x32_bf16 v[84:87], a[12:15], a[72:75], v[84:87]
  v_fma_f32 v114, v114, v148, v150
  v_fma_f32 v115, v115, v148, v150
  v_mfma_f32_16x16x32_bf16 v[64:67], a[76:79], a[12:15], v[64:67]
  s_add_u32 s78, s78, 3584
  s_cmp_eq_u32 s78, s75
  s_cselect_b32 s78, s74, s78
  v_mfma_f32_16x16x32_bf16 v[28:31], a[64:67], a[12:15], v[28:31]
  v_fma_f32 v116, v116, v148, v150
  v_fma_f32 v117, v117, v148, v150
  v_mfma_f32_16x16x32_bf16 v[48:51], a[68:71], a[16:19], v[48:51]
  v_fma_f32 v118, v118, v148, v150
  v_fma_f32 v119, v119, v148, v150
  v_mfma_f32_16x16x32_bf16 v[88:91], a[16:19], a[72:75], v[88:91]
  v_cvt_pk_bf16_f32 v220, v112, v113
  v_cvt_pk_bf16_f32 v221, v114, v115
  v_mfma_f32_16x16x32_bf16 v[68:71], a[76:79], a[16:19], v[68:71]
  s_waitcnt vmcnt(8) lgkmcnt(0)
  v_cvt_pk_bf16_f32 v222, v116, v117
  v_cvt_pk_bf16_f32 v223, v118, v119
  v_mfma_f32_16x16x32_bf16 v[32:35], a[84:87], a[20:23], v[32:35]
  ds_write_b128 v157, v[220:223] offset:20608
  v_mfma_f32_16x16x32_bf16 v[72:75], a[20:23], a[88:91], v[72:75]
  ds_read_b128 a[0:3], v10 offset:5120
  v_lshlrev_b32 v120, 16, v244
  v_mfma_f32_16x16x32_bf16 v[52:55], a[92:95], a[20:23], v[52:55]
  buffer_load_dwordx4 a[64:67], v4, s[60:63], s78 offen offset:0 sc1
  v_and_b32 v121, s98, v244
  v_mfma_f32_16x16x32_bf16 v[16:19], a[80:83], a[20:23], v[16:19]
  ds_read_b128 a[4:7], v10 offset:6144
  v_lshlrev_b32 v122, 16, v245
  v_mfma_f32_16x16x32_bf16 v[36:39], a[84:87], a[24:27], v[36:39]
  v_and_b32 v123, s98, v245
  v_lshlrev_b32 v124, 16, v246
  v_mfma_f32_16x16x32_bf16 v[76:79], a[24:27], a[88:91], v[76:79]
  ds_read_b128 a[8:11], v10 offset:7168
  v_and_b32 v125, s98, v246
  v_mfma_f32_16x16x32_bf16 v[56:59], a[92:95], a[24:27], v[56:59]
  buffer_load_dwordx4 a[68:71], v4, s[60:63], s78 offen offset:1024 sc1
  v_lshlrev_b32 v126, 16, v247
  v_mfma_f32_16x16x32_bf16 v[20:23], a[80:83], a[24:27], v[20:23]
  ds_read_b128 a[12:15], v10 offset:8192
  v_and_b32 v127, s98, v247
  v_mfma_f32_16x16x32_bf16 v[40:43], a[84:87], a[28:31], v[40:43]
  v_fma_f32 v120, v120, v152, v154
  v_fma_f32 v121, v121, v152, v154
  v_mfma_f32_16x16x32_bf16 v[80:83], a[28:31], a[88:91], v[80:83]
  ds_read_b128 a[16:19], v10 offset:9216
  v_fma_f32 v122, v122, v152, v154
  v_mfma_f32_16x16x32_bf16 v[60:63], a[92:95], a[28:31], v[60:63]
  buffer_load_dwordx4 a[72:75], v4, s[60:63], s78 offen offset:2048 sc1
  v_fma_f32 v123, v123, v152, v154
  v_mfma_f32_16x16x32_bf16 v[24:27], a[80:83], a[28:31], v[24:27]
  v_fma_f32 v124, v124, v152, v154
  v_fma_f32 v125, v125, v152, v154
  v_mfma_f32_16x16x32_bf16 v[44:47], a[84:87], a[32:35], v[44:47]
  buffer_load_dwordx4 a[76:79], v7, s[60:63], s78 offen offset:3072 sc1
  v_fma_f32 v126, v126, v152, v154
  v_mfma_f32_16x16x32_bf16 v[84:87], a[32:35], a[88:91], v[84:87]
  v_fma_f32 v127, v127, v152, v154
  v_cvt_pk_bf16_f32 v244, v120, v121
  v_mfma_f32_16x16x32_bf16 v[64:67], a[92:95], a[32:35], v[64:67]
  s_add_u32 s78, s78, 3584
  s_cmp_eq_u32 s78, s75
  s_cselect_b32 s78, s74, s78
  v_mfma_f32_16x16x32_bf16 v[28:31], a[80:83], a[32:35], v[28:31]
  v_cvt_pk_bf16_f32 v245, v122, v123
  v_cvt_pk_bf16_f32 v246, v124, v125
  v_mfma_f32_16x16x32_bf16 v[48:51], a[84:87], a[36:39], v[48:51]
  v_cvt_pk_bf16_f32 v247, v126, v127
  v_mfma_f32_16x16x32_bf16 v[88:91], a[36:39], a[88:91], v[88:91]
  ds_write_b128 v159, v[244:247] offset:0
  v_mfma_f32_16x16x32_bf16 v[68:71], a[92:95], a[36:39], v[68:71]
  s_waitcnt vmcnt(8) lgkmcnt(1)
  s_lshl_b32 s86, s23, 12
  s_lshl_b32 s87, s22, 2
  s_add_u32 s86, s86, s87
  v_mfma_f32_16x16x32_bf16 v[32:35], a[100:103], a[0:3], v[32:35]
  s_add_u32 s86, s86, 294912
  v_mov_b32 v95, s86
  v_mfma_f32_16x16x32_bf16 v[72:75], a[0:3], a[104:107], v[72:75]
  ds_read_b128 a[20:23], v11 offset:10240
  v_mfma_f32_16x16x32_bf16 v[52:55], a[108:111], a[0:3], v[52:55]
  buffer_load_dwordx4 a[80:83], v4, s[60:63], s78 offen offset:0 sc1
  v_mfma_f32_16x16x32_bf16 v[16:19], a[96:99], a[0:3], v[16:19]
  ds_read_b128 a[24:27], v11 offset:11264
  v_mfma_f32_16x16x32_bf16 v[36:39], a[100:103], a[4:7], v[36:39]
  v_cmp_gt_u32 vcc, 1, v0
  s_nop 1
  v_cndmask_b32 v95, v13, v95, vcc
  v_mfma_f32_16x16x32_bf16 v[76:79], a[4:7], a[104:107], v[76:79]
  ds_read_b128 a[28:31], v11 offset:12288
  v_lshlrev_b32 v112, 16, v224
  v_mfma_f32_16x16x32_bf16 v[56:59], a[108:111], a[4:7], v[56:59]
  buffer_load_dwordx4 a[84:87], v4, s[60:63], s78 offen offset:1024 sc1
  v_and_b32 v113, s98, v224
  v_mfma_f32_16x16x32_bf16 v[20:23], a[96:99], a[4:7], v[20:23]
  ds_read_b128 a[32:35], v11 offset:13312
  v_lshlrev_b32 v114, 16, v225
  v_mfma_f32_16x16x32_bf16 v[40:43], a[100:103], a[8:11], v[40:43]
  v_and_b32 v115, s98, v225
  v_lshlrev_b32 v116, 16, v226
  v_mfma_f32_16x16x32_bf16 v[80:83], a[8:11], a[104:107], v[80:83]
  ds_read_b128 a[36:39], v11 offset:14336
  v_and_b32 v117, s98, v226
  v_mfma_f32_16x16x32_bf16 v[60:63], a[108:111], a[8:11], v[60:63]
  buffer_load_dwordx4 a[88:91], v4, s[60:63], s78 offen offset:2048 sc1
  v_lshlrev_b32 v118, 16, v227
  v_mfma_f32_16x16x32_bf16 v[24:27], a[96:99], a[8:11], v[24:27]
  v_and_b32 v119, s98, v227
  v_fma_f32 v112, v112, v144, v146
  v_mfma_f32_16x16x32_bf16 v[44:47], a[100:103], a[12:15], v[44:47]
  buffer_load_dwordx4 a[92:95], v7, s[60:63], s78 offen offset:3072 sc1
  v_fma_f32 v113, v113, v144, v146
  v_mfma_f32_16x16x32_bf16 v[84:87], a[12:15], a[104:107], v[84:87]
  v_fma_f32 v114, v114, v144, v146
  v_fma_f32 v115, v115, v144, v146
  v_mfma_f32_16x16x32_bf16 v[64:67], a[108:111], a[12:15], v[64:67]
  s_add_u32 s78, s78, 3584
  s_cmp_eq_u32 s78, s75
  s_cselect_b32 s78, s74, s78
  v_mfma_f32_16x16x32_bf16 v[28:31], a[96:99], a[12:15], v[28:31]
  v_fma_f32 v116, v116, v144, v146
  v_fma_f32 v117, v117, v144, v146
  v_mfma_f32_16x16x32_bf16 v[48:51], a[100:103], a[16:19], v[48:51]
  v_fma_f32 v118, v118, v144, v146
  v_fma_f32 v119, v119, v144, v146
  v_mfma_f32_16x16x32_bf16 v[88:91], a[16:19], a[104:107], v[88:91]
  v_cvt_pk_bf16_f32 v224, v112, v113
  v_cvt_pk_bf16_f32 v225, v114, v115
  v_mfma_f32_16x16x32_bf16 v[68:71], a[108:111], a[16:19], v[68:71]
  s_waitcnt vmcnt(8) lgkmcnt(0)
  v_cvt_pk_bf16_f32 v226, v116, v117
  v_cvt_pk_bf16_f32 v227, v118, v119
  v_mfma_f32_16x16x32_bf16 v[32:35], a[116:119], a[20:23], v[32:35]
  s_barrier
  v_mov_b32 v5, s73
  buffer_store_dword v5, v95, s[60:63], 0 offen sc1
  v_mfma_f32_16x16x32_bf16 v[72:75], a[20:23], a[120:123], v[72:75]
  ds_read_b128 a[0:3], v10 offset:15360
  v_mfma_f32_16x16x32_bf16 v[52:55], a[124:127], a[20:23], v[52:55]
  buffer_load_dwordx4 a[96:99], v4, s[60:63], s78 offen offset:0 sc1
  v_mfma_f32_16x16x32_bf16 v[16:19], a[112:115], a[20:23], v[16:19]
  ds_read_b128 a[4:7], v10 offset:16384
  v_mfma_f32_16x16x32_bf16 v[36:39], a[116:119], a[24:27], v[36:39]
  ds_write_b128 v157, v[224:227] offset:30720
  v_mfma_f32_16x16x32_bf16 v[76:79], a[24:27], a[120:123], v[76:79]
  ds_read_b128 a[8:11], v10 offset:17408
  v_lshlrev_b32 v120, 16, v228
  v_mfma_f32_16x16x32_bf16 v[56:59], a[124:127], a[24:27], v[56:59]
  buffer_load_dwordx4 a[100:103], v4, s[60:63], s78 offen offset:1024 sc1
  v_and_b32 v121, s98, v228
  v_mfma_f32_16x16x32_bf16 v[20:23], a[112:115], a[24:27], v[20:23]
  ds_read_b128 a[12:15], v10 offset:18432
  v_lshlrev_b32 v122, 16, v229
  v_mfma_f32_16x16x32_bf16 v[40:43], a[116:119], a[28:31], v[40:43]
  v_and_b32 v123, s98, v229
  v_lshlrev_b32 v124, 16, v230
  v_mfma_f32_16x16x32_bf16 v[80:83], a[28:31], a[120:123], v[80:83]
  ds_read_b128 a[16:19], v10 offset:19456
  v_and_b32 v125, s98, v230
  v_mfma_f32_16x16x32_bf16 v[60:63], a[124:127], a[28:31], v[60:63]
  buffer_load_dwordx4 a[104:107], v4, s[60:63], s78 offen offset:2048 sc1
  v_lshlrev_b32 v126, 16, v231
  v_mfma_f32_16x16x32_bf16 v[24:27], a[112:115], a[28:31], v[24:27]
  v_and_b32 v127, s98, v231
  v_fma_f32 v120, v120, v148, v150
  v_mfma_f32_16x16x32_bf16 v[44:47], a[116:119], a[32:35], v[44:47]
  buffer_load_dwordx4 a[108:111], v7, s[60:63], s78 offen offset:3072 sc1
  v_fma_f32 v121, v121, v148, v150
  v_mfma_f32_16x16x32_bf16 v[84:87], a[32:35], a[120:123], v[84:87]
  v_fma_f32 v122, v122, v148, v150
  v_fma_f32 v123, v123, v148, v150
  v_mfma_f32_16x16x32_bf16 v[64:67], a[124:127], a[32:35], v[64:67]
  s_add_u32 s78, s78, 3584
  s_cmp_eq_u32 s78, s75
  s_cselect_b32 s78, s74, s78
  v_mfma_f32_16x16x32_bf16 v[28:31], a[112:115], a[32:35], v[28:31]
  v_fma_f32 v124, v124, v148, v150
  v_fma_f32 v125, v125, v148, v150
  v_mfma_f32_16x16x32_bf16 v[48:51], a[116:119], a[36:39], v[48:51]
  v_fma_f32 v126, v126, v148, v150
  v_fma_f32 v127, v127, v148, v150
  v_mfma_f32_16x16x32_bf16 v[88:91], a[36:39], a[120:123], v[88:91]
  v_cvt_pk_bf16_f32 v228, v120, v121
  v_cvt_pk_bf16_f32 v229, v122, v123
  v_mfma_f32_16x16x32_bf16 v[68:71], a[124:127], a[36:39], v[68:71]
  s_waitcnt vmcnt(9) lgkmcnt(0)
  v_cvt_pk_bf16_f32 v230, v124, v125
  v_cvt_pk_bf16_f32 v231, v126, v127
  v_mfma_f32_16x16x32_bf16 v[32:35], a[68:71], a[0:3], v[32:35]
  ds_write_b128 v157, v[228:231] offset:30848
  v_mfma_f32_16x16x32_bf16 v[72:75], a[0:3], a[72:75], v[72:75]
  ds_read_b128 a[20:23], v11 offset:20480
  v_lshlrev_b32 v112, 16, v248
  v_mfma_f32_16x16x32_bf16 v[52:55], a[76:79], a[0:3], v[52:55]
  buffer_load_dwordx4 a[112:115], v4, s[60:63], s78 offen offset:0 sc1
  v_and_b32 v113, s98, v248
  v_mfma_f32_16x16x32_bf16 v[16:19], a[64:67], a[0:3], v[16:19]
  ds_read_b128 a[24:27], v11 offset:21504
  v_lshlrev_b32 v114, 16, v249
  v_mfma_f32_16x16x32_bf16 v[36:39], a[68:71], a[4:7], v[36:39]
  v_and_b32 v115, s98, v249
  v_lshlrev_b32 v116, 16, v250
  v_mfma_f32_16x16x32_bf16 v[76:79], a[4:7], a[72:75], v[76:79]
  ds_read_b128 a[28:31], v11 offset:22528
  v_and_b32 v117, s98, v250
  v_mfma_f32_16x16x32_bf16 v[56:59], a[76:79], a[4:7], v[56:59]
  buffer_load_dwordx4 a[116:119], v4, s[60:63], s78 offen offset:1024 sc1
  v_lshlrev_b32 v118, 16, v251
  v_mfma_f32_16x16x32_bf16 v[20:23], a[64:67], a[4:7], v[20:23]
  ds_read_b128 a[32:35], v11 offset:23552
  v_and_b32 v119, s98, v251
  v_mfma_f32_16x16x32_bf16 v[40:43], a[68:71], a[8:11], v[40:43]
  v_fma_f32 v112, v112, v152, v154
  v_fma_f32 v113, v113, v152, v154
  v_mfma_f32_16x16x32_bf16 v[80:83], a[8:11], a[72:75], v[80:83]
  ds_read_b128 a[36:39], v11 offset:24576
  v_fma_f32 v114, v114, v152, v154
  v_mfma_f32_16x16x32_bf16 v[60:63], a[76:79], a[8:11], v[60:63]
  buffer_load_dwordx4 a[120:123], v4, s[60:63], s78 offen offset:2048 sc1
  v_fma_f32 v115, v115, v152, v154
  v_mfma_f32_16x16x32_bf16 v[24:27], a[64:67], a[8:11], v[24:27]
  v_fma_f32 v116, v116, v152, v154
  v_fma_f32 v117, v117, v152, v154
  v_mfma_f32_16x16x32_bf16 v[44:47], a[68:71], a[12:15], v[44:47]
  buffer_load_dwordx4 a[124:127], v7, s[60:63], s78 offen offset:3072 sc1
  v_fma_f32 v118, v118, v152, v154
  v_mfma_f32_16x16x32_bf16 v[84:87], a[12:15], a[72:75], v[84:87]
  v_fma_f32 v119, v119, v152, v154
  v_cvt_pk_bf16_f32 v248, v112, v113
  v_mfma_f32_16x16x32_bf16 v[64:67], a[76:79], a[12:15], v[64:67]
  s_add_u32 s78, s78, 3584
  s_cmp_eq_u32 s78, s75
  s_cselect_b32 s78, s74, s78
  v_mfma_f32_16x16x32_bf16 v[28:31], a[64:67], a[12:15], v[28:31]
  v_cvt_pk_bf16_f32 v249, v114, v115
  v_cvt_pk_bf16_f32 v250, v116, v117
  v_mfma_f32_16x16x32_bf16 v[48:51], a[68:71], a[16:19], v[48:51]
  v_cvt_pk_bf16_f32 v251, v118, v119
  v_mfma_f32_16x16x32_bf16 v[88:91], a[16:19], a[72:75], v[88:91]
  s_mov_b32 exec_lo, 0x00ff00ff
  s_mov_b32 exec_hi, 0x00ff00ff
  ds_write_b128 v159, v[248:251] offset:20480
  s_mov_b64 exec, -1
  v_mfma_f32_16x16x32_bf16 v[68:71], a[76:79], a[16:19], v[68:71]
  s_waitcnt vmcnt(9) lgkmcnt(1)
  s_lshl_b32 s84, s68, 10
  s_add_u32 s84, s84, 143360
  v_mfma_f32_16x16x32_bf16 v[32:35], a[84:87], a[20:23], v[32:35]
  v_lshl_add_u32 v234, v2, 1, s84
  v_add_u32 v235, 512, v234
  v_mfma_f32_16x16x32_bf16 v[72:75], a[20:23], a[88:91], v[72:75]
  ds_read_b128 a[0:3], v10 offset:25600
  v_mfma_f32_16x16x32_bf16 v[52:55], a[92:95], a[20:23], v[52:55]
  buffer_load_dwordx4 a[64:67], v4, s[60:63], s78 offen offset:0 sc1
  v_mfma_f32_16x16x32_bf16 v[16:19], a[80:83], a[20:23], v[16:19]
  ds_read_b128 a[4:7], v10 offset:26624
  v_mfma_f32_16x16x32_bf16 v[36:39], a[84:87], a[24:27], v[36:39]
  v_cmp_eq_u32 vcc, 1, v3
  s_nop 1
  v_cndmask_b32 v234, v235, v234, vcc
  v_mfma_f32_16x16x32_bf16 v[76:79], a[24:27], a[88:91], v[76:79]
  ds_read_b128 a[8:11], v10 offset:27648
  v_lshl_add_u32 v235, v1, 2, s84
  v_mfma_f32_16x16x32_bf16 v[56:59], a[92:95], a[24:27], v[56:59]
  buffer_load_dwordx4 a[68:71], v4, s[60:63], s78 offen offset:1024 sc1
  v_min_u32 v236, 2, v2
  v_mfma_f32_16x16x32_bf16 v[20:23], a[80:83], a[24:27], v[20:23]
  ds_read_b128 a[12:15], v10 offset:28672
  v_mul_u32_u24 v236, 160, v236
  v_mfma_f32_16x16x32_bf16 v[40:43], a[84:87], a[28:31], v[40:43]
  v_lshl_add_u32 v236, v3, 3, v236
  v_add_u32 v236, s84, v236
  v_mfma_f32_16x16x32_bf16 v[80:83], a[28:31], a[88:91], v[80:83]
  ds_read_b128 a[16:19], v10 offset:29696
  v_mov_b32 v237, s99
  v_mfma_f32_16x16x32_bf16 v[60:63], a[92:95], a[28:31], v[60:63]
  buffer_load_dwordx4 a[72:75], v4, s[60:63], s78 offen offset:2048 sc1
  s_mul_i32 s84, s22, 73728
  v_mfma_f32_16x16x32_bf16 v[24:27], a[80:83], a[28:31], v[24:27]
  s_add_u32 s84, s84, 4194304
  s_lshl_b32 s85, s23, 1
  s_lshr_b32 s86, s68, 1
  v_mfma_f32_16x16x32_bf16 v[44:47], a[84:87], a[32:35], v[44:47]
  buffer_load_dwordx4 a[76:79], v7, s[60:63], s78 offen offset:3072 sc1
  s_add_u32 s85, s85, s86
  v_mfma_f32_16x16x32_bf16 v[84:87], a[32:35], a[88:91], v[84:87]
  s_lshl_b32 s85, s85, 12
  s_and_b32 s86, s68, 1
  s_lshl_b32 s86, s86, 9
  v_mfma_f32_16x16x32_bf16 v[64:67], a[92:95], a[32:35], v[64:67]
  s_add_u32 s78, s78, 3584
  s_cmp_eq_u32 s78, s75
  s_cselect_b32 s78, s74, s78
  v_mfma_f32_16x16x32_bf16 v[28:31], a[80:83], a[32:35], v[28:31]
  s_add_u32 s85, s85, s86
  s_add_u32 s95, s85, s84
  s_lshl_b32 s87, s23, 2
  v_mfma_f32_16x16x32_bf16 v[48:51], a[84:87], a[36:39], v[48:51]
  s_add_u32 s87, s87, s68
  s_lshl_b32 s87, s87, 8
  s_add_u32 s87, s87, 65536
  v_mfma_f32_16x16x32_bf16 v[88:91], a[36:39], a[88:91], v[88:91]
  s_add_u32 s96, s87, s84
  v_and_b32 v232, 1, v3
  v_mfma_f32_16x16x32_bf16 v[68:71], a[92:95], a[36:39], v[68:71]
  s_waitcnt vmcnt(8) lgkmcnt(0)
  v_lshlrev_b32 v232, 10, v232
  v_lshrrev_b32 v233, 1, v3
  v_mfma_f32_16x16x32_bf16 v[32:35], a[100:103], a[0:3], v[32:35]
  v_lshl_add_u32 v232, v233, 8, v232
  v_lshl_add_u32 v232, v2, 4, v232
  v_mfma_f32_16x16x32_bf16 v[72:75], a[0:3], a[104:107], v[72:75]
  ds_read_b128 a[20:23], v11 offset:30720
  v_lshlrev_b32 v233, 2, v1
  v_mfma_f32_16x16x32_bf16 v[52:55], a[108:111], a[0:3], v[52:55]
  buffer_load_dwordx4 a[80:83], v4, s[60:63], s78 offen offset:0 sc1
  s_mul_i32 s79, s70, 82944
  v_mfma_f32_16x16x32_bf16 v[16:19], a[96:99], a[0:3], v[16:19]
  ds_read_b128 a[24:27], v11 offset:31744
  s_add_u32 s79, s79, 3145728
  v_mfma_f32_16x16x32_bf16 v[36:39], a[100:103], a[4:7], v[36:39]
  s_lshl_b32 s84, s68, 1
  s_add_u32 s85, s84, s3
  s_and_b32 s86, s85, 7
  v_mfma_f32_16x16x32_bf16 v[76:79], a[4:7], a[104:107], v[76:79]
  ds_read_b128 a[28:31], v11 offset:32768
  s_mul_i32 s86, s86, 9216
  v_mfma_f32_16x16x32_bf16 v[56:59], a[108:111], a[4:7], v[56:59]
  buffer_load_dwordx4 a[84:87], v4, s[60:63], s78 offen offset:1024 sc1
  s_add_u32 s80, s86, s79
  v_mfma_f32_16x16x32_bf16 v[20:23], a[96:99], a[4:7], v[20:23]
  ds_read_b128 a[32:35], v11 offset:33792
  s_add_u32 s85, s85, 1
  v_mfma_f32_16x16x32_bf16 v[40:43], a[100:103], a[8:11], v[40:43]
  s_and_b32 s86, s85, 7
  s_mul_i32 s86, s86, 9216
  s_add_u32 s81, s86, s79
  v_mfma_f32_16x16x32_bf16 v[80:83], a[8:11], a[104:107], v[80:83]
  ds_read_b128 a[36:39], v11 offset:34816
  s_lshl_b32 s84, s84, 10
  v_mfma_f32_16x16x32_bf16 v[60:63], a[108:111], a[8:11], v[60:63]
  buffer_load_dwordx4 a[88:91], v4, s[60:63], s78 offen offset:2048 sc1
  s_add_u32 s84, s84, 73728
  v_mfma_f32_16x16x32_bf16 v[24:27], a[96:99], a[8:11], v[24:27]
  s_add_u32 s82, s84, s79
  s_mov_b32 s83, s84
  s_mul_i32 s76, s68, 18432
  v_mfma_f32_16x16x32_bf16 v[44:47], a[100:103], a[12:15], v[44:47]
  buffer_load_dwordx4 a[92:95], v7, s[60:63], s78 offen offset:3072 sc1
  s_lshl_b32 s84, s69, 6
  v_mfma_f32_16x16x32_bf16 v[84:87], a[12:15], a[104:107], v[84:87]
  s_and_b32 s85, s68, 1
  s_lshl_b32 s85, s85, 5
  s_add_u32 s85, s85, s84
  v_mfma_f32_16x16x32_bf16 v[64:67], a[108:111], a[12:15], v[64:67]
  s_lshr_b32 s86, s68, 1
  s_add_u32 s85, s85, s86
  s_mul_i32 s85, s85, 1152
  v_mfma_f32_16x16x32_bf16 v[28:31], a[96:99], a[12:15], v[28:31]
  s_mul_i32 s86, s70, 144
  s_add_u32 s79, s85, s86
  v_mfma_f32_16x16x32_bf16 v[48:51], a[100:103], a[16:19], v[48:51]
  v_mul_u32_u24 v238, 7282, v1
  v_lshrrev_b32 v238, 16, v238
  v_mfma_f32_16x16x32_bf16 v[88:91], a[16:19], a[104:107], v[88:91]
  v_mul_u32_u24 v239, 9, v238
  v_sub_u32 v239, v1, v239
  v_mfma_f32_16x16x32_bf16 v[68:71], a[108:111], a[16:19], v[68:71]
  s_waitcnt vmcnt(8) lgkmcnt(0)
  v_mul_u32_u24 v238, 2304, v238
  v_lshl_add_u32 v238, v239, 4, v238
  v_mfma_f32_16x16x32_bf16 v[32:35], a[116:119], a[20:23], v[32:35]
  s_barrier
  v_mfma_f32_16x16x32_bf16 v[72:75], a[20:23], a[120:123], v[72:75]
  ds_read_b128 a[0:3], v10 offset:35840
  v_mfma_f32_16x16x32_bf16 v[52:55], a[124:127], a[20:23], v[52:55]
  v_cmp_gt_u32 vcc, 54, v1
  s_nop 1
  v_cndmask_b32 v238, v13, v238, vcc
  v_mfma_f32_16x16x32_bf16 v[16:19], a[112:115], a[20:23], v[16:19]
  ds_read_b128 a[4:7], v10 offset:36864
  s_mul_i32 s77, s68, 3072
  v_mfma_f32_16x16x32_bf16 v[36:39], a[116:119], a[24:27], v[36:39]
  s_add_u32 s77, s77, 131072
  s_mov_b32 s94, 0x3eae1a93
  s_lshl_b32 s86, s72, 12
  v_mfma_f32_16x16x32_bf16 v[76:79], a[24:27], a[120:123], v[76:79]
  ds_read_b128 a[8:11], v10 offset:37888
  s_add_u32 s86, s86, 294912
  v_mfma_f32_16x16x32_bf16 v[56:59], a[124:127], a[24:27], v[56:59]
  v_and_b32 v15, 31, v1
  v_lshl_add_u32 v15, v15, 2, s86
  v_mfma_f32_16x16x32_bf16 v[20:23], a[112:115], a[24:27], v[20:23]
  ds_read_b128 a[12:15], v10 offset:38912
  v_mov_b32 v131, 0
  v_mfma_f32_16x16x32_bf16 v[40:43], a[116:119], a[28:31], v[40:43]
  v_mov_b32 v135, 0
  v_mov_b32 v139, 0
  v_mfma_f32_16x16x32_bf16 v[80:83], a[28:31], a[120:123], v[80:83]
  ds_read_b128 a[16:19], v10 offset:39936
  v_mov_b32 v143, 0
  v_mfma_f32_16x16x32_bf16 v[60:63], a[124:127], a[28:31], v[60:63]
  v_mov_b32 v147, 0
  v_mov_b32 v115, 0
  v_mfma_f32_16x16x32_bf16 v[24:27], a[112:115], a[28:31], v[24:27]
  v_mov_b32 v119, 0
  v_mov_b32 v123, 0
  v_mfma_f32_16x16x32_bf16 v[44:47], a[116:119], a[32:35], v[44:47]
  v_mov_b32 v127, 0
  v_mfma_f32_16x16x32_bf16 v[84:87], a[32:35], a[120:123], v[84:87]
  s_add_u32 s84, s76, 0
  s_mov_b32 m0, s84
  s_nop 0
  buffer_load_dwordx4 v4, s[60:63], s80 offen offset:0 sc1 lds
  v_mfma_f32_16x16x32_bf16 v[64:67], a[124:127], a[32:35], v[64:67]
  buffer_load_dwordx4 v4, s[60:63], s80 offen offset:1024 sc1 lds
  buffer_load_dwordx4 v4, s[60:63], s80 offen offset:2048 sc1 lds
  v_mfma_f32_16x16x32_bf16 v[28:31], a[112:115], a[32:35], v[28:31]
  buffer_load_dwordx4 v4, s[60:63], s80 offen offset:3072 sc1 lds
  v_mfma_f32_16x16x32_bf16 v[48:51], a[116:119], a[36:39], v[48:51]
  s_add_u32 s84, s76, 4096
  s_mov_b32 m0, s84
  s_add_u32 s80, s80, 4096
  buffer_load_dwordx4 v4, s[60:63], s80 offen offset:0 sc1 lds
  v_mfma_f32_16x16x32_bf16 v[88:91], a[36:39], a[120:123], v[88:91]
  buffer_load_dwordx4 v4, s[60:63], s80 offen offset:1024 sc1 lds
  buffer_load_dwordx4 v4, s[60:63], s80 offen offset:2048 sc1 lds
  v_mfma_f32_16x16x32_bf16 v[68:71], a[124:127], a[36:39], v[68:71]
  s_waitcnt vmcnt(11) lgkmcnt(0)
  buffer_load_dwordx4 v4, s[60:63], s80 offen offset:3072 sc1 lds
  v_mfma_f32_16x16x32_bf16 v[32:35], a[68:71], a[0:3], v[32:35]
  v_mfma_f32_16x16x32_bf16 v[72:75], a[0:3], a[72:75], v[72:75]
  ds_read_b128 a[20:23], v11 offset:40960
  v_mfma_f32_16x16x32_bf16 v[52:55], a[76:79], a[0:3], v[52:55]
  s_add_u32 s84, s76, 8192
  s_mov_b32 m0, s84
  s_add_u32 s80, s80, 4096
  buffer_load_dwordx4 v4, s[60:63], s80 offen offset:0 sc1 lds
  v_mfma_f32_16x16x32_bf16 v[16:19], a[64:67], a[0:3], v[16:19]
  ds_read_b128 a[24:27], v11 offset:41984
  v_mfma_f32_16x16x32_bf16 v[36:39], a[68:71], a[4:7], v[36:39]
  v_mfma_f32_16x16x32_bf16 v[76:79], a[4:7], a[72:75], v[76:79]
  ds_read_b128 a[28:31], v11 offset:43008
  v_mfma_f32_16x16x32_bf16 v[56:59], a[76:79], a[4:7], v[56:59]
  v_mfma_f32_16x16x32_bf16 v[20:23], a[64:67], a[4:7], v[20:23]
  ds_read_b128 a[32:35], v11 offset:44032
  v_mfma_f32_16x16x32_bf16 v[40:43], a[68:71], a[8:11], v[40:43]
  s_add_u32 s84, s76, 9216
  s_mov_b32 m0, s84
  s_nop 0
  buffer_load_dwordx4 v4, s[60:63], s81 offen offset:0 sc1 lds
  v_mfma_f32_16x16x32_bf16 v[80:83], a[8:11], a[72:75], v[80:83]
  ds_read_b128 a[36:39], v11 offset:45056
  v_mfma_f32_16x16x32_bf16 v[60:63], a[76:79], a[8:11], v[60:63]
  v_mfma_f32_16x16x32_bf16 v[24:27], a[64:67], a[8:11], v[24:27]
  v_mfma_f32_16x16x32_bf16 v[44:47], a[68:71], a[12:15], v[44:47]
  buffer_load_dwordx4 v4, s[60:63], s81 offen offset:1024 sc1 lds
  v_mfma_f32_16x16x32_bf16 v[84:87], a[12:15], a[72:75], v[84:87]
  v_mfma_f32_16x16x32_bf16 v[64:67], a[76:79], a[12:15], v[64:67]
  v_mfma_f32_16x16x32_bf16 v[28:31], a[64:67], a[12:15], v[28:31]
  v_mfma_f32_16x16x32_bf16 v[48:51], a[68:71], a[16:19], v[48:51]
  v_mfma_f32_16x16x32_bf16 v[88:91], a[16:19], a[72:75], v[88:91]
  buffer_load_dwordx4 v4, s[60:63], s81 offen offset:2048 sc1 lds
  v_mfma_f32_16x16x32_bf16 v[68:71], a[76:79], a[16:19], v[68:71]
  s_waitcnt vmcnt(12) lgkmcnt(0)
  v_mfma_f32_16x16x32_bf16 v[32:35], a[84:87], a[20:23], v[32:35]
  v_mfma_f32_16x16x32_bf16 v[72:75], a[20:23], a[88:91], v[72:75]
  v_mfma_f32_16x16x32_bf16 v[52:55], a[92:95], a[20:23], v[52:55]
  v_mfma_f32_16x16x32_bf16 v[16:19], a[80:83], a[20:23], v[16:19]
  buffer_load_dwordx4 v4, s[60:63], s81 offen offset:3072 sc1 lds
  v_mfma_f32_16x16x32_bf16 v[36:39], a[84:87], a[24:27], v[36:39]
  v_mfma_f32_16x16x32_bf16 v[76:79], a[24:27], a[88:91], v[76:79]
  v_mfma_f32_16x16x32_bf16 v[56:59], a[92:95], a[24:27], v[56:59]
  v_mfma_f32_16x16x32_bf16 v[20:23], a[80:83], a[24:27], v[20:23]
  v_mfma_f32_16x16x32_bf16 v[40:43], a[84:87], a[28:31], v[40:43]
  v_mfma_f32_16x16x32_bf16 v[80:83], a[28:31], a[88:91], v[80:83]
  v_mfma_f32_16x16x32_bf16 v[60:63], a[92:95], a[28:31], v[60:63]
  v_mfma_f32_16x16x32_bf16 v[24:27], a[80:83], a[28:31], v[24:27]
  v_mfma_f32_16x16x32_bf16 v[44:47], a[84:87], a[32:35], v[44:47]
  v_mfma_f32_16x16x32_bf16 v[84:87], a[32:35], a[88:91], v[84:87]
  v_mfma_f32_16x16x32_bf16 v[64:67], a[92:95], a[32:35], v[64:67]
  v_mfma_f32_16x16x32_bf16 v[28:31], a[80:83], a[32:35], v[28:31]
  v_mfma_f32_16x16x32_bf16 v[48:51], a[84:87], a[36:39], v[48:51]
  v_mfma_f32_16x16x32_bf16 v[88:91], a[36:39], a[88:91], v[88:91]
  v_mfma_f32_16x16x32_bf16 v[68:71], a[92:95], a[36:39], v[68:71]
  s_barrier
  s_mov_b32 exec_hi, 0xffff
  ds_write_b32 v235, v237 offset:320
  s_mov_b32 exec_hi, -1
  v_cvt_pk_bf16_f32 v114, v52, v53
  s_add_u32 s84, s76, 13312
  s_mov_b32 m0, s84
  s_add_u32 s81, s81, 4096
  buffer_load_dwordx4 v4, s[60:63], s81 offen offset:0 sc1 lds
  ds_write_b16 v234, v114 offset:0
  ds_write_b16_d16_hi v234, v114 offset:160
  v_cvt_pk_bf16_f32 v118, v56, v57
  ds_write_b16 v234, v118 offset:32
  ds_write_b16_d16_hi v234, v118 offset:192
  v_cvt_pk_bf16_f32 v122, v60, v61
  ds_write_b16 v234, v122 offset:64
  ds_write_b16_d16_hi v234, v122 offset:224
  v_cvt_pk_bf16_f32 v126, v64, v65
  buffer_load_dwordx4 v4, s[60:63], s81 offen offset:1024 sc1 lds
  ds_write_b16 v234, v126 offset:96
  ds_write_b16_d16_hi v234, v126 offset:256
  v_cvt_pk_bf16_f32 v172, v68, v69
  ds_write_b16 v234, v172 offset:128
  ds_write_b16_d16_hi v234, v172 offset:288
  v_cvt_pk_bf16_f32 v144, v48, v49
  v_cvt_pk_bf16_f32 v145, v50, v51
  v_cvt_pk_bf16_f32 v146, v70, v71
  v_cvt_pk_bf16_f32 v112, v16, v17
  buffer_load_dwordx4 v4, s[60:63], s81 offen offset:2048 sc1 lds
  v_cvt_pk_bf16_f32 v113, v18, v19
  v_cvt_pk_bf16_f32 v128, v32, v33
  v_cvt_pk_bf16_f32 v129, v34, v35
  v_cvt_pk_bf16_f32 v130, v54, v55
  v_mfma_f32_16x16x32_bf16 v[176:179], v[144:147], v[112:115], v[104:107]
  v_cvt_pk_bf16_f32 v116, v20, v21
  v_cvt_pk_bf16_f32 v117, v22, v23
  v_cvt_pk_bf16_f32 v132, v36, v37
  v_cvt_pk_bf16_f32 v133, v38, v39
  buffer_load_dwordx4 v4, s[60:63], s81 offen offset:3072 sc1 lds
  v_cvt_pk_bf16_f32 v134, v58, v59
  v_mfma_f32_16x16x32_bf16 v[180:183], v[128:131], v[112:115], v[96:99]
  v_mfma_f32_16x16x32_bf16 v[184:187], v[128:131], v[116:119], v[100:103]
  v_cvt_pk_bf16_f32 v120, v24, v25
  v_cvt_pk_bf16_f32 v121, v26, v27
  v_cvt_pk_bf16_f32 v136, v40, v41
  v_cvt_pk_bf16_f32 v137, v42, v43
  v_cvt_pk_bf16_f32 v138, v62, v63
  v_mfma_f32_16x16x32_bf16 v[188:191], v[132:135], v[116:119], v[96:99]
  s_add_u32 s84, s76, 17408
  s_mov_b32 m0, s84
  s_add_u32 s81, s81, 4096
  buffer_load_dwordx4 v4, s[60:63], s81 offen offset:0 sc1 lds
  v_mfma_f32_16x16x32_bf16 v[192:195], v[144:147], v[120:123], v[108:111]
  v_cvt_pk_bf16_f32 v124, v28, v29
  v_cvt_pk_bf16_f32 v125, v30, v31
  v_cvt_pk_bf16_f32 v140, v44, v45
  v_cvt_pk_bf16_f32 v141, v46, v47
  v_cvt_pk_bf16_f32 v142, v66, v67
  v_mfma_f32_16x16x32_bf16 v[196:199], v[136:139], v[120:123], v[96:99]
  v_mfma_f32_16x16x32_bf16 v[200:203], v[136:139], v[124:127], v[100:103]
  v_cvt_pk_bf16_f32 v148, v88, v89
  s_mov_b32 m0, s83
  s_nop 0
  buffer_load_dwordx4 v4, s[60:63], s82 offen offset:0 sc1 lds
  v_cvt_pk_bf16_f32 v149, v90, v91
  v_mfma_f32_16x16x32_bf16 v[204:207], v[140:143], v[124:127], v[96:99]
  v_cvt_pk_bf16_f32 v150, v72, v73
  v_cvt_pk_bf16_f32 v151, v74, v75
  v_cvt_pk_bf16_f32 v152, v76, v77
  v_cvt_pk_bf16_f32 v153, v78, v79
  v_cvt_pk_bf16_f32 v154, v88, v89
  v_cvt_pk_bf16_f32 v155, v90, v91
  v_cvt_pk_bf16_f32 v156, v80, v81
  buffer_load_dwordx4 v4, s[60:63], s82 offen offset:1024 sc1 lds
  v_cvt_pk_bf16_f32 v157, v82, v83
  v_cvt_pk_bf16_f32 v158, v84, v85
  v_cvt_pk_bf16_f32 v159, v86, v87
  s_waitcnt lgkmcnt(0)
  ds_read_b64 v[160:161], v236 offset:128
  ds_read_b64 v[162:163], v236 offset:0
  ds_read_b64 v[164:165], v236 offset:32
  ds_read_b64 v[166:167], v236 offset:128
  ds_read_b64 v[168:169], v236 offset:64
  buffer_load_dwordx4 v4, s[60:63], s82 offen offset:2048 sc1 lds
  ds_read_b64 v[170:171], v236 offset:96
  v_max3_f32 v208, v176, v177, v178
  v_max3_f32 v212, v179, v180, v181
  v_max3_f32 v209, v184, v185, v186
  v_max3_f32 v213, v187, v188, v189
  v_max3_f32 v210, v192, v193, v194
  v_max3_f32 v214, v195, v196, v197
  v_max3_f32 v211, v200, v201, v202
  v_max3_f32 v215, v203, v204, v205
  s_mov_b32 m0, s77
  s_nop 0
  buffer_load_dwordx4 v238, s[28:31], s79 offen offset:0 lds
  v_max3_f32 v208, v208, v182, v183
  v_max3_f32 v209, v209, v190, v191
  v_max3_f32 v210, v210, v198, v199
  v_max3_f32 v211, v211, v206, v207
  v_max_f32 v208, v208, v212
  v_max_f32 v209, v209, v213
  v_max_f32 v210, v210, v214
  v_max_f32 v211, v211, v215
  v_permlane16_swap_b32 v208, v209
  s_add_u32 s79, s79, 12800
  buffer_load_dwordx4 v238, s[28:31], s79 offen offset:1024 lds
  v_permlane16_swap_b32 v210, v211
  v_max_f32 v208, v208, v209
  v_max_f32 v210, v210, v211
  s_nop 1
  v_permlane32_swap_b32 v208, v210
  v_max_f32 v208, v208, v210
  v_mul_f32 v208, s94, v208
  v_mov_b32 v210, v208
  s_nop 1
  v_permlane32_swap_b32 v208, v210
  v_mov_b32 v209, v208
  s_add_u32 s79, s79, 12800
  buffer_load_dwordx4 v238, s[28:31], s79 offen offset:2048 lds
  v_mov_b32 v211, v210
  v_permlane16_swap_b32 v208, v209
  s_nop 0
  v_permlane16_swap_b32 v210, v211
  v_pk_fma_f32 v[176:177], v[176:177], s[94:95], v[208:209] op_sel:[0,0,0] op_sel_hi:[1,0,0] neg_lo:[0,0,1] neg_hi:[0,0,1]
  v_pk_fma_f32 v[178:179], v[178:179], s[94:95], v[208:209] op_sel:[0,0,0] op_sel_hi:[1,0,0] neg_lo:[0,0,1] neg_hi:[0,0,1]
  v_pk_fma_f32 v[180:181], v[180:181], s[94:95], v[208:209] op_sel:[0,0,0] op_sel_hi:[1,0,0] neg_lo:[0,0,1] neg_hi:[0,0,1]
  v_pk_fma_f32 v[182:183], v[182:183], s[94:95], v[208:209] op_sel:[0,0,0] op_sel_hi:[1,0,0] neg_lo:[0,0,1] neg_hi:[0,0,1]
  v_exp_f32 v176, v176
  v_exp_f32 v177, v177
  buffer_load_dword v14, v15, s[60:63], 0 offen sc1
  v_exp_f32 v178, v178
  v_exp_f32 v179, v179
  v_exp_f32 v180, v180
  v_exp_f32 v181, v181
  v_exp_f32 v182, v182
  v_exp_f32 v183, v183
  v_cvt_pk_bf16_f32 v216, v176, v177
  v_cvt_pk_bf16_f32 v217, v178, v179
  v_cvt_pk_bf16_f32 v218, v180, v181
  v_cvt_pk_bf16_f32 v219, v182, v183
  v_pk_fma_f32 v[184:185], v[184:185], s[94:95], v[208:209] op_sel:[0,0,1] op_sel_hi:[1,0,1] neg_lo:[0,0,1] neg_hi:[0,0,1]
  v_pk_fma_f32 v[186:187], v[186:187], s[94:95], v[208:209] op_sel:[0,0,1] op_sel_hi:[1,0,1] neg_lo:[0,0,1] neg_hi:[0,0,1]
  v_pk_fma_f32 v[188:189], v[188:189], s[94:95], v[208:209] op_sel:[0,0,1] op_sel_hi:[1,0,1] neg_lo:[0,0,1] neg_hi:[0,0,1]
  v_pk_fma_f32 v[190:191], v[190:191], s[94:95], v[208:209] op_sel:[0,0,1] op_sel_hi:[1,0,1] neg_lo:[0,0,1] neg_hi:[0,0,1]
  s_waitcnt lgkmcnt(4)
  v_mfma_f32_16x16x32_bf16 v[32:35], v[160:163], v[216:219], 0
  v_mfma_f32_16x16x32_bf16 v[16:19], v[148:151], v[216:219], 0
  v_exp_f32 v184, v184
  v_exp_f32 v185, v185
  v_exp_f32 v186, v186
  v_exp_f32 v187, v187
  v_exp_f32 v188, v188
  v_exp_f32 v189, v189
  v_exp_f32 v190, v190
  v_exp_f32 v191, v191
  v_cvt_pk_bf16_f32 v220, v184, v185
  v_cvt_pk_bf16_f32 v221, v186, v187
  v_cvt_pk_bf16_f32 v222, v188, v189
  v_cvt_pk_bf16_f32 v223, v190, v191
  v_pk_fma_f32 v[192:193], v[192:193], s[94:95], v[210:211] op_sel:[0,0,0] op_sel_hi:[1,0,0] neg_lo:[0,0,1] neg_hi:[0,0,1]
  v_pk_fma_f32 v[194:195], v[194:195], s[94:95], v[210:211] op_sel:[0,0,0] op_sel_hi:[1,0,0] neg_lo:[0,0,1] neg_hi:[0,0,1]
  v_pk_fma_f32 v[196:197], v[196:197], s[94:95], v[210:211] op_sel:[0,0,0] op_sel_hi:[1,0,0] neg_lo:[0,0,1] neg_hi:[0,0,1]
  v_pk_fma_f32 v[198:199], v[198:199], s[94:95], v[210:211] op_sel:[0,0,0] op_sel_hi:[1,0,0] neg_lo:[0,0,1] neg_hi:[0,0,1]
  s_waitcnt lgkmcnt(3)
  v_mfma_f32_16x16x32_bf16 v[36:39], v[162:165], v[220:223], 0
  v_mfma_f32_16x16x32_bf16 v[20:23], v[150:153], v[220:223], 0
  v_exp_f32 v192, v192
  v_exp_f32 v193, v193
  v_exp_f32 v194, v194
  v_exp_f32 v195, v195
  v_exp_f32 v196, v196
  v_exp_f32 v197, v197
  v_exp_f32 v198, v198
  v_exp_f32 v199, v199
  v_cvt_pk_bf16_f32 v224, v192, v193
  v_cvt_pk_bf16_f32 v225, v194, v195
  v_cvt_pk_bf16_f32 v226, v196, v197
  v_cvt_pk_bf16_f32 v227, v198, v199
  v_pk_fma_f32 v[200:201], v[200:201], s[94:95], v[210:211] op_sel:[0,0,1] op_sel_hi:[1,0,1] neg_lo:[0,0,1] neg_hi:[0,0,1]
  v_pk_fma_f32 v[202:203], v[202:203], s[94:95], v[210:211] op_sel:[0,0,1] op_sel_hi:[1,0,1] neg_lo:[0,0,1] neg_hi:[0,0,1]
  v_pk_fma_f32 v[204:205], v[204:205], s[94:95], v[210:211] op_sel:[0,0,1] op_sel_hi:[1,0,1] neg_lo:[0,0,1] neg_hi:[0,0,1]
  v_pk_fma_f32 v[206:207], v[206:207], s[94:95], v[210:211] op_sel:[0,0,1] op_sel_hi:[1,0,1] neg_lo:[0,0,1] neg_hi:[0,0,1]
  s_waitcnt lgkmcnt(1)
  v_mfma_f32_16x16x32_bf16 v[40:43], v[166:169], v[224:227], 0
  v_mfma_f32_16x16x32_bf16 v[24:27], v[154:157], v[224:227], 0
  v_exp_f32 v200, v200
  v_exp_f32 v201, v201
  v_exp_f32 v202, v202
  v_exp_f32 v203, v203
  v_exp_f32 v204, v204
  v_exp_f32 v205, v205
  v_exp_f32 v206, v206
  v_exp_f32 v207, v207
  v_cvt_pk_bf16_f32 v228, v200, v201
  v_cvt_pk_bf16_f32 v229, v202, v203
  v_cvt_pk_bf16_f32 v230, v204, v205
  v_cvt_pk_bf16_f32 v231, v206, v207
  v_rcp_f32 v208, v34
  v_rcp_f32 v209, v38
  s_waitcnt lgkmcnt(0)
  v_mfma_f32_16x16x32_bf16 v[44:47], v[168:171], v[228:231], 0
  v_mfma_f32_16x16x32_bf16 v[28:31], v[156:159], v[228:231], 0
  v_pk_mul_f32 v[16:17], v[16:17], v[208:209] op_sel:[0,0] op_sel_hi:[1,0]
  v_pk_mul_f32 v[18:19], v[18:19], v[208:209] op_sel:[0,0] op_sel_hi:[1,0]
  v_cvt_pk_bf16_f32 v112, v16, v17
  v_cvt_pk_bf16_f32 v113, v18, v19
  v_pk_mul_f32 v[20:21], v[20:21], v[208:209] op_sel:[0,1] op_sel_hi:[1,1]
  v_pk_mul_f32 v[22:23], v[22:23], v[208:209] op_sel:[0,1] op_sel_hi:[1,1]
  v_cvt_pk_bf16_f32 v114, v20, v21
  v_cvt_pk_bf16_f32 v115, v22, v23
  v_pk_mul_f32 v[32:33], v[32:33], v[208:209] op_sel:[0,0] op_sel_hi:[1,0]
  v_pk_mul_f32 v[36:37], v[36:37], v[208:209] op_sel:[0,1] op_sel_hi:[1,1]
  v_permlane16_swap_b32 v112, v114
  v_permlane16_swap_b32 v113, v115
  buffer_store_dwordx4 v[112:115], v232, s[60:63], s95 offen offset:0 sc1
  v_cvt_pk_bf16_f32 v120, v32, v33
  v_cvt_pk_bf16_f32 v121, v36, v37
  v_rcp_f32 v210, v42
  v_rcp_f32 v211, v46
  s_nop 0
  v_pk_mul_f32 v[24:25], v[24:25], v[210:211] op_sel:[0,0] op_sel_hi:[1,0]
  v_pk_mul_f32 v[26:27], v[26:27], v[210:211] op_sel:[0,0] op_sel_hi:[1,0]
  v_cvt_pk_bf16_f32 v116, v24, v25
  v_cvt_pk_bf16_f32 v117, v26, v27
  v_pk_mul_f32 v[28:29], v[28:29], v[210:211] op_sel:[0,1] op_sel_hi:[1,1]
  v_pk_mul_f32 v[30:31], v[30:31], v[210:211] op_sel:[0,1] op_sel_hi:[1,1]
  v_cvt_pk_bf16_f32 v118, v28, v29
  v_cvt_pk_bf16_f32 v119, v30, v31
  v_pk_mul_f32 v[40:41], v[40:41], v[210:211] op_sel:[0,0] op_sel_hi:[1,0]
  v_pk_mul_f32 v[44:45], v[44:45], v[210:211] op_sel:[0,1] op_sel_hi:[1,1]
  v_permlane16_swap_b32 v116, v118
  v_permlane16_swap_b32 v117, v119
  buffer_store_dwordx4 v[116:119], v232, s[60:63], s95 offen offset:2048 sc1
  v_cvt_pk_bf16_f32 v122, v40, v41
  v_cvt_pk_bf16_f32 v123, v44, v45
  v_permlane16_swap_b32 v120, v121
  s_nop 0
  v_permlane16_swap_b32 v122, v123
  s_nop 1
  v_permlane32_swap_b32 v120, v122
  buffer_store_dword v120, v233, s[60:63], s96 offen sc1
  s_lshl_b32 s88, s72, 2
  s_add_u32 s88, s88, s68
  s_mul_i32 s88, s88, 165888
  s_add_u32 s89, s88, 16777216
  s_add_u32 s88, s88, 10485760
  s_mul_i32 s92, s1, 9216
  s_add_u32 s92, s92, s88
  s_mov_b32 s90, s88
  s_add_u32 s91, s88, 165888
  v_add_u32 v12, 4096, v4
  v_add_u32 v255, 8192, v4
  s_waitcnt vmcnt(3)
  v_cmp_ne_u32 vcc, s73, v14
  s_cbranch_vccnz L_slow1
L_back1:
  buffer_load_dwordx4 a[0:3], v4, s[60:63], s92 offen offset:0 sc1
  buffer_load_dwordx4 a[4:7], v4, s[60:63], s92 offen offset:1024 sc1
  buffer_load_dwordx4 a[8:11], v4, s[60:63], s92 offen offset:2048 sc1
  buffer_load_dwordx4 a[12:15], v4, s[60:63], s92 offen offset:3072 sc1
  buffer_load_dwordx4 a[16:19], v255, s[60:63], s92 offen offset:0 sc1
  s_add_u32 s92, s92, 9216
  s_cmp_eq_u32 s92, s91
  s_cselect_b32 s92, s90, s92
  buffer_load_dwordx4 a[20:23], v4, s[60:63], s92 offen offset:0 sc1
  buffer_load_dwordx4 a[24:27], v4, s[60:63], s92 offen offset:1024 sc1
  buffer_load_dwordx4 a[28:31], v4, s[60:63], s92 offen offset:2048 sc1
  s_lshl_b32 s86, s22, 12
  s_lshl_b32 s87, s23, 4
  s_add_u32 s86, s86, s87
  s_add_u32 s86, s86, 131072
  v_mov_b32 v14, s86
  v_cmp_gt_u32 vcc, 1, v0
  s_nop 1
  v_cndmask_b32 v14, v13, v14, vcc
  s_lshl_b32 s86, s69, 12
  s_add_u32 s86, s86, 131072
  v_and_b32 v15, 7, v1
  v_lshl_add_u32 v15, v15, 4, s86
  v_add_u32 v10, 41472, v4
  v_and_b32 v11, 7, v2
  v_lshlrev_b32 v11, 4, v11
  v_lshl_add_u32 v11, v3, 7, v11
  v_add_u32 v9, 41472, v11
  v_mul_u32_u24 v7, 43, v2
  v_lshrrev_b32 v7, 8, v7
  v_mul_u32_u24 v7, 160, v7
  v_mul_u32_u24 v6, 144, v2
  v_add3_u32 v6, v6, v7, s77
  v_and_b32 v7, 1, v3
  v_lshl_add_u32 v7, v7, 3, v6
  v_lshl_add_u32 v6, v3, 4, v6
  s_waitcnt vmcnt(8)
  s_barrier
  v_mov_b32 v5, s73
  buffer_store_dword v5, v14, s[60:63], 0 offen sc1
  s_lshl_b32 s84, s68, 13
  s_add_u32 s84, s84, 98304
  s_mov_b32 m0, s84
  s_nop 0
  buffer_load_dwordx4 v93, s[44:47], s24 offen offset:0 nt lds
  s_add_u32 s24, s24, 8192
  buffer_load_dwordx4 v93, s[44:47], s24 offen offset:1024 nt lds
  s_add_u32 s24, s24, 8192
  buffer_load_dwordx4 v93, s[44:47], s24 offen offset:2048 nt lds
  s_add_u32 s24, s24, 8192
  buffer_load_dwordx4 v93, s[44:47], s24 offen offset:3072 nt lds
  s_lshl_b32 s84, s68, 13
  s_add_u32 s84, s84, 102400
  s_mov_b32 m0, s84
  s_nop 0
  buffer_load_dwordx4 v93, s[44:47], s26 offen offset:0 nt lds
  s_add_u32 s26, s26, 8192
  buffer_load_dwordx4 v93, s[44:47], s26 offen offset:1024 nt lds
  s_add_u32 s26, s26, 8192
  buffer_load_dwordx4 v93, s[44:47], s26 offen offset:2048 nt lds
  s_add_u32 s26, s26, 8192
  buffer_load_dwordx4 v93, s[44:47], s26 offen offset:3072 nt lds
  buffer_load_dwordx4 a[32:35], v4, s[60:63], s92 offen offset:3072 sc1
  buffer_load_dwordx4 a[36:39], v255, s[60:63], s92 offen offset:0 sc1
  s_add_u32 s92, s92, 9216
  s_cmp_eq_u32 s92, s91
  s_cselect_b32 s92, s90, s92
  buffer_load_dwordx4 a[40:43], v4, s[60:63], s92 offen offset:0 sc1
  buffer_load_dwordx4 a[44:47], v4, s[60:63], s92 offen offset:1024 sc1
  buffer_load_dwordx4 a[48:51], v4, s[60:63], s92 offen offset:2048 sc1
  buffer_load_dwordx4 a[52:55], v4, s[60:63], s92 offen offset:3072 sc1
  buffer_load_dwordx4 a[56:59], v255, s[60:63], s92 offen offset:0 sc1
  s_add_u32 s92, s92, 9216
  s_cmp_eq_u32 s92, s91
  s_cselect_b32 s92, s90, s92
  buffer_load_dwordx4 a[60:63], v4, s[60:63], s92 offen offset:0 sc1
  buffer_load_dword v46, v15, s[60:63], 0 offen sc1
  ds_read_b128 v[36:39], v6
  ds_read_b128 v[40:43], v6 offset:64
  ds_read_b64 v[44:45], v7 offset:128
  ds_read_b128 v[120:123], v4 offset:0
  ds_read_b128 v[124:127], v4 offset:1024
  ds_read_b128 v[128:131], v4 offset:2048
  ds_read_b128 v[132:135], v4 offset:3072
  ds_read_b128 v[136:139], v11 offset:4096
  ds_read_b128 v[140:143], v4 offset:4608
  ds_read_b128 v[144:147], v4 offset:5632
  ds_read_b128 v[148:151], v4 offset:6656
  ds_read_b128 v[152:155], v4 offset:7680
  ds_read_b128 v[156:159], v11 offset:8704
  ds_read_b128 v[160:163], v4 offset:9216
  ds_read_b128 v[164:167], v4 offset:10240
  ds_read_b128 v[168:171], v4 offset:11264
  ds_read_b128 v[172:175], v4 offset:12288
  ds_read_b128 v[176:179], v11 offset:13312
  ds_read_b128 v[180:183], v4 offset:13824
  ds_read_b128 v[184:187], v4 offset:14848
  ds_read_b128 v[188:191], v4 offset:15872
  ds_read_b128 v[192:195], v4 offset:16896
  ds_read_b128 v[196:199], v11 offset:17920
  ds_read_b128 v[200:203], v4 offset:18432
  ds_read_b128 v[204:207], v4 offset:19456
  ds_read_b128 v[208:211], v4 offset:20480
  ds_read_b128 v[212:215], v4 offset:21504
  ds_read_b128 v[216:219], v11 offset:22528
  ds_read_b128 v[220:223], v4 offset:23040
  ds_read_b128 v[224:227], v4 offset:24064
  s_mul_i32 s84, s69, 73728
  s_lshl_b32 s85, s68, 10
  s_add_u32 s84, s84, s85
  s_add_u32 s74, s84, 4194304
  s_add_u32 s75, s74, 65536
  s_mul_i32 s79, s68, 960
  s_sub_u32 s79, s75, s79
  v_lshlrev_b32 v232, 10, v3
  v_lshl_add_u32 v232, v2, 2, v232
  s_lshl_b32 s78, s3, 13
  s_add_u32 s78, s78, s74
  s_add_u32 s84, s84, 7340032
  s_mul_i32 s85, s70, 9
  v_add_u32 v6, s85, v3
  v_lshrrev_b32 v7, 2, v6
  v_lshlrev_b32 v7, 12, v7
  v_and_b32 v6, 3, v6
  v_lshl_add_u32 v6, v6, 8, v7
  v_lshl_add_u32 v6, v2, 4, v6
  v_add_u32 v6, s84, v6
  s_add_u32 s85, s85, 8
  s_lshr_b32 s86, s85, 2
  s_lshl_b32 s86, s86, 12
  s_and_b32 s85, s85, 3
  s_lshl_b32 s85, s85, 8
  s_add_u32 s85, s85, s86
  s_add_u32 s85, s85, s84
  v_lshlrev_b32 v7, 4, v2
  v_lshl_add_u32 v7, v3, 3, v7
  v_add_u32 v7, s85, v7
  v_cmp_gt_u32 s[82:83], 2, v3
  v_add_u32 v8, 4096, v6
  v_add_u32 v47, 98304, v94
  v_mov_b32 v235, v93
  v_cndmask_b32 v7, v13, v7, s[82:83]
  s_lshl_b32 s84, s69, 2
  s_add_u32 s84, s84, s68
  s_lshl_b32 s84, s84, 3
  s_add_u32 s84, s84, s70
  s_lshl_b32 s84, s84, 7
  s_add_u32 s84, s84, 786432
  v_lshl_add_u32 v233, v2, 3, s84
  v_cmp_gt_u32 vcc, 16, v1
  s_nop 1
  v_cndmask_b32 v233, v13, v233, vcc
  s_waitcnt lgkmcnt(15)
  v_lshlrev_b32 v16, 16, v36
  v_and_b32 v17, s98, v36
  v_lshlrev_b32 v18, 16, v37
  v_and_b32 v19, s98, v37
  v_lshlrev_b32 v20, 16, v38
  v_and_b32 v21, s98, v38
  v_lshlrev_b32 v22, 16, v39
  v_and_b32 v23, s98, v39
  v_lshlrev_b32 v24, 16, v40
  v_and_b32 v25, s98, v40
  v_lshlrev_b32 v26, 16, v41
  v_and_b32 v27, s98, v41
  v_lshlrev_b32 v28, 16, v42
  v_and_b32 v29, s98, v42
  v_lshlrev_b32 v30, 16, v43
  v_and_b32 v31, s98, v43
  v_lshlrev_b32 v32, 16, v44
  v_and_b32 v33, s98, v44
  v_lshlrev_b32 v34, 16, v45
  v_and_b32 v35, s98, v45
  s_waitcnt vmcnt(0)
  v_cmp_ne_u32 vcc, s73, v46
  s_cbranch_vccnz L_slow2
L_back2:
  buffer_load_dwordx4 v[48:51], v4, s[60:63], s78 offen sc1
  s_add_u32 s78, s78, 4096
  s_cmp_eq_u32 s78, s75
  s_cselect_b32 s78, s74, s78
  buffer_load_dwordx4 v[52:55], v4, s[60:63], s78 offen sc1
  s_add_u32 s78, s78, 4096
  s_cmp_eq_u32 s78, s75
  s_cselect_b32 s78, s74, s78
  buffer_load_dwordx4 v[56:59], v4, s[60:63], s78 offen sc1
  s_add_u32 s78, s78, 4096
  s_cmp_eq_u32 s78, s75
  s_cselect_b32 s78, s74, s78
  buffer_load_dwordx4 v[60:63], v4, s[60:63], s78 offen sc1
  s_add_u32 s78, s78, 4096
  s_cmp_eq_u32 s78, s75
  s_cselect_b32 s78, s74, s78
  buffer_load_dwordx4 v[64:67], v4, s[60:63], s78 offen sc1
  s_add_u32 s78, s78, 4096
  s_cmp_eq_u32 s78, s75
  s_cselect_b32 s78, s74, s78
  buffer_load_dwordx4 v[68:71], v4, s[60:63], s78 offen sc1
  s_add_u32 s78, s78, 4096
  s_cmp_eq_u32 s78, s75
  s_cselect_b32 s78, s74, s78
  buffer_load_dwordx4 v[72:75], v4, s[60:63], s78 offen sc1
  s_add_u32 s78, s78, 4096
  s_cmp_eq_u32 s78, s75
  s_cselect_b32 s78, s74, s78
  buffer_load_dwordx4 v[76:79], v4, s[60:63], s78 offen sc1
  s_add_u32 s78, s78, 4096
  s_cmp_eq_u32 s78, s75
  s_cselect_b32 s78, s74, s78
  s_waitcnt vmcnt(7)
  v_mfma_f32_16x16x32_bf16 v[16:19], v[120:123], v[48:51], v[16:19]
  ds_read_b128 v[228:231], v4 offset:25088
  buffer_load_dwordx4 v[80:83], v4, s[60:63], s78 offen sc1
  v_mfma_f32_16x16x32_bf16 v[20:23], v[124:127], v[48:51], v[20:23]
  ds_read_b128 v[120:123], v4 offset:26112
  s_add_u32 s78, s78, 4096
  s_cmp_eq_u32 s78, s75
  s_cselect_b32 s78, s74, s78
  v_mfma_f32_16x16x32_bf16 v[24:27], v[128:131], v[48:51], v[24:27]
  ds_read_b128 v[124:127], v11 offset:27136
  s_lshl_b32 s86, s69, 12
  v_mfma_f32_16x16x32_bf16 v[28:31], v[132:135], v[48:51], v[28:31]
  ds_read_b128 v[128:131], v4 offset:27648
  buffer_load_dwordx4 v[84:87], v4, s[60:63], s78 offen sc1
  v_mfma_f32_16x16x32_bf16 v[32:35], v[136:139], v[48:51], v[32:35]
  ds_read_b128 v[132:135], v4 offset:28672
  s_add_u32 s78, s78, 4096
  s_cmp_eq_u32 s78, s75
  s_cselect_b32 s78, s74, s78
  s_waitcnt vmcnt(8)
  v_mfma_f32_16x16x32_bf16 v[16:19], v[140:143], v[52:55], v[16:19]
  ds_read_b128 v[136:139], v4 offset:29696
  s_lshl_b32 s87, s70, 4
  v_mfma_f32_16x16x32_bf16 v[20:23], v[144:147], v[52:55], v[20:23]
  ds_read_b128 v[140:143], v4 offset:30720
  s_add_u32 s86, s86, s87
  v_mfma_f32_16x16x32_bf16 v[24:27], v[148:151], v[52:55], v[24:27]
  ds_read_b128 v[144:147], v11 offset:31744
  buffer_load_dwordx4 v[88:91], v4, s[60:63], s78 offen sc1
  v_mfma_f32_16x16x32_bf16 v[28:31], v[152:155], v[52:55], v[28:31]
  ds_read_b128 v[148:151], v4 offset:32256
  s_add_u32 s78, s78, 4096
  s_cmp_eq_u32 s78, s75
  s_cselect_b32 s78, s74, s78
  v_mfma_f32_16x16x32_bf16 v[32:35], v[156:159], v[52:55], v[32:35]
  ds_read_b128 v[152:155], v4 offset:33280
  s_add_u32 s86, s86, 327680
  s_waitcnt vmcnt(8)
  v_mfma_f32_16x16x32_bf16 v[16:19], v[160:163], v[56:59], v[16:19]
  ds_read_b128 v[156:159], v4 offset:34304
  buffer_load_dwordx4 v[92:95], v4, s[60:63], s78 offen sc1
  v_mfma_f32_16x16x32_bf16 v[20:23], v[164:167], v[56:59], v[20:23]
  ds_read_b128 v[160:163], v4 offset:35328
  s_add_u32 s78, s78, 4096
  s_cmp_eq_u32 s78, s75
  s_cselect_b32 s78, s74, s78
  s_waitcnt lgkmcnt(15)
  v_mfma_f32_16x16x32_bf16 v[24:27], v[168:171], v[56:59], v[24:27]
  ds_read_b128 v[164:167], v11 offset:36352
  v_mov_b32 v14, s86
  v_mfma_f32_16x16x32_bf16 v[28:31], v[172:175], v[56:59], v[28:31]
  ds_read_b128 v[168:171], v4 offset:36864
  v_mfma_f32_16x16x32_bf16 v[32:35], v[176:179], v[56:59], v[32:35]
  ds_read_b128 v[172:175], v4 offset:37888
  buffer_load_dwordx4 v[96:99], v4, s[60:63], s78 offen sc1
  s_waitcnt vmcnt(9)
  v_mfma_f32_16x16x32_bf16 v[16:19], v[180:183], v[60:63], v[16:19]
  ds_read_b128 v[176:179], v4 offset:38912
  s_add_u32 s78, s78, 4096
  s_cmp_eq_u32 s78, s75
  s_cselect_b32 s78, s74, s78
  v_mfma_f32_16x16x32_bf16 v[20:23], v[184:187], v[60:63], v[20:23]
  ds_read_b128 v[180:183], v4 offset:39936
  v_mfma_f32_16x16x32_bf16 v[24:27], v[188:191], v[60:63], v[24:27]
  ds_read_b128 v[184:187], v11 offset:40960
  buffer_load_dwordx4 v[100:103], v4, s[60:63], s78 offen sc1
  v_mfma_f32_16x16x32_bf16 v[28:31], v[192:195], v[60:63], v[28:31]
  ds_read_b128 v[188:191], v10 offset:0
  s_add_u32 s78, s78, 4096
  s_cmp_eq_u32 s78, s75
  s_cselect_b32 s78, s74, s78
  v_mfma_f32_16x16x32_bf16 v[32:35], v[196:199], v[60:63], v[32:35]
  ds_read_b128 v[192:195], v10 offset:1024
  s_waitcnt vmcnt(9)
  v_mfma_f32_16x16x32_bf16 v[16:19], v[200:203], v[64:67], v[16:19]
  ds_read_b128 v[196:199], v10 offset:2048
  v_mfma_f32_16x16x32_bf16 v[20:23], v[204:207], v[64:67], v[20:23]
  ds_read_b128 v[200:203], v10 offset:3072
  buffer_load_dwordx4 v[104:107], v4, s[60:63], s78 offen sc1
  v_mfma_f32_16x16x32_bf16 v[24:27], v[208:211], v[64:67], v[24:27]
  ds_read_b128 v[204:207], v9 offset:4096
  s_add_u32 s78, s78, 4096
  s_cmp_eq_u32 s78, s75
  s_cselect_b32 s78, s74, s78
  v_mfma_f32_16x16x32_bf16 v[28:31], v[212:215], v[64:67], v[28:31]
  ds_read_b128 v[208:211], v10 offset:4608
  s_waitcnt lgkmcnt(15)
  v_mfma_f32_16x16x32_bf16 v[32:35], v[216:219], v[64:67], v[32:35]
  ds_read_b128 v[212:215], v10 offset:5632
  buffer_load_dwordx4 v[108:111], v4, s[60:63], s78 offen sc1
  s_waitcnt vmcnt(10)
  v_mfma_f32_16x16x32_bf16 v[16:19], v[220:223], v[68:71], v[16:19]
  ds_read_b128 v[216:219], v10 offset:6656
  v_mfma_f32_16x16x32_bf16 v[20:23], v[224:227], v[68:71], v[20:23]
  ds_read_b128 v[220:223], v10 offset:7680
  v_mfma_f32_16x16x32_bf16 v[24:27], v[228:231], v[68:71], v[24:27]
  ds_read_b128 v[224:227], v9 offset:8704
  v_mfma_f32_16x16x32_bf16 v[28:31], v[120:123], v[68:71], v[28:31]
  ds_read_b128 v[228:231], v10 offset:9216
  buffer_load_dword v112, v232, s[60:63], s79 offen offset:0 sc1
  v_mfma_f32_16x16x32_bf16 v[32:35], v[124:127], v[68:71], v[32:35]
  ds_read_b128 v[120:123], v10 offset:10240
  s_waitcnt vmcnt(10)
  v_mfma_f32_16x16x32_bf16 v[16:19], v[128:131], v[72:75], v[16:19]
  ds_read_b128 v[124:127], v10 offset:11264
  v_mfma_f32_16x16x32_bf16 v[20:23], v[132:135], v[72:75], v[20:23]
  ds_read_b128 v[128:131], v10 offset:12288
  buffer_load_dword v113, v232, s[60:63], s79 offen offset:256 sc1
  v_mfma_f32_16x16x32_bf16 v[24:27], v[136:139], v[72:75], v[24:27]
  ds_read_b128 v[132:135], v9 offset:13312
  v_mfma_f32_16x16x32_bf16 v[28:31], v[140:143], v[72:75], v[28:31]
  ds_read_b128 v[136:139], v10 offset:13824
  v_mfma_f32_16x16x32_bf16 v[32:35], v[144:147], v[72:75], v[32:35]
  ds_read_b128 v[140:143], v10 offset:14848
  s_waitcnt vmcnt(10)
  v_mfma_f32_16x16x32_bf16 v[16:19], v[148:151], v[76:79], v[16:19]
  ds_read_b128 v[144:147], v10 offset:15872
  buffer_load_dword v114, v232, s[60:63], s79 offen offset:512 sc1
  s_waitcnt lgkmcnt(15)
  v_mfma_f32_16x16x32_bf16 v[20:23], v[152:155], v[76:79], v[20:23]
  ds_read_b128 v[148:151], v10 offset:16896
  v_mfma_f32_16x16x32_bf16 v[24:27], v[156:159], v[76:79], v[24:27]
  ds_read_b128 v[152:155], v9 offset:17920
  v_mfma_f32_16x16x32_bf16 v[28:31], v[160:163], v[76:79], v[28:31]
  ds_read_b128 v[156:159], v10 offset:18432
  buffer_load_dword v115, v232, s[60:63], s79 offen offset:768 sc1
  v_mfma_f32_16x16x32_bf16 v[32:35], v[164:167], v[76:79], v[32:35]
  ds_read_b128 v[160:163], v10 offset:19456
  s_add_u32 s79, s79, 4096
  s_waitcnt vmcnt(11)
  v_mfma_f32_16x16x32_bf16 v[16:19], v[168:171], v[80:83], v[16:19]
  ds_read_b128 v[164:167], v10 offset:20480
  v_mfma_f32_16x16x32_bf16 v[20:23], v[172:175], v[80:83], v[20:23]
  ds_read_b128 v[168:171], v10 offset:21504
  v_mfma_f32_16x16x32_bf16 v[24:27], v[176:179], v[80:83], v[24:27]
  ds_read_b128 v[172:175], v9 offset:22528
  buffer_load_dword v116, v232, s[60:63], s79 offen offset:0 sc1
  v_mfma_f32_16x16x32_bf16 v[28:31], v[180:183], v[80:83], v[28:31]
  ds_read_b128 v[176:179], v10 offset:23040
  v_mfma_f32_16x16x32_bf16 v[32:35], v[184:187], v[80:83], v[32:35]
  ds_read_b128 v[180:183], v10 offset:24064
  s_waitcnt vmcnt(11)
  v_mfma_f32_16x16x32_bf16 v[16:19], v[188:191], v[84:87], v[16:19]
  ds_read_b128 v[184:187], v10 offset:25088
  buffer_load_dword v117, v232, s[60:63], s79 offen offset:256 sc1
  v_mfma_f32_16x16x32_bf16 v[20:23], v[192:195], v[84:87], v[20:23]
  ds_read_b128 v[188:191], v10 offset:26112
  v_mfma_f32_16x16x32_bf16 v[24:27], v[196:199], v[84:87], v[24:27]
  ds_read_b128 v[192:195], v9 offset:27136
  s_waitcnt lgkmcnt(15)
  v_mfma_f32_16x16x32_bf16 v[28:31], v[200:203], v[84:87], v[28:31]
  ds_read_b128 v[196:199], v10 offset:27648
  v_mfma_f32_16x16x32_bf16 v[32:35], v[204:207], v[84:87], v[32:35]
  ds_read_b128 v[200:203], v10 offset:28672
  buffer_load_dword v118, v232, s[60:63], s79 offen offset:512 sc1
  s_waitcnt vmcnt(12)
  v_mfma_f32_16x16x32_bf16 v[16:19], v[208:211], v[88:91], v[16:19]
  ds_read_b128 v[204:207], v10 offset:29696
  v_mfma_f32_16x16x32_bf16 v[20:23], v[212:215], v[88:91], v[20:23]
  ds_read_b128 v[208:211], v10 offset:30720
  v_mfma_f32_16x16x32_bf16 v[24:27], v[216:219], v[88:91], v[24:27]
  ds_read_b128 v[212:215], v9 offset:31744
  buffer_load_dword v119, v232, s[60:63], s79 offen offset:768 sc1
  v_mfma_f32_16x16x32_bf16 v[28:31], v[220:223], v[88:91], v[28:31]
  ds_read_b128 v[216:219], v10 offset:32256
  v_mfma_f32_16x16x32_bf16 v[32:35], v[224:227], v[88:91], v[32:35]
  ds_read_b128 v[220:223], v10 offset:33280
  s_waitcnt vmcnt(12)
  v_mfma_f32_16x16x32_bf16 v[16:19], v[228:231], v[92:95], v[16:19]
  ds_read_b128 v[224:227], v10 offset:34304
  v_mfma_f32_16x16x32_bf16 v[20:23], v[120:123], v[92:95], v[20:23]
  ds_read_b128 v[228:231], v10 offset:35328
  v_mfma_f32_16x16x32_bf16 v[24:27], v[124:127], v[92:95], v[24:27]
  ds_read_b128 v[120:123], v9 offset:36352
  v_mfma_f32_16x16x32_bf16 v[28:31], v[128:131], v[92:95], v[28:31]
  ds_read_b128 v[124:127], v10 offset:36864
  v_mfma_f32_16x16x32_bf16 v[32:35], v[132:135], v[92:95], v[32:35]
  ds_read_b128 v[128:131], v10 offset:37888
  s_waitcnt vmcnt(11) lgkmcnt(15)
  v_mfma_f32_16x16x32_bf16 v[16:19], v[136:139], v[96:99], v[16:19]
  ds_read_b128 v[132:135], v10 offset:38912
  v_mfma_f32_16x16x32_bf16 v[20:23], v[140:143], v[96:99], v[20:23]
  ds_read_b128 v[136:139], v10 offset:39936
  v_mfma_f32_16x16x32_bf16 v[24:27], v[144:147], v[96:99], v[24:27]
  ds_read_b128 v[140:143], v9 offset:40960
  v_mfma_f32_16x16x32_bf16 v[28:31], v[148:151], v[96:99], v[28:31]
  v_cmp_gt_u32 vcc, 1, v0
  s_nop 1
  v_cndmask_b32 v14, v13, v14, vcc
  v_mfma_f32_16x16x32_bf16 v[32:35], v[152:155], v[96:99], v[32:35]
  s_lshl_b32 s86, s71, 12
  s_add_u32 s86, s86, 327680
  s_waitcnt vmcnt(10)
  v_mfma_f32_16x16x32_bf16 v[16:19], v[156:159], v[100:103], v[16:19]
  v_and_b32 v15, 7, v1
  v_lshl_add_u32 v15, v15, 4, s86
  v_mfma_f32_16x16x32_bf16 v[20:23], v[160:163], v[100:103], v[20:23]
  s_mul_i32 s84, s72, 1152
  s_lshl_b32 s85, s68, 8
  s_add_u32 s80, s85, s84
  v_mfma_f32_16x16x32_bf16 v[24:27], v[164:167], v[100:103], v[24:27]
  s_lshr_b32 s86, s68, 1
  s_lshl_b32 s86, s86, 6
  s_and_b32 s87, s68, 1
  v_mfma_f32_16x16x32_bf16 v[28:31], v[168:171], v[100:103], v[28:31]
  s_lshl_b32 s87, s87, 3
  s_add_u32 s86, s86, s87
  s_add_u32 s81, s86, s84
  v_mfma_f32_16x16x32_bf16 v[32:35], v[172:175], v[100:103], v[32:35]
  v_lshlrev_b32 v234, 4, v3
  buffer_load_dwordx4 a[64:67], v4, s[60:63], s92 offen offset:1024 sc1
  s_waitcnt vmcnt(10)
  v_mfma_f32_16x16x32_bf16 v[16:19], v[176:179], v[104:107], v[16:19]
  buffer_load_dwordx4 a[68:71], v4, s[60:63], s92 offen offset:2048 sc1
  buffer_load_dwordx4 a[72:75], v4, s[60:63], s92 offen offset:3072 sc1
  v_mfma_f32_16x16x32_bf16 v[20:23], v[180:183], v[104:107], v[20:23]
  buffer_load_dwordx4 a[76:79], v255, s[60:63], s92 offen offset:0 sc1
  s_waitcnt lgkmcnt(15)
  v_mfma_f32_16x16x32_bf16 v[24:27], v[184:187], v[104:107], v[24:27]
  v_mfma_f32_16x16x32_bf16 v[28:31], v[188:191], v[104:107], v[28:31]
  v_mfma_f32_16x16x32_bf16 v[32:35], v[192:195], v[104:107], v[32:35]
  s_waitcnt vmcnt(12) lgkmcnt(14)
  v_mfma_f32_16x16x32_bf16 v[16:19], v[196:199], v[108:111], v[16:19]
  s_waitcnt lgkmcnt(13)
  v_mfma_f32_16x16x32_bf16 v[20:23], v[200:203], v[108:111], v[20:23]
  s_waitcnt lgkmcnt(12)
  v_mfma_f32_16x16x32_bf16 v[24:27], v[204:207], v[108:111], v[24:27]
  s_waitcnt lgkmcnt(11)
  v_mfma_f32_16x16x32_bf16 v[28:31], v[208:211], v[108:111], v[28:31]
  s_waitcnt lgkmcnt(10)
  v_mfma_f32_16x16x32_bf16 v[32:35], v[212:215], v[108:111], v[32:35]
  s_waitcnt vmcnt(8) lgkmcnt(9)
  v_mfma_f32_16x16x32_bf16 v[16:19], v[216:219], v[112:115], v[16:19]
  s_waitcnt lgkmcnt(8)
  v_mfma_f32_16x16x32_bf16 v[20:23], v[220:223], v[112:115], v[20:23]
  s_waitcnt lgkmcnt(7)
  v_mfma_f32_16x16x32_bf16 v[24:27], v[224:227], v[112:115], v[24:27]
  s_waitcnt lgkmcnt(6)
  v_mfma_f32_16x16x32_bf16 v[28:31], v[228:231], v[112:115], v[28:31]
  s_waitcnt lgkmcnt(5)
  v_mfma_f32_16x16x32_bf16 v[32:35], v[120:123], v[112:115], v[32:35]
  s_waitcnt vmcnt(4) lgkmcnt(4)
  v_mfma_f32_16x16x32_bf16 v[16:19], v[124:127], v[116:119], v[16:19]
  s_waitcnt lgkmcnt(3)
  v_mfma_f32_16x16x32_bf16 v[20:23], v[128:131], v[116:119], v[20:23]
  s_waitcnt lgkmcnt(2)
  v_mfma_f32_16x16x32_bf16 v[24:27], v[132:135], v[116:119], v[24:27]
  s_waitcnt lgkmcnt(1)
  v_mfma_f32_16x16x32_bf16 v[28:31], v[136:139], v[116:119], v[28:31]
  s_waitcnt lgkmcnt(0)
  v_mfma_f32_16x16x32_bf16 v[32:35], v[140:143], v[116:119], v[32:35]
  v_cvt_pk_bf16_f32 v36, v16, v17
  v_cvt_pk_bf16_f32 v37, v18, v19
  v_cvt_pk_bf16_f32 v38, v20, v21
  v_cvt_pk_bf16_f32 v39, v22, v23
  buffer_store_dwordx4 v[36:39], v6, s[60:63], 0 offen sc1
  v_cvt_pk_bf16_f32 v40, v24, v25
  v_cvt_pk_bf16_f32 v41, v26, v27
  v_cvt_pk_bf16_f32 v42, v28, v29
  v_cvt_pk_bf16_f32 v43, v30, v31
  buffer_store_dwordx4 v[40:43], v8, s[60:63], 0 offen sc1
  v_cvt_pk_bf16_f32 v44, v32, v33
  v_cvt_pk_bf16_f32 v45, v34, v35
  buffer_store_dwordx2 v[44:45], v7, s[60:63], 0 offen sc1
  v_cndmask_b32 v16, 0, v44, s[82:83]
  v_cndmask_b32 v17, 0, v45, s[82:83]
  v_dot2_f32_bf16 v20, v16, s99, 0
  v_dot2_f32_bf16 v21, v16, v16, 0
  v_dot2_f32_bf16 v22, v17, s99, 0
  v_dot2_f32_bf16 v23, v17, v17, 0
  v_dot2_f32_bf16 v20, v36, s99, v20
  v_dot2_f32_bf16 v21, v36, v36, v21
  v_dot2_f32_bf16 v22, v37, s99, v22
  v_dot2_f32_bf16 v23, v37, v37, v23
  v_dot2_f32_bf16 v20, v38, s99, v20
  v_dot2_f32_bf16 v21, v38, v38, v21
  v_dot2_f32_bf16 v22, v39, s99, v22
  v_dot2_f32_bf16 v23, v39, v39, v23
  v_dot2_f32_bf16 v20, v40, s99, v20
  v_dot2_f32_bf16 v21, v40, v40, v21
  v_dot2_f32_bf16 v22, v41, s99, v22
  v_dot2_f32_bf16 v23, v41, v41, v23
  v_dot2_f32_bf16 v20, v42, s99, v20
  v_dot2_f32_bf16 v21, v42, v42, v21
  v_dot2_f32_bf16 v22, v43, s99, v22
  v_dot2_f32_bf16 v23, v43, v43, v23
  s_nop 1
  v_add_f32 v20, v20, v22
  v_add_f32 v21, v21, v23
  v_mov_b32 v22, v20
  v_mov_b32 v23, v21
  s_nop 0
  v_permlane16_swap_b32 v20, v22
  v_permlane16_swap_b32 v21, v23
  v_add_f32 v20, v20, v22
  v_add_f32 v21, v21, v23
  v_mov_b32 v22, v20
  v_mov_b32 v23, v21
  s_nop 0
  v_permlane32_swap_b32 v20, v22
  v_permlane32_swap_b32 v21, v23
  v_add_f32 v20, v20, v22
  v_add_f32 v21, v21, v23
  buffer_store_dwordx2 v[20:21], v233, s[60:63], 0 offen sc1
  buffer_load_dwordx4 v[136:139], v234, s[48:51], s80 offen offset:0
  buffer_load_dwordx4 v[140:143], v234, s[48:51], s80 offen offset:64
  buffer_load_dwordx4 v[144:147], v234, s[48:51], s80 offen offset:128
  buffer_load_dwordx4 v[148:151], v234, s[48:51], s80 offen offset:192
  buffer_load_dwordx2 v[152:153], v234, s[48:51], s81 offen offset:1024
  s_add_u32 s92, s92, 9216
  s_cmp_eq_u32 s92, s91
  s_cselect_b32 s92, s90, s92
  buffer_load_dwordx4 a[80:83], v4, s[60:63], s92 offen offset:0 sc1
  buffer_load_dwordx4 a[84:87], v4, s[60:63], s92 offen offset:1024 sc1
  buffer_load_dwordx4 a[88:91], v4, s[60:63], s92 offen offset:2048 sc1
  buffer_load_dwordx4 a[92:95], v4, s[60:63], s92 offen offset:3072 sc1
  buffer_load_dwordx4 a[96:99], v255, s[60:63], s92 offen offset:0 sc1
  s_add_u32 s92, s92, 9216
  s_cmp_eq_u32 s92, s91
  s_cselect_b32 s92, s90, s92
  buffer_load_dwordx4 a[100:103], v4, s[60:63], s92 offen offset:0 sc1
  buffer_load_dwordx4 a[104:107], v4, s[60:63], s92 offen offset:1024 sc1
  buffer_load_dwordx4 a[108:111], v4, s[60:63], s92 offen offset:2048 sc1
  s_waitcnt vmcnt(13)
  s_barrier
  v_mov_b32 v5, s73
  buffer_store_dword v5, v14, s[60:63], 0 offen sc1
L_markB:
  ds_read_b64_tr_b16 v[48:49], v47 offset:0
  ds_read_b64_tr_b16 v[50:51], v47 offset:512
  ds_read_b64_tr_b16 v[52:53], v47 offset:8
  ds_read_b64_tr_b16 v[54:55], v47 offset:520
  ds_read_b64_tr_b16 v[56:57], v47 offset:64
  ds_read_b64_tr_b16 v[58:59], v47 offset:576
  ds_read_b64_tr_b16 v[60:61], v47 offset:72
  ds_read_b64_tr_b16 v[62:63], v47 offset:584
  ds_read_b64_tr_b16 v[64:65], v47 offset:4096
  ds_read_b64_tr_b16 v[66:67], v47 offset:4608
  ds_read_b64_tr_b16 v[68:69], v47 offset:4104
  ds_read_b64_tr_b16 v[70:71], v47 offset:4616
  ds_read_b64_tr_b16 v[72:73], v47 offset:4160
  ds_read_b64_tr_b16 v[74:75], v47 offset:4672
  ds_read_b64_tr_b16 v[76:77], v47 offset:4168
  ds_read_b64_tr_b16 v[78:79], v47 offset:4680
  s_waitcnt lgkmcnt(14)
  buffer_store_dwordx4 v[48:51], v4, s[60:63], s25 offen sc1
  s_add_u32 s25, s25, s34
  s_waitcnt lgkmcnt(12)
  buffer_store_dwordx4 v[52:55], v4, s[60:63], s25 offen sc1
  s_add_u32 s25, s25, s34
  s_waitcnt lgkmcnt(10)
  buffer_store_dwordx4 v[56:59], v4, s[60:63], s25 offen sc1
  s_add_u32 s25, s25, s34
  s_waitcnt lgkmcnt(8)
  buffer_store_dwordx4 v[60:63], v4, s[60:63], s25 offen sc1
  s_waitcnt lgkmcnt(6)
  buffer_store_dwordx4 v[64:67], v4, s[60:63], s27 offen sc1
  s_add_u32 s27, s27, s37
  s_waitcnt lgkmcnt(4)
  buffer_store_dwordx4 v[68:71], v4, s[60:63], s27 offen sc1
  s_add_u32 s27, s27, s37
  s_waitcnt lgkmcnt(2)
  buffer_store_dwordx4 v[72:75], v4, s[60:63], s27 offen sc1
  s_add_u32 s27, s27, s37
  s_waitcnt lgkmcnt(0)
  buffer_store_dwordx4 v[76:79], v4, s[60:63], s27 offen sc1
  s_getpc_b64 s[64:65]
L_pc1:
  s_and_b32 s65, s65, 0xffff
  s_mov_b32 s66, L_code_end - L_pc1
  s_mov_b32 s67, 0x00020000
  s_lshr_b32 s84, s2, 3
  s_lshl_b32 s84, s84, 2
  v_lshrrev_b32 v17, 6, v0
  v_and_b32 v16, 63, v0
  v_lshlrev_b32 v16, 7, v16
  v_add3_u32 v16, v16, v17, s84
  v_lshlrev_b32 v16, 7, v16
  buffer_load_dword v16, v16, s[64:67], 0 offen
  buffer_load_dwordx4 a[112:115], v4, s[60:63], s92 offen offset:3072 sc1
  buffer_load_dwordx4 a[116:119], v255, s[60:63], s92 offen offset:0 sc1
  s_add_u32 s92, s92, 9216
  s_cmp_eq_u32 s92, s91
  s_cselect_b32 s92, s90, s92
  buffer_load_dwordx4 a[120:123], v4, s[60:63], s92 offen offset:0 sc1
  buffer_load_dwordx4 a[124:127], v4, s[60:63], s92 offen offset:1024 sc1
  buffer_load_dwordx4 a[128:131], v4, s[60:63], s92 offen offset:2048 sc1
  buffer_load_dwordx4 a[132:135], v4, s[60:63], s92 offen offset:3072 sc1
  buffer_load_dwordx4 a[136:139], v255, s[60:63], s92 offen offset:0 sc1
  s_add_u32 s92, s92, 9216
  s_cmp_eq_u32 s92, s91
  s_cselect_b32 s92, s90, s92
  buffer_load_dwordx4 a[140:143], v4, s[60:63], s92 offen offset:0 sc1
  buffer_load_dwordx4 a[144:147], v4, s[60:63], s92 offen offset:1024 sc1
  buffer_load_dwordx4 a[148:151], v4, s[60:63], s92 offen offset:2048 sc1
  buffer_load_dwordx4 a[152:155], v4, s[60:63], s92 offen offset:3072 sc1
  buffer_load_dwordx4 a[156:159], v255, s[60:63], s92 offen offset:0 sc1
  s_add_u32 s92, s92, 9216
  s_cmp_eq_u32 s92, s91
  s_cselect_b32 s92, s90, s92
  buffer_load_dwordx4 a[160:163], v4, s[60:63], s92 offen offset:0 sc1
  buffer_load_dwordx4 a[164:167], v4, s[60:63], s92 offen offset:1024 sc1
  buffer_load_dwordx4 a[168:171], v4, s[60:63], s92 offen offset:2048 sc1
  buffer_load_dwordx4 a[172:175], v4, s[60:63], s92 offen offset:3072 sc1
  buffer_load_dwordx4 a[176:179], v255, s[60:63], s92 offen offset:0 sc1
  s_add_u32 s92, s92, 9216
  s_cmp_eq_u32 s92, s91
  s_cselect_b32 s92, s90, s92
  buffer_load_dwordx4 a[180:183], v4, s[60:63], s92 offen offset:0 sc1
  buffer_load_dwordx4 a[184:187], v4, s[60:63], s92 offen offset:1024 sc1
  buffer_load_dwordx4 a[188:191], v4, s[60:63], s92 offen offset:2048 sc1
  buffer_load_dwordx4 a[192:195], v4, s[60:63], s92 offen offset:3072 sc1
  buffer_load_dwordx4 a[196:199], v255, s[60:63], s92 offen offset:0 sc1
  s_add_u32 s92, s92, 9216
  s_cmp_eq_u32 s92, s91
  s_cselect_b32 s92, s90, s92
  buffer_load_dwordx4 a[200:203], v4, s[60:63], s92 offen offset:0 sc1
  buffer_load_dwordx4 a[204:207], v4, s[60:63], s92 offen offset:1024 sc1
  buffer_load_dwordx4 a[208:211], v4, s[60:63], s92 offen offset:2048 sc1
  buffer_load_dwordx4 a[212:215], v4, s[60:63], s92 offen offset:3072 sc1
  buffer_load_dword v46, v15, s[60:63], 0 offen sc1
  s_waitcnt vmcnt(49)
  v_lshlrev_b32 v96, 16, v136
  v_and_b32 v97, s98, v136
  v_lshlrev_b32 v98, 16, v137
  v_and_b32 v99, s98, v137
  v_lshlrev_b32 v100, 16, v138
  v_and_b32 v101, s98, v138
  v_lshlrev_b32 v102, 16, v139
  v_and_b32 v103, s98, v139
  s_waitcnt vmcnt(48)
  v_lshlrev_b32 v104, 16, v140
  v_and_b32 v105, s98, v140
  v_lshlrev_b32 v106, 16, v141
  v_and_b32 v107, s98, v141
  v_lshlrev_b32 v108, 16, v142
  v_and_b32 v109, s98, v142
  v_lshlrev_b32 v110, 16, v143
  v_and_b32 v111, s98, v143
  s_waitcnt vmcnt(45)
  v_lshlrev_b32 v112, 16, v152
  v_and_b32 v113, s98, v152
  v_lshlrev_b32 v114, 16, v153
  v_and_b32 v115, s98, v153
  s_mul_i32 s84, s71, 73728
  s_lshl_b32 s85, s68, 10
  s_add_u32 s84, s84, s85
  s_add_u32 s74, s84, 7340032
  s_add_u32 s75, s74, 73728
  s_lshl_b32 s77, s1, 12
  s_add_u32 s77, s77, s74
  v_add_u32 v6, s85, v4
  v_add_u32 v7, 36864, v6
  v_add_u32 v8, 36864, v4
  v_add_u32 v9, 73728, v4
  v_add_u32 v10, 110592, v4
  v_mov_b32 v11, v47
  s_and_b32 s93, s71, 15
  s_lshr_b32 s94, s93, 1
  s_mul_i32 s93, s93, 5
  s_lshr_b32 s93, s93, 3
  s_lshl_b32 s84, s71, 12
  s_add_u32 s84, s84, s85
  s_add_u32 s84, s84, 786432
  v_lshlrev_b32 v239, 8, v3
  v_lshl_add_u32 v239, v2, 3, v239
  s_lshl_b32 s86, s23, 12
  s_lshl_b32 s87, s22, 2
  s_add_u32 s86, s86, s87
  s_add_u32 s86, s86, 491520
  v_mov_b32 v14, s86
  v_cmp_gt_u32 vcc, 1, v0
  s_nop 1
  v_cndmask_b32 v14, v13, v14, vcc
  s_lshl_b32 s86, s71, 12
  s_lshl_b32 s87, s72, 4
  s_add_u32 s86, s86, s87
  s_add_u32 s86, s86, 524288
  v_mov_b32 v242, s86
  v_cmp_gt_u32 vcc, 1, v0
  s_nop 1
  v_cndmask_b32 v242, v13, v242, vcc
  s_lshl_b32 s86, s71, 12
  s_add_u32 s86, s86, 524288
  v_and_b32 v243, 7, v1
  v_lshl_add_u32 v243, v243, 4, s86
  s_lshl_b32 s86, s71, 6
  s_add_u32 s86, s86, s72
  s_mul_i32 s86, s86, 9216
  s_add_u32 s86, s86, 23068672
  v_lshrrev_b32 v240, 3, v2
  v_mul_u32_u24 v240, 73728, v240
  v_and_b32 v5, 7, v2
  v_lshlrev_b32 v5, 3, v5
  v_lshl_add_u32 v5, v3, 6, v5
  v_add3_u32 v241, v240, v5, s86
  v_add_u32 v240, v241, v5
  s_lshl_b32 s85, s68, 8
  s_add_u32 s87, s85, 8192
  v_add_u32 v241, s87, v241
  s_lshl_b32 s76, s68, 11
  v_add_u32 v240, s76, v240
  s_lshl_b32 s86, s71, 3
  s_add_u32 s86, s86, s72
  s_mul_i32 s86, s86, 73728
  s_add_u32 s86, s86, 23068672
  s_add_u32 s76, s76, s86
  v_add_u32 v244, s76, v4
  s_add_u32 s87, s87, s86
  v_lshl_add_u32 v246, v1, 3, s87
  v_cmp_gt_u32 vcc, 32, v1
  v_lshrrev_b32 v5, 5, v1
  v_bfe_u32 v250, v1, 3, 2
  v_cndmask_b32 v246, v13, v246, vcc
  v_and_b32 v252, 7, v1
  v_lshlrev_b32 v247, 12, v5
  v_lshl_add_u32 v247, v250, 8, v247
  v_lshl_add_u32 v247, v252, 4, v247
  v_lshlrev_b32 v250, 4, v250
  v_lshl_add_u32 v250, v5, 6, v250
  s_lshr_b32 s87, s72, 1
  s_and_b32 s86, s72, 1
  s_lshl_b32 s76, s71, 6
  s_and_b32 s32, s87, 1
  s_lshl_b32 s32, s32, 5
  s_add_u32 s76, s76, s32
  s_lshr_b32 s32, s87, 1
  s_add_u32 s76, s76, s32
  s_lshl_b32 s32, s86, 4
  s_add_u32 s76, s76, s32
  s_mul_i32 s76, s76, 1152
  v_mul_u32_u24 v252, 2304, v252
  v_add3_u32 v252, v252, v250, s76
  v_cndmask_b32 v254, v13, v252, vcc
  s_mul_i32 s76, s71, 73728
  s_lshl_b32 s87, s87, 10
  s_add_u32 s76, s76, s87
  s_lshl_b32 s86, s86, 7
  s_add_u32 s76, s76, s86
  s_add_u32 s76, s76, 7340032
  s_lshl_b32 s86, s68, 14
  s_add_u32 s32, s76, s86
  s_add_u32 s33, s32, 8192
  s_lshr_b32 s86, s68, 1
  s_and_b32 s87, s68, 1
  s_lshl_b32 s87, s87, 3
  s_lshl_b32 s36, s86, 12
  s_add_u32 s36, s36, s87
  s_add_u32 s36, s36, 65536
  s_add_u32 s36, s36, s76
  s_mov_b32 s38, s85
  s_lshl_b32 s39, s86, 6
  s_add_u32 s39, s39, s87
  s_add_u32 s39, s39, 1024
  s_mov_b32 s80, 0
  s_mov_b32 s81, 147456
  s_mov_b32 s82, 294912
  s_mov_b32 s83, 442368
  s_mov_b32 s95, 0x00003f80
  s_mov_b32 s96, 0x3f800000
L_markC:
  s_or_b32 s86, s2, s68
  s_cbranch_scc0 L_epoch
L_epoch_back:
  s_waitcnt vmcnt(0)
  v_cmp_ne_u32 vcc, s73, v46
  s_cbranch_vccnz L_slow3
L_back3:
  buffer_load_dwordx2 v[154:155], v239, s[60:63], s84 offen offset:0 sc1
  buffer_load_dwordx2 v[156:157], v239, s[60:63], s84 offen offset:128 sc1
  buffer_load_dwordx4 v[160:163], v4, s[60:63], s77 offen sc1
  s_add_u32 s77, s77, 4096
  s_cmp_eq_u32 s77, s75
  s_cselect_b32 s77, s74, s77
  buffer_load_dwordx4 v[164:167], v4, s[60:63], s77 offen sc1
  s_add_u32 s77, s77, 4096
  s_cmp_eq_u32 s77, s75
  s_cselect_b32 s77, s74, s77
  buffer_load_dwordx4 v[168:171], v4, s[60:63], s77 offen sc1
  s_add_u32 s77, s77, 4096
  s_cmp_eq_u32 s77, s75
  s_cselect_b32 s77, s74, s77
  buffer_load_dwordx4 v[172:175], v4, s[60:63], s77 offen sc1
  s_add_u32 s77, s77, 4096
  s_cmp_eq_u32 s77, s75
  s_cselect_b32 s77, s74, s77
  s_waitcnt vmcnt(4)
  v_add_f32 v132, v154, v156
  v_add_f32 v133, v155, v157
  v_mov_b32 v134, v132
  v_mov_b32 v135, v133
  s_nop 0
  v_permlane16_swap_b32 v132, v134
  v_permlane16_swap_b32 v133, v135
  v_add_f32 v132, v132, v134
  v_add_f32 v133, v133, v135
  v_mov_b32 v134, v132
  v_mov_b32 v135, v133
  s_nop 0
  v_permlane32_swap_b32 v132, v134
  v_permlane32_swap_b32 v133, v135
  v_add_f32 v132, v132, v134
  v_add_f32 v133, v133, v135
  v_mul_f32 v132, 0x3ae38e39, v132
  v_mul_f32 v134, v132, v132
  v_mul_f32 v133, 0x3ae38e39, v133
  v_sub_f32 v133, v133, v134
  v_max_f32 v133, 0, v133
  v_add_f32 v133, 0x3727c5ac, v133
  v_rsq_f32 v133, v133
  s_nop 0
  v_mul_f32 v134, v132, -v133
  v_mov_b32 v132, v133
  v_mov_b32 v135, v134
  buffer_load_dwordx4 v[176:179], v4, s[60:63], s77 offen sc1
  s_add_u32 s77, s77, 4096
  s_cmp_eq_u32 s77, s75
  s_cselect_b32 s77, s74, s77
  buffer_load_dwordx4 v[180:183], v4, s[60:63], s77 offen sc1
  s_add_u32 s77, s77, 4096
  s_cmp_eq_u32 s77, s75
  s_cselect_b32 s77, s74, s77
  buffer_load_dwordx4 v[184:187], v4, s[60:63], s77 offen sc1
  s_add_u32 s77, s77, 4096
  s_cmp_eq_u32 s77, s75
  s_cselect_b32 s77, s74, s77
  buffer_load_dwordx4 v[188:191], v4, s[60:63], s77 offen sc1
  s_add_u32 s77, s77, 4096
  s_cmp_eq_u32 s77, s75
  s_cselect_b32 s77, s74, s77
  buffer_load_dwordx4 v[192:195], v4, s[60:63], s77 offen sc1
  s_add_u32 s77, s77, 4096
  s_cmp_eq_u32 s77, s75
  s_cselect_b32 s77, s74, s77
  buffer_load_dwordx4 v[196:199], v4, s[60:63], s77 offen sc1
  s_add_u32 s77, s77, 4096
  s_cmp_eq_u32 s77, s75
  s_cselect_b32 s77, s74, s77
  buffer_load_dwordx4 v[200:203], v4, s[60:63], s77 offen sc1
  s_add_u32 s77, s77, 4096
  s_cmp_eq_u32 s77, s75
  s_cselect_b32 s77, s74, s77
  buffer_load_dwordx4 v[204:207], v4, s[60:63], s77 offen sc1
  s_add_u32 s77, s77, 4096
  s_cmp_eq_u32 s77, s75
  s_cselect_b32 s77, s74, s77
  buffer_load_dwordx4 v[208:211], v4, s[60:63], s77 offen sc1
  s_add_u32 s77, s77, 4096
  s_cmp_eq_u32 s77, s75
  s_cselect_b32 s77, s74, s77
  buffer_load_dwordx4 v[212:215], v4, s[60:63], s77 offen sc1
  s_add_u32 s77, s77, 4096
  s_cmp_eq_u32 s77, s75
  s_cselect_b32 s77, s74, s77
  buffer_load_dwordx4 v[216:219], v4, s[60:63], s77 offen sc1
  s_add_u32 s77, s77, 4096
  s_cmp_eq_u32 s77, s75
  s_cselect_b32 s77, s74, s77
  buffer_load_dwordx4 v[220:223], v4, s[60:63], s77 offen sc1
  s_add_u32 s77, s77, 4096
  s_cmp_eq_u32 s77, s75
  s_cselect_b32 s77, s74, s77
  buffer_load_dwordx4 v[224:227], v4, s[60:63], s77 offen sc1
  s_add_u32 s77, s77, 4096
  s_cmp_eq_u32 s77, s75
  s_cselect_b32 s77, s74, s77
  buffer_load_dwordx4 v[228:231], v4, s[60:63], s77 offen sc1
  s_waitcnt vmcnt(17)
  v_lshlrev_b32 v116, 16, v160
  v_and_b32 v117, s98, v160
  v_lshlrev_b32 v118, 16, v161
  v_and_b32 v119, s98, v161
  v_lshlrev_b32 v120, 16, v162
  v_and_b32 v121, s98, v162
  v_lshlrev_b32 v122, 16, v163
  v_and_b32 v123, s98, v163
  v_pk_fma_f32 v[116:117], v[116:117], v[132:133], v[134:135]
  v_pk_fma_f32 v[118:119], v[118:119], v[132:133], v[134:135]
  v_pk_fma_f32 v[120:121], v[120:121], v[132:133], v[134:135]
  v_pk_fma_f32 v[122:123], v[122:123], v[132:133], v[134:135]
  v_cvt_pk_bf16_f32 v160, v116, v117
  v_cvt_pk_bf16_f32 v161, v118, v119
  v_cvt_pk_bf16_f32 v162, v120, v121
  v_cvt_pk_bf16_f32 v163, v122, v123
  ds_write_b128 v6, v[160:163] offset:0
  s_waitcnt vmcnt(16)
  v_lshlrev_b32 v124, 16, v164
  v_and_b32 v125, s98, v164
  v_lshlrev_b32 v126, 16, v165
  v_and_b32 v127, s98, v165
  v_lshlrev_b32 v128, 16, v166
  v_and_b32 v129, s98, v166
  v_lshlrev_b32 v130, 16, v167
  v_and_b32 v131, s98, v167
  v_pk_fma_f32 v[124:125], v[124:125], v[132:133], v[134:135]
  v_pk_fma_f32 v[126:127], v[126:127], v[132:133], v[134:135]
  v_pk_fma_f32 v[128:129], v[128:129], v[132:133], v[134:135]
  v_pk_fma_f32 v[130:131], v[130:131], v[132:133], v[134:135]
  v_cvt_pk_bf16_f32 v164, v124, v125
  v_cvt_pk_bf16_f32 v165, v126, v127
  v_cvt_pk_bf16_f32 v166, v128, v129
  v_cvt_pk_bf16_f32 v167, v130, v131
  ds_write_b128 v6, v[164:167] offset:4096
  s_waitcnt vmcnt(15)
  v_lshlrev_b32 v116, 16, v168
  v_and_b32 v117, s98, v168
  v_lshlrev_b32 v118, 16, v169
  v_and_b32 v119, s98, v169
  v_lshlrev_b32 v120, 16, v170
  v_and_b32 v121, s98, v170
  v_lshlrev_b32 v122, 16, v171
  v_and_b32 v123, s98, v171
  v_pk_fma_f32 v[116:117], v[116:117], v[132:133], v[134:135]
  v_pk_fma_f32 v[118:119], v[118:119], v[132:133], v[134:135]
  v_pk_fma_f32 v[120:121], v[120:121], v[132:133], v[134:135]
  v_pk_fma_f32 v[122:123], v[122:123], v[132:133], v[134:135]
  v_cvt_pk_bf16_f32 v168, v116, v117
  v_cvt_pk_bf16_f32 v169, v118, v119
  v_cvt_pk_bf16_f32 v170, v120, v121
  v_cvt_pk_bf16_f32 v171, v122, v123
  ds_write_b128 v6, v[168:171] offset:8192
  s_waitcnt lgkmcnt(0)
  s_barrier
  ds_read_b128 a[224:227], v4 offset:0
  ds_read_b128 a[228:231], v4 offset:1024
  ds_read_b128 a[232:235], v4 offset:2048
  ds_read_b128 a[236:239], v4 offset:3072
  s_waitcnt lgkmcnt(3)
  v_mfma_f32_16x16x32_bf16 v[16:19], a[0:3], a[224:227], v[96:99]
  ds_read_b128 a[240:243], v4 offset:4096
  buffer_load_dwordx4 a[216:219], v255, s[60:63], s92 offen offset:0 sc1
  s_waitcnt lgkmcnt(3)
  v_mfma_f32_16x16x32_bf16 v[20:23], a[0:3], a[228:231], v[96:99]
  s_add_u32 s92, s92, 9216
  s_cmp_eq_u32 s92, s91
  s_cselect_b32 s92, s90, s92
  s_waitcnt lgkmcnt(2)
  v_mfma_f32_16x16x32_bf16 v[24:27], a[0:3], a[232:235], v[96:99]
  ds_read_b128 a[244:247], v4 offset:5120
  buffer_load_dwordx4 a[220:223], v4, s[60:63], s92 offen offset:0 sc1
  s_waitcnt lgkmcnt(2)
  v_mfma_f32_16x16x32_bf16 v[28:31], a[0:3], a[236:239], v[96:99]
  s_waitcnt vmcnt(16)
  v_lshlrev_b32 v124, 16, v172
  v_and_b32 v125, s98, v172
  v_mfma_f32_16x16x32_bf16 v[44:47], a[4:7], a[236:239], v[100:103]
  ds_read_b128 a[248:251], v4 offset:6144
  buffer_load_dwordx4 a[0:3], v4, s[60:63], s92 offen offset:1024 sc1
  v_mfma_f32_16x16x32_bf16 v[40:43], a[4:7], a[232:235], v[100:103]
  v_lshlrev_b32 v126, 16, v173
  v_and_b32 v127, s98, v173
  v_mfma_f32_16x16x32_bf16 v[36:39], a[4:7], a[228:231], v[100:103]
  ds_read_b128 a[252:255], v4 offset:7168
  v_lshlrev_b32 v128, 16, v174
  v_mfma_f32_16x16x32_bf16 v[32:35], a[4:7], a[224:227], v[100:103]
  v_and_b32 v129, s98, v174
  v_lshlrev_b32 v130, 16, v175
  v_mfma_f32_16x16x32_bf16 v[48:51], a[8:11], a[224:227], v[104:107]
  buffer_load_dwordx4 a[4:7], v4, s[60:63], s92 offen offset:2048 sc1
  v_and_b32 v131, s98, v175
  v_mfma_f32_16x16x32_bf16 v[52:55], a[8:11], a[228:231], v[104:107]
  v_fma_f32 v124, v124, v132, v134
  v_fma_f32 v125, v125, v132, v134
  v_mfma_f32_16x16x32_bf16 v[56:59], a[8:11], a[232:235], v[104:107]
  v_fma_f32 v126, v126, v132, v134
  v_fma_f32 v127, v127, v132, v134
  v_mfma_f32_16x16x32_bf16 v[60:63], a[8:11], a[236:239], v[104:107]
  v_fma_f32 v128, v128, v132, v134
  v_fma_f32 v129, v129, v132, v134
  v_mfma_f32_16x16x32_bf16 v[76:79], a[12:15], a[236:239], v[108:111]
  buffer_load_dwordx4 a[8:11], v4, s[60:63], s92 offen offset:3072 sc1
  v_fma_f32 v130, v130, v132, v134
  v_mfma_f32_16x16x32_bf16 v[72:75], a[12:15], a[232:235], v[108:111]
  v_fma_f32 v131, v131, v132, v134
  v_cvt_pk_bf16_f32 v172, v124, v125
  v_mfma_f32_16x16x32_bf16 v[68:71], a[12:15], a[228:231], v[108:111]
  v_cvt_pk_bf16_f32 v173, v126, v127
  v_cvt_pk_bf16_f32 v174, v128, v129
  v_mfma_f32_16x16x32_bf16 v[64:67], a[12:15], a[224:227], v[108:111]
  v_cvt_pk_bf16_f32 v175, v130, v131
  v_mfma_f32_16x16x32_bf16 v[80:83], a[16:19], a[224:227], v[112:115]
  buffer_load_dwordx4 a[12:15], v255, s[60:63], s92 offen offset:0 sc1
  v_mfma_f32_16x16x32_bf16 v[84:87], a[16:19], a[228:231], v[112:115]
  ds_write_b128 v6, v[172:175] offset:12288
  v_mfma_f32_16x16x32_bf16 v[88:91], a[16:19], a[232:235], v[112:115]
  s_waitcnt vmcnt(19)
  v_lshlrev_b32 v116, 16, v176
  v_and_b32 v117, s98, v176
  v_mfma_f32_16x16x32_bf16 v[92:95], a[16:19], a[236:239], v[112:115]
  s_waitcnt lgkmcnt(1)
  v_lshlrev_b32 v118, 16, v177
  v_and_b32 v119, s98, v177
  v_mfma_f32_16x16x32_bf16 v[16:19], a[20:23], a[240:243], v[16:19]
  ds_read_b128 a[224:227], v4 offset:8192
  v_lshlrev_b32 v120, 16, v178
  v_mfma_f32_16x16x32_bf16 v[20:23], a[20:23], a[244:247], v[20:23]
  s_add_u32 s92, s92, 9216
  s_cmp_eq_u32 s92, s91
  s_cselect_b32 s92, s90, s92
  v_mfma_f32_16x16x32_bf16 v[24:27], a[20:23], a[248:251], v[24:27]
  ds_read_b128 a[228:231], v4 offset:9216
  buffer_load_dwordx4 a[16:19], v4, s[60:63], s92 offen offset:0 sc1
  v_mfma_f32_16x16x32_bf16 v[28:31], a[20:23], a[252:255], v[28:31]
  v_and_b32 v121, s98, v178
  v_lshlrev_b32 v122, 16, v179
  v_mfma_f32_16x16x32_bf16 v[44:47], a[24:27], a[252:255], v[44:47]
  ds_read_b128 a[232:235], v4 offset:10240
  buffer_load_dwordx4 a[20:23], v4, s[60:63], s92 offen offset:1024 sc1
  v_mfma_f32_16x16x32_bf16 v[40:43], a[24:27], a[248:251], v[40:43]
  v_and_b32 v123, s98, v179
  v_fma_f32 v116, v116, v132, v134
  v_mfma_f32_16x16x32_bf16 v[36:39], a[24:27], a[244:247], v[36:39]
  ds_read_b128 a[236:239], v4 offset:11264
  v_fma_f32 v117, v117, v132, v134
  v_mfma_f32_16x16x32_bf16 v[32:35], a[24:27], a[240:243], v[32:35]
  v_fma_f32 v118, v118, v132, v134
  v_fma_f32 v119, v119, v132, v134
  v_mfma_f32_16x16x32_bf16 v[48:51], a[28:31], a[240:243], v[48:51]
  buffer_load_dwordx4 a[24:27], v4, s[60:63], s92 offen offset:2048 sc1
  v_fma_f32 v120, v120, v132, v134
  v_mfma_f32_16x16x32_bf16 v[52:55], a[28:31], a[244:247], v[52:55]
  v_fma_f32 v121, v121, v132, v134
  v_fma_f32 v122, v122, v132, v134
  v_mfma_f32_16x16x32_bf16 v[56:59], a[28:31], a[248:251], v[56:59]
  v_fma_f32 v123, v123, v132, v134
  v_cvt_pk_bf16_f32 v176, v116, v117
  v_mfma_f32_16x16x32_bf16 v[60:63], a[28:31], a[252:255], v[60:63]
  v_cvt_pk_bf16_f32 v177, v118, v119
  v_cvt_pk_bf16_f32 v178, v120, v121
  v_mfma_f32_16x16x32_bf16 v[76:79], a[32:35], a[252:255], v[76:79]
  buffer_load_dwordx4 a[28:31], v4, s[60:63], s92 offen offset:3072 sc1
  v_cvt_pk_bf16_f32 v179, v122, v123
  v_mfma_f32_16x16x32_bf16 v[72:75], a[32:35], a[248:251], v[72:75]
  ds_write_b128 v6, v[176:179] offset:16384
  v_mfma_f32_16x16x32_bf16 v[68:71], a[32:35], a[244:247], v[68:71]
  s_waitcnt vmcnt(22)
  v_lshlrev_b32 v124, 16, v180
  v_and_b32 v125, s98, v180
  v_mfma_f32_16x16x32_bf16 v[64:67], a[32:35], a[240:243], v[64:67]
  v_lshlrev_b32 v126, 16, v181
  v_and_b32 v127, s98, v181
  v_mfma_f32_16x16x32_bf16 v[80:83], a[36:39], a[240:243], v[80:83]
  buffer_load_dwordx4 a[32:35], v255, s[60:63], s92 offen offset:0 sc1
  v_lshlrev_b32 v128, 16, v182
  v_mfma_f32_16x16x32_bf16 v[84:87], a[36:39], a[244:247], v[84:87]
  v_and_b32 v129, s98, v182
  v_lshlrev_b32 v130, 16, v183
  v_mfma_f32_16x16x32_bf16 v[88:91], a[36:39], a[248:251], v[88:91]
  v_and_b32 v131, s98, v183
  v_fma_f32 v124, v124, v132, v134
  v_mfma_f32_16x16x32_bf16 v[92:95], a[36:39], a[252:255], v[92:95]
  s_waitcnt lgkmcnt(1)
  v_fma_f32 v125, v125, v132, v134
  v_fma_f32 v126, v126, v132, v134
  v_mfma_f32_16x16x32_bf16 v[16:19], a[40:43], a[224:227], v[16:19]
  s_waitcnt lgkmcnt(0)
  s_barrier
  v_fma_f32 v127, v127, v132, v134
  v_mfma_f32_16x16x32_bf16 v[20:23], a[40:43], a[228:231], v[20:23]
  ds_read_b128 a[240:243], v4 offset:12288
  v_fma_f32 v128, v128, v132, v134
  v_mfma_f32_16x16x32_bf16 v[24:27], a[40:43], a[232:235], v[24:27]
  s_add_u32 s92, s92, 9216
  s_cmp_eq_u32 s92, s91
  s_cselect_b32 s92, s90, s92
  v_mfma_f32_16x16x32_bf16 v[28:31], a[40:43], a[236:239], v[28:31]
  ds_read_b128 a[244:247], v4 offset:13312
  buffer_load_dwordx4 a[36:39], v4, s[60:63], s92 offen offset:0 sc1
  v_mfma_f32_16x16x32_bf16 v[44:47], a[44:47], a[236:239], v[44:47]
  buffer_load_dwordx4 a[40:43], v4, s[60:63], s92 offen offset:1024 sc1
  v_fma_f32 v129, v129, v132, v134
  v_mfma_f32_16x16x32_bf16 v[40:43], a[44:47], a[232:235], v[40:43]
  ds_read_b128 a[248:251], v4 offset:14336
  v_fma_f32 v130, v130, v132, v134
  v_mfma_f32_16x16x32_bf16 v[36:39], a[44:47], a[228:231], v[36:39]
  v_fma_f32 v131, v131, v132, v134
  v_cvt_pk_bf16_f32 v180, v124, v125
  v_mfma_f32_16x16x32_bf16 v[32:35], a[44:47], a[224:227], v[32:35]
  ds_read_b128 a[252:255], v4 offset:15360
  v_cvt_pk_bf16_f32 v181, v126, v127
  v_mfma_f32_16x16x32_bf16 v[48:51], a[48:51], a[224:227], v[48:51]
  buffer_load_dwordx4 a[44:47], v4, s[60:63], s92 offen offset:2048 sc1
  v_cvt_pk_bf16_f32 v182, v128, v129
  v_mfma_f32_16x16x32_bf16 v[52:55], a[48:51], a[228:231], v[52:55]
  v_cvt_pk_bf16_f32 v183, v130, v131
  v_mfma_f32_16x16x32_bf16 v[56:59], a[48:51], a[232:235], v[56:59]
  ds_write_b128 v6, v[180:183] offset:20480
  v_mfma_f32_16x16x32_bf16 v[60:63], a[48:51], a[236:239], v[60:63]
  s_waitcnt vmcnt(25)
  v_lshlrev_b32 v116, 16, v184
  v_and_b32 v117, s98, v184
  v_mfma_f32_16x16x32_bf16 v[76:79], a[52:55], a[236:239], v[76:79]
  buffer_load_dwordx4 a[48:51], v4, s[60:63], s92 offen offset:3072 sc1
  v_lshlrev_b32 v118, 16, v185
  v_mfma_f32_16x16x32_bf16 v[72:75], a[52:55], a[232:235], v[72:75]
  v_and_b32 v119, s98, v185
  v_lshlrev_b32 v120, 16, v186
  v_mfma_f32_16x16x32_bf16 v[68:71], a[52:55], a[228:231], v[68:71]
  v_and_b32 v121, s98, v186
  v_lshlrev_b32 v122, 16, v187
  v_mfma_f32_16x16x32_bf16 v[64:67], a[52:55], a[224:227], v[64:67]
  v_and_b32 v123, s98, v187
  v_fma_f32 v116, v116, v132, v134
  v_mfma_f32_16x16x32_bf16 v[80:83], a[56:59], a[224:227], v[80:83]
  buffer_load_dwordx4 a[52:55], v255, s[60:63], s92 offen offset:0 sc1
  v_fma_f32 v117, v117, v132, v134
  v_mfma_f32_16x16x32_bf16 v[84:87], a[56:59], a[228:231], v[84:87]
  v_fma_f32 v118, v118, v132, v134
  v_fma_f32 v119, v119, v132, v134
  v_mfma_f32_16x16x32_bf16 v[88:91], a[56:59], a[232:235], v[88:91]
  v_fma_f32 v120, v120, v132, v134
  v_fma_f32 v121, v121, v132, v134
  v_mfma_f32_16x16x32_bf16 v[92:95], a[56:59], a[236:239], v[92:95]
  s_waitcnt lgkmcnt(1)
  v_fma_f32 v122, v122, v132, v134
  v_fma_f32 v123, v123, v132, v134
  v_mfma_f32_16x16x32_bf16 v[16:19], a[60:63], a[240:243], v[16:19]
  ds_read_b128 a[224:227], v4 offset:16384
  v_cvt_pk_bf16_f32 v184, v116, v117
  v_mfma_f32_16x16x32_bf16 v[20:23], a[60:63], a[244:247], v[20:23]
  s_add_u32 s92, s92, 9216
  s_cmp_eq_u32 s92, s91
  s_cselect_b32 s92, s90, s92
  v_mfma_f32_16x16x32_bf16 v[24:27], a[60:63], a[248:251], v[24:27]
  ds_read_b128 a[228:231], v4 offset:17408
  buffer_load_dwordx4 a[56:59], v4, s[60:63], s92 offen offset:0 sc1
  v_mfma_f32_16x16x32_bf16 v[28:31], a[60:63], a[252:255], v[28:31]
  v_cvt_pk_bf16_f32 v185, v118, v119
  v_cvt_pk_bf16_f32 v186, v120, v121
  v_mfma_f32_16x16x32_bf16 v[44:47], a[64:67], a[252:255], v[44:47]
  ds_read_b128 a[232:235], v4 offset:18432
  buffer_load_dwordx4 a[60:63], v4, s[60:63], s92 offen offset:1024 sc1
  v_mfma_f32_16x16x32_bf16 v[40:43], a[64:67], a[248:251], v[40:43]
  v_cvt_pk_bf16_f32 v187, v122, v123
  v_mfma_f32_16x16x32_bf16 v[36:39], a[64:67], a[244:247], v[36:39]
  ds_read_b128 a[236:239], v4 offset:19456
  v_mfma_f32_16x16x32_bf16 v[32:35], a[64:67], a[240:243], v[32:35]
  ds_write_b128 v6, v[184:187] offset:24576
  v_mfma_f32_16x16x32_bf16 v[48:51], a[68:71], a[240:243], v[48:51]
  buffer_load_dwordx4 a[64:67], v4, s[60:63], s92 offen offset:2048 sc1
  s_waitcnt vmcnt(29)
  v_lshlrev_b32 v124, 16, v188
  v_mfma_f32_16x16x32_bf16 v[52:55], a[68:71], a[244:247], v[52:55]
  v_and_b32 v125, s98, v188
  v_lshlrev_b32 v126, 16, v189
  v_mfma_f32_16x16x32_bf16 v[56:59], a[68:71], a[248:251], v[56:59]
  v_and_b32 v127, s98, v189
  v_lshlrev_b32 v128, 16, v190
  v_mfma_f32_16x16x32_bf16 v[60:63], a[68:71], a[252:255], v[60:63]
  v_and_b32 v129, s98, v190
  v_lshlrev_b32 v130, 16, v191
  v_mfma_f32_16x16x32_bf16 v[76:79], a[72:75], a[252:255], v[76:79]
  buffer_load_dwordx4 a[68:71], v4, s[60:63], s92 offen offset:3072 sc1
  v_and_b32 v131, s98, v191
  v_mfma_f32_16x16x32_bf16 v[72:75], a[72:75], a[248:251], v[72:75]
  v_fma_f32 v124, v124, v132, v134
  v_fma_f32 v125, v125, v132, v134
  v_mfma_f32_16x16x32_bf16 v[68:71], a[72:75], a[244:247], v[68:71]
  v_fma_f32 v126, v126, v132, v134
  v_fma_f32 v127, v127, v132, v134
  v_mfma_f32_16x16x32_bf16 v[64:67], a[72:75], a[240:243], v[64:67]
  v_fma_f32 v128, v128, v132, v134
  v_fma_f32 v129, v129, v132, v134
  v_mfma_f32_16x16x32_bf16 v[80:83], a[76:79], a[240:243], v[80:83]
  buffer_load_dwordx4 a[72:75], v255, s[60:63], s92 offen offset:0 sc1
  v_fma_f32 v130, v130, v132, v134
  v_mfma_f32_16x16x32_bf16 v[84:87], a[76:79], a[244:247], v[84:87]
  v_fma_f32 v131, v131, v132, v134
  v_cvt_pk_bf16_f32 v188, v124, v125
  v_mfma_f32_16x16x32_bf16 v[88:91], a[76:79], a[248:251], v[88:91]
  v_cvt_pk_bf16_f32 v189, v126, v127
  v_cvt_pk_bf16_f32 v190, v128, v129
  v_mfma_f32_16x16x32_bf16 v[92:95], a[76:79], a[252:255], v[92:95]
  s_waitcnt lgkmcnt(1)
  v_cvt_pk_bf16_f32 v191, v130, v131
  v_mfma_f32_16x16x32_bf16 v[16:19], a[80:83], a[224:227], v[16:19]
  ds_write_b128 v6, v[188:191] offset:28672
  s_waitcnt lgkmcnt(0)
  s_barrier
  s_waitcnt vmcnt(30)
  v_lshlrev_b32 v116, 16, v192
  v_mfma_f32_16x16x32_bf16 v[20:23], a[80:83], a[228:231], v[20:23]
  ds_read_b128 a[240:243], v4 offset:20480
  v_and_b32 v117, s98, v192
  v_mfma_f32_16x16x32_bf16 v[24:27], a[80:83], a[232:235], v[24:27]
  s_add_u32 s92, s92, 9216
  s_cmp_eq_u32 s92, s91
  s_cselect_b32 s92, s90, s92
  v_mfma_f32_16x16x32_bf16 v[28:31], a[80:83], a[236:239], v[28:31]
  ds_read_b128 a[244:247], v4 offset:21504
  buffer_load_dwordx4 a[76:79], v4, s[60:63], s92 offen offset:0 sc1
  v_mfma_f32_16x16x32_bf16 v[44:47], a[84:87], a[236:239], v[44:47]
  buffer_load_dwordx4 a[80:83], v4, s[60:63], s92 offen offset:1024 sc1
  v_lshlrev_b32 v118, 16, v193
  v_mfma_f32_16x16x32_bf16 v[40:43], a[84:87], a[232:235], v[40:43]
  ds_read_b128 a[248:251], v4 offset:22528
  v_and_b32 v119, s98, v193
  v_mfma_f32_16x16x32_bf16 v[36:39], a[84:87], a[228:231], v[36:39]
  v_lshlrev_b32 v120, 16, v194
  v_and_b32 v121, s98, v194
  v_mfma_f32_16x16x32_bf16 v[32:35], a[84:87], a[224:227], v[32:35]
  ds_read_b128 a[252:255], v4 offset:23552
  v_lshlrev_b32 v122, 16, v195
  v_mfma_f32_16x16x32_bf16 v[48:51], a[88:91], a[224:227], v[48:51]
  buffer_load_dwordx4 a[84:87], v4, s[60:63], s92 offen offset:2048 sc1
  v_and_b32 v123, s98, v195
  v_mfma_f32_16x16x32_bf16 v[52:55], a[88:91], a[228:231], v[52:55]
  v_fma_f32 v116, v116, v132, v134
  v_fma_f32 v117, v117, v132, v134
  v_mfma_f32_16x16x32_bf16 v[56:59], a[88:91], a[232:235], v[56:59]
  v_fma_f32 v118, v118, v132, v134
  v_fma_f32 v119, v119, v132, v134
  v_mfma_f32_16x16x32_bf16 v[60:63], a[88:91], a[236:239], v[60:63]
  v_fma_f32 v120, v120, v132, v134
  v_fma_f32 v121, v121, v132, v134
  v_mfma_f32_16x16x32_bf16 v[76:79], a[92:95], a[236:239], v[76:79]
  buffer_load_dwordx4 a[88:91], v4, s[60:63], s92 offen offset:3072 sc1
  v_fma_f32 v122, v122, v132, v134
  v_mfma_f32_16x16x32_bf16 v[72:75], a[92:95], a[232:235], v[72:75]
  v_fma_f32 v123, v123, v132, v134
  v_cvt_pk_bf16_f32 v192, v116, v117
  v_mfma_f32_16x16x32_bf16 v[68:71], a[92:95], a[228:231], v[68:71]
  v_cvt_pk_bf16_f32 v193, v118, v119
  v_cvt_pk_bf16_f32 v194, v120, v121
  v_mfma_f32_16x16x32_bf16 v[64:67], a[92:95], a[224:227], v[64:67]
  v_cvt_pk_bf16_f32 v195, v122, v123
  v_mfma_f32_16x16x32_bf16 v[80:83], a[96:99], a[224:227], v[80:83]
  buffer_load_dwordx4 a[92:95], v255, s[60:63], s92 offen offset:0 sc1
  v_mfma_f32_16x16x32_bf16 v[84:87], a[96:99], a[228:231], v[84:87]
  ds_write_b128 v6, v[192:195] offset:32768
  v_mfma_f32_16x16x32_bf16 v[88:91], a[96:99], a[232:235], v[88:91]
  s_waitcnt vmcnt(34)
  v_lshlrev_b32 v124, 16, v196
  v_and_b32 v125, s98, v196
  v_mfma_f32_16x16x32_bf16 v[92:95], a[96:99], a[236:239], v[92:95]
  s_waitcnt lgkmcnt(1)
  v_lshlrev_b32 v126, 16, v197
  v_and_b32 v127, s98, v197
  v_mfma_f32_16x16x32_bf16 v[16:19], a[100:103], a[240:243], v[16:19]
  ds_read_b128 a[224:227], v4 offset:24576
  v_lshlrev_b32 v128, 16, v198
  v_mfma_f32_16x16x32_bf16 v[20:23], a[100:103], a[244:247], v[20:23]
  s_add_u32 s92, s92, 9216
  s_cmp_eq_u32 s92, s91
  s_cselect_b32 s92, s90, s92
  v_mfma_f32_16x16x32_bf16 v[24:27], a[100:103], a[248:251], v[24:27]
  ds_read_b128 a[228:231], v4 offset:25600
  buffer_load_dwordx4 a[96:99], v4, s[60:63], s92 offen offset:0 sc1
  v_mfma_f32_16x16x32_bf16 v[28:31], a[100:103], a[252:255], v[28:31]
  v_and_b32 v129, s98, v198
  v_lshlrev_b32 v130, 16, v199
  v_mfma_f32_16x16x32_bf16 v[44:47], a[104:107], a[252:255], v[44:47]
  ds_read_b128 a[232:235], v4 offset:26624
  buffer_load_dwordx4 a[100:103], v4, s[60:63], s92 offen offset:1024 sc1
  v_mfma_f32_16x16x32_bf16 v[40:43], a[104:107], a[248:251], v[40:43]
  v_and_b32 v131, s98, v199
  v_fma_f32 v124, v124, v132, v134
  v_mfma_f32_16x16x32_bf16 v[36:39], a[104:107], a[244:247], v[36:39]
  ds_read_b128 a[236:239], v4 offset:27648
  v_fma_f32 v125, v125, v132, v134
  v_mfma_f32_16x16x32_bf16 v[32:35], a[104:107], a[240:243], v[32:35]
  v_fma_f32 v126, v126, v132, v134
  v_fma_f32 v127, v127, v132, v134
  v_mfma_f32_16x16x32_bf16 v[48:51], a[108:111], a[240:243], v[48:51]
  buffer_load_dwordx4 a[104:107], v4, s[60:63], s92 offen offset:2048 sc1
  v_fma_f32 v128, v128, v132, v134
  v_mfma_f32_16x16x32_bf16 v[52:55], a[108:111], a[244:247], v[52:55]
  v_fma_f32 v129, v129, v132, v134
  v_fma_f32 v130, v130, v132, v134
  v_mfma_f32_16x16x32_bf16 v[56:59], a[108:111], a[248:251], v[56:59]
  v_fma_f32 v131, v131, v132, v134
  v_cvt_pk_bf16_f32 v196, v124, v125
  v_mfma_f32_16x16x32_bf16 v[60:63], a[108:111], a[252:255], v[60:63]
  v_cvt_pk_bf16_f32 v197, v126, v127
  v_cvt_pk_bf16_f32 v198, v128, v129
  v_mfma_f32_16x16x32_bf16 v[76:79], a[112:115], a[252:255], v[76:79]
  buffer_load_dwordx4 a[108:111], v4, s[60:63], s92 offen offset:3072 sc1
  v_cvt_pk_bf16_f32 v199, v130, v131
  v_mfma_f32_16x16x32_bf16 v[72:75], a[112:115], a[248:251], v[72:75]
  ds_write_b128 v7, v[196:199] offset:0
  v_mfma_f32_16x16x32_bf16 v[68:71], a[112:115], a[244:247], v[68:71]
  s_waitcnt vmcnt(37)
  v_lshlrev_b32 v116, 16, v200
  v_and_b32 v117, s98, v200
  v_mfma_f32_16x16x32_bf16 v[64:67], a[112:115], a[240:243], v[64:67]
  v_lshlrev_b32 v118, 16, v201
  v_and_b32 v119, s98, v201
  v_mfma_f32_16x16x32_bf16 v[80:83], a[116:119], a[240:243], v[80:83]
  buffer_load_dwordx4 a[112:115], v255, s[60:63], s92 offen offset:0 sc1
  v_lshlrev_b32 v120, 16, v202
  v_mfma_f32_16x16x32_bf16 v[84:87], a[116:119], a[244:247], v[84:87]
  v_and_b32 v121, s98, v202
  v_lshlrev_b32 v122, 16, v203
  v_mfma_f32_16x16x32_bf16 v[88:91], a[116:119], a[248:251], v[88:91]
  v_and_b32 v123, s98, v203
  v_fma_f32 v116, v116, v132, v134
  v_mfma_f32_16x16x32_bf16 v[92:95], a[116:119], a[252:255], v[92:95]
  s_waitcnt lgkmcnt(1)
  v_fma_f32 v117, v117, v132, v134
  v_fma_f32 v118, v118, v132, v134
  v_mfma_f32_16x16x32_bf16 v[16:19], a[120:123], a[224:227], v[16:19]
  ds_read_b128 a[240:243], v4 offset:28672
  v_fma_f32 v119, v119, v132, v134
  v_mfma_f32_16x16x32_bf16 v[20:23], a[120:123], a[228:231], v[20:23]
  s_add_u32 s92, s92, 9216
  s_cmp_eq_u32 s92, s91
  s_cselect_b32 s92, s90, s92
  v_mfma_f32_16x16x32_bf16 v[24:27], a[120:123], a[232:235], v[24:27]
  ds_read_b128 a[244:247], v4 offset:29696
  buffer_load_dwordx4 a[116:119], v4, s[60:63], s92 offen offset:0 sc1
  v_mfma_f32_16x16x32_bf16 v[28:31], a[120:123], a[236:239], v[28:31]
  v_fma_f32 v120, v120, v132, v134
  v_fma_f32 v121, v121, v132, v134
  v_mfma_f32_16x16x32_bf16 v[44:47], a[124:127], a[236:239], v[44:47]
  ds_read_b128 a[248:251], v4 offset:30720
  buffer_load_dwordx4 a[120:123], v4, s[60:63], s92 offen offset:1024 sc1
  v_mfma_f32_16x16x32_bf16 v[40:43], a[124:127], a[232:235], v[40:43]
  v_fma_f32 v122, v122, v132, v134
  v_fma_f32 v123, v123, v132, v134
  v_mfma_f32_16x16x32_bf16 v[36:39], a[124:127], a[228:231], v[36:39]
  ds_read_b128 a[252:255], v4 offset:31744
  v_cvt_pk_bf16_f32 v200, v116, v117
  v_mfma_f32_16x16x32_bf16 v[32:35], a[124:127], a[224:227], v[32:35]
  v_cvt_pk_bf16_f32 v201, v118, v119
  v_cvt_pk_bf16_f32 v202, v120, v121
  v_mfma_f32_16x16x32_bf16 v[48:51], a[128:131], a[224:227], v[48:51]
  buffer_load_dwordx4 a[124:127], v4, s[60:63], s92 offen offset:2048 sc1
  v_cvt_pk_bf16_f32 v203, v122, v123
  v_mfma_f32_16x16x32_bf16 v[52:55], a[128:131], a[228:231], v[52:55]
  ds_write_b128 v7, v[200:203] offset:4096
  v_mfma_f32_16x16x32_bf16 v[56:59], a[128:131], a[232:235], v[56:59]
  s_waitcnt vmcnt(40)
  v_lshlrev_b32 v124, 16, v204
  v_and_b32 v125, s98, v204
  v_mfma_f32_16x16x32_bf16 v[60:63], a[128:131], a[236:239], v[60:63]
  v_lshlrev_b32 v126, 16, v205
  v_and_b32 v127, s98, v205
  v_mfma_f32_16x16x32_bf16 v[76:79], a[132:135], a[236:239], v[76:79]
  buffer_load_dwordx4 a[128:131], v4, s[60:63], s92 offen offset:3072 sc1
  v_lshlrev_b32 v128, 16, v206
  v_mfma_f32_16x16x32_bf16 v[72:75], a[132:135], a[232:235], v[72:75]
  v_and_b32 v129, s98, v206
  v_lshlrev_b32 v130, 16, v207
  v_mfma_f32_16x16x32_bf16 v[68:71], a[132:135], a[228:231], v[68:71]
  v_and_b32 v131, s98, v207
  v_fma_f32 v124, v124, v132, v134
  v_mfma_f32_16x16x32_bf16 v[64:67], a[132:135], a[224:227], v[64:67]
  v_fma_f32 v125, v125, v132, v134
  v_fma_f32 v126, v126, v132, v134
  v_mfma_f32_16x16x32_bf16 v[80:83], a[136:139], a[224:227], v[80:83]
  buffer_load_dwordx4 a[132:135], v255, s[60:63], s92 offen offset:0 sc1
  v_fma_f32 v127, v127, v132, v134
  v_mfma_f32_16x16x32_bf16 v[84:87], a[136:139], a[228:231], v[84:87]
  v_fma_f32 v128, v128, v132, v134
  v_fma_f32 v129, v129, v132, v134
  v_mfma_f32_16x16x32_bf16 v[88:91], a[136:139], a[232:235], v[88:91]
  v_fma_f32 v130, v130, v132, v134
  v_fma_f32 v131, v131, v132, v134
  v_mfma_f32_16x16x32_bf16 v[92:95], a[136:139], a[236:239], v[92:95]
  s_waitcnt lgkmcnt(1)
  v_cvt_pk_bf16_f32 v204, v124, v125
  v_cvt_pk_bf16_f32 v205, v126, v127
  v_mfma_f32_16x16x32_bf16 v[16:19], a[140:143], a[240:243], v[16:19]
  s_waitcnt lgkmcnt(0)
  s_barrier
  v_mov_b32 v5, s73
  buffer_store_dword v5, v14, s[60:63], 0 offen sc1
  v_mfma_f32_16x16x32_bf16 v[20:23], a[140:143], a[244:247], v[20:23]
  ds_read_b128 a[224:227], v4 offset:32768
  v_cvt_pk_bf16_f32 v206, v128, v129
  v_mfma_f32_16x16x32_bf16 v[24:27], a[140:143], a[248:251], v[24:27]
  s_mul_i32 s92, s1, 9216
  s_add_u32 s92, s92, s90
  v_mfma_f32_16x16x32_bf16 v[28:31], a[140:143], a[252:255], v[28:31]
  ds_read_b128 a[228:231], v4 offset:33792
  buffer_load_dwordx4 a[136:139], v12, s[60:63], s92 offen offset:0 sc1
  v_mfma_f32_16x16x32_bf16 v[44:47], a[144:147], a[252:255], v[44:47]
  buffer_load_dwordx4 a[140:143], v12, s[60:63], s92 offen offset:1024 sc1
  v_cvt_pk_bf16_f32 v207, v130, v131
  v_mfma_f32_16x16x32_bf16 v[40:43], a[144:147], a[248:251], v[40:43]
  ds_read_b128 a[232:235], v4 offset:34816
  v_mfma_f32_16x16x32_bf16 v[36:39], a[144:147], a[244:247], v[36:39]
  ds_write_b128 v7, v[204:207] offset:8192
  v_mfma_f32_16x16x32_bf16 v[32:35], a[144:147], a[240:243], v[32:35]
  ds_read_b128 a[236:239], v4 offset:35840
  s_waitcnt vmcnt(44)
  v_lshlrev_b32 v116, 16, v208
  v_mfma_f32_16x16x32_bf16 v[48:51], a[148:151], a[240:243], v[48:51]
  buffer_load_dwordx4 a[144:147], v12, s[60:63], s92 offen offset:2048 sc1
  v_and_b32 v117, s98, v208
  v_mfma_f32_16x16x32_bf16 v[52:55], a[148:151], a[244:247], v[52:55]
  v_lshlrev_b32 v118, 16, v209
  v_and_b32 v119, s98, v209
  v_mfma_f32_16x16x32_bf16 v[56:59], a[148:151], a[248:251], v[56:59]
  v_lshlrev_b32 v120, 16, v210
  v_and_b32 v121, s98, v210
  v_mfma_f32_16x16x32_bf16 v[60:63], a[148:151], a[252:255], v[60:63]
  v_lshlrev_b32 v122, 16, v211
  v_and_b32 v123, s98, v211
  v_mfma_f32_16x16x32_bf16 v[76:79], a[152:155], a[252:255], v[76:79]
  buffer_load_dwordx4 a[148:151], v12, s[60:63], s92 offen offset:3072 sc1
  v_fma_f32 v116, v116, v132, v134
  v_mfma_f32_16x16x32_bf16 v[72:75], a[152:155], a[248:251], v[72:75]
  v_fma_f32 v117, v117, v132, v134
  v_fma_f32 v118, v118, v132, v134
  v_mfma_f32_16x16x32_bf16 v[68:71], a[152:155], a[244:247], v[68:71]
  v_fma_f32 v119, v119, v132, v134
  v_fma_f32 v120, v120, v132, v134
  v_mfma_f32_16x16x32_bf16 v[64:67], a[152:155], a[240:243], v[64:67]
  v_fma_f32 v121, v121, v132, v134
  v_fma_f32 v122, v122, v132, v134
  v_mfma_f32_16x16x32_bf16 v[80:83], a[156:159], a[240:243], v[80:83]
  s_add_u32 s92, s92, 9216
  s_cmp_eq_u32 s92, s91
  s_cselect_b32 s92, s90, s92
  v_mfma_f32_16x16x32_bf16 v[84:87], a[156:159], a[244:247], v[84:87]
  buffer_load_dwordx4 a[152:155], v12, s[60:63], s92 offen offset:0 sc1
  v_fma_f32 v123, v123, v132, v134
  v_mfma_f32_16x16x32_bf16 v[88:91], a[156:159], a[248:251], v[88:91]
  v_cvt_pk_bf16_f32 v208, v116, v117
  v_cvt_pk_bf16_f32 v209, v118, v119
  v_mfma_f32_16x16x32_bf16 v[92:95], a[156:159], a[252:255], v[92:95]
  s_waitcnt lgkmcnt(0)
  v_cvt_pk_bf16_f32 v210, v120, v121
  v_cvt_pk_bf16_f32 v211, v122, v123
  v_mfma_f32_16x16x32_bf16 v[16:19], a[160:163], a[224:227], v[16:19]
  ds_read_b128 a[240:243], v8 offset:0
  buffer_load_dwordx4 a[156:159], v12, s[60:63], s92 offen offset:1024 sc1
  v_mfma_f32_16x16x32_bf16 v[20:23], a[160:163], a[228:231], v[20:23]
  ds_write_b128 v7, v[208:211] offset:12288
  v_mfma_f32_16x16x32_bf16 v[24:27], a[160:163], a[232:235], v[24:27]
  ds_read_b128 a[244:247], v8 offset:1024
  s_waitcnt vmcnt(47)
  v_lshlrev_b32 v124, 16, v212
  v_mfma_f32_16x16x32_bf16 v[28:31], a[160:163], a[236:239], v[28:31]
  v_and_b32 v125, s98, v212
  v_lshlrev_b32 v126, 16, v213
  v_mfma_f32_16x16x32_bf16 v[44:47], a[164:167], a[236:239], v[44:47]
  ds_read_b128 a[248:251], v8 offset:2048
  buffer_load_dwordx4 a[160:163], v12, s[60:63], s92 offen offset:2048 sc1
  v_mfma_f32_16x16x32_bf16 v[40:43], a[164:167], a[232:235], v[40:43]
  v_and_b32 v127, s98, v213
  v_lshlrev_b32 v128, 16, v214
  v_mfma_f32_16x16x32_bf16 v[36:39], a[164:167], a[228:231], v[36:39]
  ds_read_b128 a[252:255], v8 offset:3072
  v_and_b32 v129, s98, v214
  v_mfma_f32_16x16x32_bf16 v[32:35], a[164:167], a[224:227], v[32:35]
  v_lshlrev_b32 v130, 16, v215
  v_and_b32 v131, s98, v215
  v_mfma_f32_16x16x32_bf16 v[48:51], a[168:171], a[224:227], v[48:51]
  buffer_load_dwordx4 a[164:167], v12, s[60:63], s92 offen offset:3072 sc1
  v_fma_f32 v124, v124, v132, v134
  v_mfma_f32_16x16x32_bf16 v[52:55], a[168:171], a[228:231], v[52:55]
  v_fma_f32 v125, v125, v132, v134
  v_fma_f32 v126, v126, v132, v134
  v_mfma_f32_16x16x32_bf16 v[56:59], a[168:171], a[232:235], v[56:59]
  v_fma_f32 v127, v127, v132, v134
  v_fma_f32 v128, v128, v132, v134
  v_mfma_f32_16x16x32_bf16 v[60:63], a[168:171], a[236:239], v[60:63]
  v_fma_f32 v129, v129, v132, v134
  v_fma_f32 v130, v130, v132, v134
  v_mfma_f32_16x16x32_bf16 v[76:79], a[172:175], a[236:239], v[76:79]
  s_add_u32 s92, s92, 9216
  s_cmp_eq_u32 s92, s91
  s_cselect_b32 s92, s90, s92
  v_mfma_f32_16x16x32_bf16 v[72:75], a[172:175], a[232:235], v[72:75]
  buffer_load_dwordx4 a[168:171], v12, s[60:63], s92 offen offset:0 sc1
  v_fma_f32 v131, v131, v132, v134
  v_mfma_f32_16x16x32_bf16 v[68:71], a[172:175], a[228:231], v[68:71]
  v_cvt_pk_bf16_f32 v212, v124, v125
  v_cvt_pk_bf16_f32 v213, v126, v127
  v_mfma_f32_16x16x32_bf16 v[64:67], a[172:175], a[224:227], v[64:67]
  v_cvt_pk_bf16_f32 v214, v128, v129
  v_cvt_pk_bf16_f32 v215, v130, v131
  v_mfma_f32_16x16x32_bf16 v[80:83], a[176:179], a[224:227], v[80:83]
  buffer_load_dwordx4 a[172:175], v12, s[60:63], s92 offen offset:1024 sc1
  v_mfma_f32_16x16x32_bf16 v[84:87], a[176:179], a[228:231], v[84:87]
  ds_write_b128 v7, v[212:215] offset:16384
  v_mfma_f32_16x16x32_bf16 v[88:91], a[176:179], a[232:235], v[88:91]
  s_waitcnt vmcnt(50)
  v_lshlrev_b32 v116, 16, v216
  v_and_b32 v117, s98, v216
  v_mfma_f32_16x16x32_bf16 v[92:95], a[176:179], a[236:239], v[92:95]
  s_waitcnt lgkmcnt(1)
  v_lshlrev_b32 v118, 16, v217
  v_and_b32 v119, s98, v217
  v_mfma_f32_16x16x32_bf16 v[16:19], a[180:183], a[240:243], v[16:19]
  ds_read_b128 a[224:227], v8 offset:4096
  buffer_load_dwordx4 a[176:179], v12, s[60:63], s92 offen offset:2048 sc1
  v_mfma_f32_16x16x32_bf16 v[20:23], a[180:183], a[244:247], v[20:23]
  v_lshlrev_b32 v120, 16, v218
  v_and_b32 v121, s98, v218
  v_mfma_f32_16x16x32_bf16 v[24:27], a[180:183], a[248:251], v[24:27]
  ds_read_b128 a[228:231], v8 offset:5120
  v_lshlrev_b32 v122, 16, v219
  v_mfma_f32_16x16x32_bf16 v[28:31], a[180:183], a[252:255], v[28:31]
  v_and_b32 v123, s98, v219
  v_fma_f32 v116, v116, v132, v134
  v_mfma_f32_16x16x32_bf16 v[44:47], a[184:187], a[252:255], v[44:47]
  ds_read_b128 a[232:235], v8 offset:6144
  buffer_load_dwordx4 a[180:183], v12, s[60:63], s92 offen offset:3072 sc1
  v_mfma_f32_16x16x32_bf16 v[40:43], a[184:187], a[248:251], v[40:43]
  v_fma_f32 v117, v117, v132, v134
  v_fma_f32 v118, v118, v132, v134
  v_mfma_f32_16x16x32_bf16 v[36:39], a[184:187], a[244:247], v[36:39]
  ds_read_b128 a[236:239], v8 offset:7168
  v_fma_f32 v119, v119, v132, v134
  v_mfma_f32_16x16x32_bf16 v[32:35], a[184:187], a[240:243], v[32:35]
  v_fma_f32 v120, v120, v132, v134
  v_fma_f32 v121, v121, v132, v134
  v_mfma_f32_16x16x32_bf16 v[48:51], a[188:191], a[240:243], v[48:51]
  s_add_u32 s92, s92, 9216
  s_cmp_eq_u32 s92, s91
  s_cselect_b32 s92, s90, s92
  v_mfma_f32_16x16x32_bf16 v[52:55], a[188:191], a[244:247], v[52:55]
  buffer_load_dwordx4 a[184:187], v12, s[60:63], s92 offen offset:0 sc1
  v_fma_f32 v122, v122, v132, v134
  v_mfma_f32_16x16x32_bf16 v[56:59], a[188:191], a[248:251], v[56:59]
  v_fma_f32 v123, v123, v132, v134
  v_cvt_pk_bf16_f32 v216, v116, v117
  v_mfma_f32_16x16x32_bf16 v[60:63], a[188:191], a[252:255], v[60:63]
  v_cvt_pk_bf16_f32 v217, v118, v119
  v_cvt_pk_bf16_f32 v218, v120, v121
  v_mfma_f32_16x16x32_bf16 v[76:79], a[192:195], a[252:255], v[76:79]
  buffer_load_dwordx4 a[188:191], v12, s[60:63], s92 offen offset:1024 sc1
  v_cvt_pk_bf16_f32 v219, v122, v123
  v_mfma_f32_16x16x32_bf16 v[72:75], a[192:195], a[248:251], v[72:75]
  ds_write_b128 v7, v[216:219] offset:20480
  v_mfma_f32_16x16x32_bf16 v[68:71], a[192:195], a[244:247], v[68:71]
  s_waitcnt vmcnt(53)
  v_lshlrev_b32 v124, 16, v220
  v_and_b32 v125, s98, v220
  v_mfma_f32_16x16x32_bf16 v[64:67], a[192:195], a[240:243], v[64:67]
  v_lshlrev_b32 v126, 16, v221
  v_and_b32 v127, s98, v221
  v_mfma_f32_16x16x32_bf16 v[80:83], a[196:199], a[240:243], v[80:83]
  buffer_load_dwordx4 a[192:195], v12, s[60:63], s92 offen offset:2048 sc1
  v_lshlrev_b32 v128, 16, v222
  v_mfma_f32_16x16x32_bf16 v[84:87], a[196:199], a[244:247], v[84:87]
  v_and_b32 v129, s98, v222
  v_lshlrev_b32 v130, 16, v223
  v_mfma_f32_16x16x32_bf16 v[88:91], a[196:199], a[248:251], v[88:91]
  v_and_b32 v131, s98, v223
  v_fma_f32 v124, v124, v132, v134
  v_mfma_f32_16x16x32_bf16 v[92:95], a[196:199], a[252:255], v[92:95]
  s_waitcnt vmcnt(51) lgkmcnt(1)
  v_fma_f32 v125, v125, v132, v134
  v_fma_f32 v126, v126, v132, v134
  v_mfma_f32_16x16x32_bf16 v[16:19], a[200:203], a[224:227], v[16:19]
  s_waitcnt lgkmcnt(0)
  s_barrier
  buffer_load_dwordx4 a[196:199], v12, s[60:63], s92 offen offset:3072 sc1
  v_mfma_f32_16x16x32_bf16 v[20:23], a[200:203], a[228:231], v[20:23]
  ds_read_b128 a[240:243], v8 offset:8192
  v_fma_f32 v127, v127, v132, v134
  v_mfma_f32_16x16x32_bf16 v[24:27], a[200:203], a[232:235], v[24:27]
  v_fma_f32 v128, v128, v132, v134
  v_fma_f32 v129, v129, v132, v134
  v_mfma_f32_16x16x32_bf16 v[28:31], a[200:203], a[236:239], v[28:31]
  ds_read_b128 a[244:247], v8 offset:9216
  v_fma_f32 v130, v130, v132, v134
  v_mfma_f32_16x16x32_bf16 v[44:47], a[204:207], a[236:239], v[44:47]
  s_add_u32 s92, s92, 9216
  s_cmp_eq_u32 s92, s91
  s_cselect_b32 s92, s90, s92
  v_mfma_f32_16x16x32_bf16 v[40:43], a[204:207], a[232:235], v[40:43]
  ds_read_b128 a[248:251], v8 offset:10240
  buffer_load_dwordx4 a[200:203], v12, s[60:63], s92 offen offset:0 sc1
  v_mfma_f32_16x16x32_bf16 v[36:39], a[204:207], a[228:231], v[36:39]
  v_fma_f32 v131, v131, v132, v134
  v_cvt_pk_bf16_f32 v220, v124, v125
  v_mfma_f32_16x16x32_bf16 v[32:35], a[204:207], a[224:227], v[32:35]
  ds_read_b128 a[252:255], v8 offset:11264
  v_cvt_pk_bf16_f32 v221, v126, v127
  v_mfma_f32_16x16x32_bf16 v[48:51], a[208:211], a[224:227], v[48:51]
  buffer_load_dwordx4 a[204:207], v12, s[60:63], s92 offen offset:1024 sc1
  v_cvt_pk_bf16_f32 v222, v128, v129
  v_mfma_f32_16x16x32_bf16 v[52:55], a[208:211], a[228:231], v[52:55]
  v_cvt_pk_bf16_f32 v223, v130, v131
  v_mfma_f32_16x16x32_bf16 v[56:59], a[208:211], a[232:235], v[56:59]
  ds_write_b128 v7, v[220:223] offset:24576
  v_mfma_f32_16x16x32_bf16 v[60:63], a[208:211], a[236:239], v[60:63]
  v_lshlrev_b32 v116, 16, v224
  v_and_b32 v117, s98, v224
  v_mfma_f32_16x16x32_bf16 v[76:79], a[212:215], a[236:239], v[76:79]
  buffer_load_dwordx4 a[208:211], v12, s[60:63], s92 offen offset:2048 sc1
  v_lshlrev_b32 v118, 16, v225
  v_mfma_f32_16x16x32_bf16 v[72:75], a[212:215], a[232:235], v[72:75]
  v_and_b32 v119, s98, v225
  v_lshlrev_b32 v120, 16, v226
  v_mfma_f32_16x16x32_bf16 v[68:71], a[212:215], a[228:231], v[68:71]
  v_and_b32 v121, s98, v226
  v_lshlrev_b32 v122, 16, v227
  v_mfma_f32_16x16x32_bf16 v[64:67], a[212:215], a[224:227], v[64:67]
  v_and_b32 v123, s98, v227
  v_fma_f32 v116, v116, v132, v134
  v_mfma_f32_16x16x32_bf16 v[80:83], a[216:219], a[224:227], v[80:83]
  buffer_load_dwordx4 a[212:215], v12, s[60:63], s92 offen offset:3072 sc1
  v_fma_f32 v117, v117, v132, v134
  v_mfma_f32_16x16x32_bf16 v[84:87], a[216:219], a[228:231], v[84:87]
  v_fma_f32 v118, v118, v132, v134
  v_fma_f32 v119, v119, v132, v134
  v_mfma_f32_16x16x32_bf16 v[88:91], a[216:219], a[232:235], v[88:91]
  v_fma_f32 v120, v120, v132, v134
  v_fma_f32 v121, v121, v132, v134
  v_mfma_f32_16x16x32_bf16 v[92:95], a[216:219], a[236:239], v[92:95]
  s_waitcnt vmcnt(51) lgkmcnt(1)
  v_fma_f32 v122, v122, v132, v134
  v_fma_f32 v123, v123, v132, v134
  v_mfma_f32_16x16x32_bf16 v[16:19], a[220:223], a[240:243], v[16:19]
  ds_read_b128 a[224:227], v8 offset:12288
  v_cvt_pk_bf16_f32 v224, v116, v117
  v_mfma_f32_16x16x32_bf16 v[20:23], a[220:223], a[244:247], v[20:23]
  s_add_u32 s92, s92, 9216
  s_cmp_eq_u32 s92, s91
  s_cselect_b32 s92, s90, s92
  v_mfma_f32_16x16x32_bf16 v[24:27], a[220:223], a[248:251], v[24:27]
  ds_read_b128 a[228:231], v8 offset:13312
  buffer_load_dwordx4 a[216:219], v12, s[60:63], s92 offen offset:0 sc1
  v_mfma_f32_16x16x32_bf16 v[28:31], a[220:223], a[252:255], v[28:31]
  v_cvt_pk_bf16_f32 v225, v118, v119
  v_cvt_pk_bf16_f32 v226, v120, v121
  v_mfma_f32_16x16x32_bf16 v[44:47], a[0:3], a[252:255], v[44:47]
  ds_read_b128 a[232:235], v8 offset:14336
  buffer_load_dwordx4 a[220:223], v12, s[60:63], s92 offen offset:1024 sc1
  v_mfma_f32_16x16x32_bf16 v[40:43], a[0:3], a[248:251], v[40:43]
  v_cvt_pk_bf16_f32 v227, v122, v123
  v_mfma_f32_16x16x32_bf16 v[36:39], a[0:3], a[244:247], v[36:39]
  ds_read_b128 a[236:239], v8 offset:15360
  v_mfma_f32_16x16x32_bf16 v[32:35], a[0:3], a[240:243], v[32:35]
  ds_write_b128 v7, v[224:227] offset:28672
  v_mfma_f32_16x16x32_bf16 v[48:51], a[4:7], a[240:243], v[48:51]
  buffer_load_dwordx4 a[0:3], v12, s[60:63], s92 offen offset:2048 sc1
  v_lshlrev_b32 v124, 16, v228
  v_mfma_f32_16x16x32_bf16 v[52:55], a[4:7], a[244:247], v[52:55]
  v_and_b32 v125, s98, v228
  v_lshlrev_b32 v126, 16, v229
  v_mfma_f32_16x16x32_bf16 v[56:59], a[4:7], a[248:251], v[56:59]
  v_and_b32 v127, s98, v229
  v_lshlrev_b32 v128, 16, v230
  v_mfma_f32_16x16x32_bf16 v[60:63], a[4:7], a[252:255], v[60:63]
  v_and_b32 v129, s98, v230
  v_lshlrev_b32 v130, 16, v231
  v_mfma_f32_16x16x32_bf16 v[76:79], a[8:11], a[252:255], v[76:79]
  buffer_load_dwordx4 a[4:7], v12, s[60:63], s92 offen offset:3072 sc1
  v_and_b32 v131, s98, v231
  v_mfma_f32_16x16x32_bf16 v[72:75], a[8:11], a[248:251], v[72:75]
  v_fma_f32 v124, v124, v132, v134
  v_fma_f32 v125, v125, v132, v134
  v_mfma_f32_16x16x32_bf16 v[68:71], a[8:11], a[244:247], v[68:71]
  v_fma_f32 v126, v126, v132, v134
  v_fma_f32 v127, v127, v132, v134
  v_mfma_f32_16x16x32_bf16 v[64:67], a[8:11], a[240:243], v[64:67]
  v_fma_f32 v128, v128, v132, v134
  v_fma_f32 v129, v129, v132, v134
  v_mfma_f32_16x16x32_bf16 v[80:83], a[12:15], a[240:243], v[80:83]
  s_add_u32 s92, s92, 9216
  s_cmp_eq_u32 s92, s91
  s_cselect_b32 s92, s90, s92
  v_mfma_f32_16x16x32_bf16 v[84:87], a[12:15], a[244:247], v[84:87]
  buffer_load_dwordx4 a[8:11], v12, s[60:63], s92 offen offset:0 sc1
  v_fma_f32 v130, v130, v132, v134
  v_mfma_f32_16x16x32_bf16 v[88:91], a[12:15], a[248:251], v[88:91]
  v_fma_f32 v131, v131, v132, v134
  v_cvt_pk_bf16_f32 v228, v124, v125
  v_mfma_f32_16x16x32_bf16 v[92:95], a[12:15], a[252:255], v[92:95]
  s_waitcnt vmcnt(51) lgkmcnt(1)
  v_cvt_pk_bf16_f32 v229, v126, v127
  v_cvt_pk_bf16_f32 v230, v128, v129
  v_mfma_f32_16x16x32_bf16 v[16:19], a[16:19], a[224:227], v[16:19]
  ds_read_b128 a[240:243], v8 offset:16384
  buffer_load_dwordx4 a[12:15], v12, s[60:63], s92 offen offset:1024 sc1
  v_mfma_f32_16x16x32_bf16 v[20:23], a[16:19], a[228:231], v[20:23]
  v_cvt_pk_bf16_f32 v231, v130, v131
  v_mfma_f32_16x16x32_bf16 v[24:27], a[16:19], a[232:235], v[24:27]
  ds_read_b128 a[244:247], v8 offset:17408
  v_mfma_f32_16x16x32_bf16 v[28:31], a[16:19], a[236:239], v[28:31]
  ds_write_b128 v7, v[228:231] offset:32768
  v_mfma_f32_16x16x32_bf16 v[44:47], a[20:23], a[236:239], v[44:47]
  ds_read_b128 a[248:251], v8 offset:18432
  buffer_load_dwordx4 a[16:19], v12, s[60:63], s92 offen offset:2048 sc1
  v_mfma_f32_16x16x32_bf16 v[40:43], a[20:23], a[232:235], v[40:43]
  s_lshl_b32 s86, s72, 12
  s_add_u32 s86, s86, 491520
  v_mfma_f32_16x16x32_bf16 v[36:39], a[20:23], a[228:231], v[36:39]
  ds_read_b128 a[252:255], v8 offset:19456
  v_and_b32 v15, 31, v1
  v_mfma_f32_16x16x32_bf16 v[32:35], a[20:23], a[224:227], v[32:35]
  v_lshl_add_u32 v15, v15, 2, s86
  v_lshlrev_b32 v160, 16, v144
  v_mfma_f32_16x16x32_bf16 v[48:51], a[24:27], a[224:227], v[48:51]
  buffer_load_dwordx4 a[20:23], v12, s[60:63], s92 offen offset:3072 sc1
  v_and_b32 v161, s98, v144
  v_mfma_f32_16x16x32_bf16 v[52:55], a[24:27], a[228:231], v[52:55]
  v_lshlrev_b32 v162, 16, v145
  v_and_b32 v163, s98, v145
  v_mfma_f32_16x16x32_bf16 v[56:59], a[24:27], a[232:235], v[56:59]
  v_lshlrev_b32 v164, 16, v146
  v_and_b32 v165, s98, v146
  v_mfma_f32_16x16x32_bf16 v[60:63], a[24:27], a[236:239], v[60:63]
  v_lshlrev_b32 v166, 16, v147
  v_and_b32 v167, s98, v147
  v_mfma_f32_16x16x32_bf16 v[76:79], a[28:31], a[236:239], v[76:79]
  s_add_u32 s92, s92, 9216
  s_cmp_eq_u32 s92, s91
  s_cselect_b32 s92, s90, s92
  v_mfma_f32_16x16x32_bf16 v[72:75], a[28:31], a[232:235], v[72:75]
  buffer_load_dwordx4 a[24:27], v12, s[60:63], s92 offen offset:0 sc1
  v_lshlrev_b32 v168, 16, v148
  v_mfma_f32_16x16x32_bf16 v[68:71], a[28:31], a[228:231], v[68:71]
  v_and_b32 v169, s98, v148
  v_lshlrev_b32 v170, 16, v149
  v_mfma_f32_16x16x32_bf16 v[64:67], a[28:31], a[224:227], v[64:67]
  v_and_b32 v171, s98, v149
  v_lshlrev_b32 v172, 16, v150
  v_mfma_f32_16x16x32_bf16 v[80:83], a[32:35], a[224:227], v[80:83]
  buffer_load_dwordx4 a[28:31], v12, s[60:63], s92 offen offset:1024 sc1
  v_and_b32 v173, s98, v150
  v_mfma_f32_16x16x32_bf16 v[84:87], a[32:35], a[228:231], v[84:87]
  v_lshlrev_b32 v174, 16, v151
  v_and_b32 v175, s98, v151
  v_mfma_f32_16x16x32_bf16 v[88:91], a[32:35], a[232:235], v[88:91]
  s_lshl_b32 s84, s68, 1
  s_sub_u32 s84, s84, s93
  s_cselect_b32 s85, 10, 0
  v_mfma_f32_16x16x32_bf16 v[92:95], a[32:35], a[236:239], v[92:95]
  s_waitcnt vmcnt(51) lgkmcnt(0)
  s_add_u32 s84, s84, s85
  s_add_u32 s84, s84, 0
  s_lshl_b32 s84, s84, 12
  v_mfma_f32_16x16x32_bf16 v[16:19], a[36:39], a[240:243], v[16:19]
  ds_read_b128 a[224:227], v8 offset:20480
  buffer_load_dwordx4 a[32:35], v12, s[60:63], s92 offen offset:2048 sc1
  v_mfma_f32_16x16x32_bf16 v[20:23], a[36:39], a[244:247], v[20:23]
  v_add_u32 v192, s84, v9
  v_mfma_f32_16x16x32_bf16 v[24:27], a[36:39], a[248:251], v[24:27]
  ds_read_b128 a[228:231], v8 offset:21504
  v_mfma_f32_16x16x32_bf16 v[28:31], a[36:39], a[252:255], v[28:31]
  s_lshl_b32 s84, s68, 1
  s_add_u32 s84, s84, 1
  v_mfma_f32_16x16x32_bf16 v[44:47], a[40:43], a[252:255], v[44:47]
  ds_read_b128 a[232:235], v8 offset:22528
  buffer_load_dwordx4 a[36:39], v12, s[60:63], s92 offen offset:3072 sc1
  v_mfma_f32_16x16x32_bf16 v[40:43], a[40:43], a[248:251], v[40:43]
  s_sub_u32 s84, s84, s93
  s_cselect_b32 s85, 10, 0
  v_mfma_f32_16x16x32_bf16 v[36:39], a[40:43], a[244:247], v[36:39]
  ds_read_b128 a[236:239], v8 offset:23552
  v_mfma_f32_16x16x32_bf16 v[32:35], a[40:43], a[240:243], v[32:35]
  s_add_u32 s84, s84, s85
  s_add_u32 s84, s84, 0
  s_lshl_b32 s84, s84, 12
  v_mfma_f32_16x16x32_bf16 v[48:51], a[44:47], a[240:243], v[48:51]
  s_add_u32 s92, s92, 9216
  s_cmp_eq_u32 s92, s91
  s_cselect_b32 s92, s90, s92
  v_mfma_f32_16x16x32_bf16 v[52:55], a[44:47], a[244:247], v[52:55]
  buffer_load_dwordx4 a[40:43], v12, s[60:63], s92 offen offset:0 sc1
  v_add_u32 v193, s84, v9
  v_mfma_f32_16x16x32_bf16 v[56:59], a[44:47], a[248:251], v[56:59]
  s_lshr_b32 s84, s68, 1
  s_add_u32 s84, s84, 8
  v_mfma_f32_16x16x32_bf16 v[60:63], a[44:47], a[252:255], v[60:63]
  s_sub_u32 s84, s84, s93
  s_cselect_b32 s85, 10, 0
  v_mfma_f32_16x16x32_bf16 v[76:79], a[48:51], a[252:255], v[76:79]
  buffer_load_dwordx4 a[44:47], v12, s[60:63], s92 offen offset:1024 sc1
  v_mfma_f32_16x16x32_bf16 v[72:75], a[48:51], a[248:251], v[72:75]
  s_add_u32 s84, s84, s85
  s_add_u32 s84, s84, 0
  s_lshl_b32 s84, s84, 12
  v_mfma_f32_16x16x32_bf16 v[68:71], a[48:51], a[244:247], v[68:71]
  s_and_b32 s85, s68, 1
  s_lshl_b32 s85, s85, 3
  s_add_u32 s84, s84, s85
  v_mfma_f32_16x16x32_bf16 v[64:67], a[48:51], a[240:243], v[64:67]
  v_add_u32 v194, s84, v9
  s_lshl_b32 s84, s68, 1
  v_mfma_f32_16x16x32_bf16 v[80:83], a[52:55], a[240:243], v[80:83]
  buffer_load_dwordx4 a[48:51], v12, s[60:63], s92 offen offset:2048 sc1
  v_mfma_f32_16x16x32_bf16 v[84:87], a[52:55], a[244:247], v[84:87]
  s_sub_u32 s84, s84, s94
  s_cselect_b32 s85, 8, 0
  v_mfma_f32_16x16x32_bf16 v[88:91], a[52:55], a[248:251], v[88:91]
  s_add_u32 s84, s84, s85
  s_add_u32 s84, s84, 10
  s_lshl_b32 s84, s84, 12
  v_mfma_f32_16x16x32_bf16 v[92:95], a[52:55], a[252:255], v[92:95]
  s_waitcnt vmcnt(51) lgkmcnt(0)
  v_add_u32 v195, s84, v9
  v_mfma_f32_16x16x32_bf16 v[16:19], a[56:59], a[224:227], v[16:19]
  s_barrier
  buffer_load_dwordx4 a[52:55], v12, s[60:63], s92 offen offset:3072 sc1
  v_mfma_f32_16x16x32_bf16 v[20:23], a[56:59], a[228:231], v[20:23]
  ds_read_b128 a[240:243], v8 offset:24576
  v_mfma_f32_16x16x32_bf16 v[24:27], a[56:59], a[232:235], v[24:27]
  s_lshl_b32 s84, s68, 1
  s_add_u32 s84, s84, 1
  v_mfma_f32_16x16x32_bf16 v[28:31], a[56:59], a[236:239], v[28:31]
  ds_read_b128 a[244:247], v8 offset:25600
  v_mfma_f32_16x16x32_bf16 v[44:47], a[60:63], a[236:239], v[44:47]
  s_add_u32 s92, s92, 9216
  s_cmp_eq_u32 s92, s91
  s_cselect_b32 s92, s90, s92
  v_mfma_f32_16x16x32_bf16 v[40:43], a[60:63], a[232:235], v[40:43]
  ds_read_b128 a[248:251], v8 offset:26624
  buffer_load_dwordx4 a[56:59], v12, s[60:63], s92 offen offset:0 sc1
  v_mfma_f32_16x16x32_bf16 v[36:39], a[60:63], a[228:231], v[36:39]
  s_sub_u32 s84, s84, s94
  s_cselect_b32 s85, 8, 0
  v_mfma_f32_16x16x32_bf16 v[32:35], a[60:63], a[224:227], v[32:35]
  ds_read_b128 a[252:255], v8 offset:27648
  v_mfma_f32_16x16x32_bf16 v[48:51], a[64:67], a[224:227], v[48:51]
  buffer_load_dwordx4 a[60:63], v12, s[60:63], s92 offen offset:1024 sc1
  v_mfma_f32_16x16x32_bf16 v[52:55], a[64:67], a[228:231], v[52:55]
  s_add_u32 s84, s84, s85
  s_add_u32 s84, s84, 10
  s_lshl_b32 s84, s84, 12
  v_mfma_f32_16x16x32_bf16 v[56:59], a[64:67], a[232:235], v[56:59]
  v_add_u32 v196, s84, v9
  v_mfma_f32_16x16x32_bf16 v[60:63], a[64:67], a[236:239], v[60:63]
  v_mfma_f32_16x16x32_bf16 v[76:79], a[68:71], a[236:239], v[76:79]
  buffer_load_dwordx4 a[64:67], v12, s[60:63], s92 offen offset:2048 sc1
  v_mfma_f32_16x16x32_bf16 v[72:75], a[68:71], a[232:235], v[72:75]
  v_mfma_f32_16x16x32_bf16 v[68:71], a[68:71], a[228:231], v[68:71]
  v_mfma_f32_16x16x32_bf16 v[64:67], a[68:71], a[224:227], v[64:67]
  v_mfma_f32_16x16x32_bf16 v[80:83], a[72:75], a[224:227], v[80:83]
  buffer_load_dwordx4 a[68:71], v12, s[60:63], s92 offen offset:3072 sc1
  v_mfma_f32_16x16x32_bf16 v[84:87], a[72:75], a[228:231], v[84:87]
  v_mfma_f32_16x16x32_bf16 v[88:91], a[72:75], a[232:235], v[88:91]
  v_mfma_f32_16x16x32_bf16 v[92:95], a[72:75], a[236:239], v[92:95]
  s_waitcnt vmcnt(51) lgkmcnt(0)
  v_mfma_f32_16x16x32_bf16 v[16:19], a[76:79], a[240:243], v[16:19]
  ds_read_b128 a[224:227], v8 offset:28672
  v_mfma_f32_16x16x32_bf16 v[20:23], a[76:79], a[244:247], v[20:23]
  s_add_u32 s92, s92, 9216
  s_cmp_eq_u32 s92, s91
  s_cselect_b32 s92, s90, s92
  v_mfma_f32_16x16x32_bf16 v[24:27], a[76:79], a[248:251], v[24:27]
  ds_read_b128 a[228:231], v8 offset:29696
  buffer_load_dwordx4 a[72:75], v12, s[60:63], s92 offen offset:0 sc1
  v_mfma_f32_16x16x32_bf16 v[28:31], a[76:79], a[252:255], v[28:31]
  v_mfma_f32_16x16x32_bf16 v[44:47], a[80:83], a[252:255], v[44:47]
  ds_read_b128 a[232:235], v8 offset:30720
  buffer_load_dwordx4 a[76:79], v12, s[60:63], s92 offen offset:1024 sc1
  v_mfma_f32_16x16x32_bf16 v[40:43], a[80:83], a[248:251], v[40:43]
  v_mfma_f32_16x16x32_bf16 v[36:39], a[80:83], a[244:247], v[36:39]
  ds_read_b128 a[236:239], v8 offset:31744
  v_mfma_f32_16x16x32_bf16 v[32:35], a[80:83], a[240:243], v[32:35]
  v_mfma_f32_16x16x32_bf16 v[48:51], a[84:87], a[240:243], v[48:51]
  buffer_load_dwordx4 a[80:83], v12, s[60:63], s92 offen offset:2048 sc1
  v_mfma_f32_16x16x32_bf16 v[52:55], a[84:87], a[244:247], v[52:55]
  v_mfma_f32_16x16x32_bf16 v[56:59], a[84:87], a[248:251], v[56:59]
  v_mfma_f32_16x16x32_bf16 v[60:63], a[84:87], a[252:255], v[60:63]
  v_mfma_f32_16x16x32_bf16 v[76:79], a[88:91], a[252:255], v[76:79]
  buffer_load_dwordx4 a[84:87], v12, s[60:63], s92 offen offset:3072 sc1
  v_mfma_f32_16x16x32_bf16 v[72:75], a[88:91], a[248:251], v[72:75]
  v_mfma_f32_16x16x32_bf16 v[68:71], a[88:91], a[244:247], v[68:71]
  v_mfma_f32_16x16x32_bf16 v[64:67], a[88:91], a[240:243], v[64:67]
  v_mfma_f32_16x16x32_bf16 v[80:83], a[92:95], a[240:243], v[80:83]
  s_add_u32 s92, s92, 9216
  s_cmp_eq_u32 s92, s91
  s_cselect_b32 s92, s90, s92
  v_mfma_f32_16x16x32_bf16 v[84:87], a[92:95], a[244:247], v[84:87]
  buffer_load_dwordx4 a[88:91], v12, s[60:63], s92 offen offset:0 sc1
  v_mfma_f32_16x16x32_bf16 v[88:91], a[92:95], a[248:251], v[88:91]
  v_mfma_f32_16x16x32_bf16 v[92:95], a[92:95], a[252:255], v[92:95]
  s_waitcnt vmcnt(51) lgkmcnt(0)
  v_mfma_f32_16x16x32_bf16 v[16:19], a[96:99], a[224:227], v[16:19]
  ds_read_b128 a[240:243], v8 offset:32768
  buffer_load_dwordx4 a[92:95], v12, s[60:63], s92 offen offset:1024 sc1
  v_mfma_f32_16x16x32_bf16 v[20:23], a[96:99], a[228:231], v[20:23]
  v_mfma_f32_16x16x32_bf16 v[24:27], a[96:99], a[232:235], v[24:27]
  ds_read_b128 a[244:247], v8 offset:33792
  v_mfma_f32_16x16x32_bf16 v[28:31], a[96:99], a[236:239], v[28:31]
  v_mfma_f32_16x16x32_bf16 v[44:47], a[100:103], a[236:239], v[44:47]
  ds_read_b128 a[248:251], v8 offset:34816
  buffer_load_dwordx4 a[96:99], v12, s[60:63], s92 offen offset:2048 sc1
  v_mfma_f32_16x16x32_bf16 v[40:43], a[100:103], a[232:235], v[40:43]
  v_mfma_f32_16x16x32_bf16 v[36:39], a[100:103], a[228:231], v[36:39]
  ds_read_b128 a[252:255], v8 offset:35840
  v_mfma_f32_16x16x32_bf16 v[32:35], a[100:103], a[224:227], v[32:35]
  v_mfma_f32_16x16x32_bf16 v[48:51], a[104:107], a[224:227], v[48:51]
  buffer_load_dwordx4 a[100:103], v12, s[60:63], s92 offen offset:3072 sc1
  v_mfma_f32_16x16x32_bf16 v[52:55], a[104:107], a[228:231], v[52:55]
  v_mfma_f32_16x16x32_bf16 v[56:59], a[104:107], a[232:235], v[56:59]
  v_mfma_f32_16x16x32_bf16 v[60:63], a[104:107], a[236:239], v[60:63]
  v_mfma_f32_16x16x32_bf16 v[76:79], a[108:111], a[236:239], v[76:79]
  s_add_u32 s92, s92, 9216
  s_cmp_eq_u32 s92, s91
  s_cselect_b32 s92, s90, s92
  v_mfma_f32_16x16x32_bf16 v[72:75], a[108:111], a[232:235], v[72:75]
  buffer_load_dwordx4 a[104:107], v12, s[60:63], s92 offen offset:0 sc1
  v_mfma_f32_16x16x32_bf16 v[68:71], a[108:111], a[228:231], v[68:71]
  v_mfma_f32_16x16x32_bf16 v[64:67], a[108:111], a[224:227], v[64:67]
  v_mfma_f32_16x16x32_bf16 v[80:83], a[112:115], a[224:227], v[80:83]
  buffer_load_dwordx4 a[108:111], v12, s[60:63], s92 offen offset:1024 sc1
  v_mfma_f32_16x16x32_bf16 v[84:87], a[112:115], a[228:231], v[84:87]
  v_mfma_f32_16x16x32_bf16 v[88:91], a[112:115], a[232:235], v[88:91]
  v_mfma_f32_16x16x32_bf16 v[92:95], a[112:115], a[236:239], v[92:95]
  s_waitcnt vmcnt(51) lgkmcnt(0)
  v_mfma_f32_16x16x32_bf16 v[16:19], a[116:119], a[240:243], v[16:19]
  ds_read_b128 a[224:227], v4 offset:0
  buffer_load_dwordx4 a[112:115], v12, s[60:63], s92 offen offset:2048 sc1
  v_mfma_f32_16x16x32_bf16 v[20:23], a[116:119], a[244:247], v[20:23]
  v_mfma_f32_16x16x32_bf16 v[24:27], a[116:119], a[248:251], v[24:27]
  ds_read_b128 a[228:231], v4 offset:1024
  v_mfma_f32_16x16x32_bf16 v[28:31], a[116:119], a[252:255], v[28:31]
  v_mfma_f32_16x16x32_bf16 v[44:47], a[120:123], a[252:255], v[44:47]
  ds_read_b128 a[232:235], v4 offset:2048
  buffer_load_dwordx4 a[116:119], v12, s[60:63], s92 offen offset:3072 sc1
  v_mfma_f32_16x16x32_bf16 v[40:43], a[120:123], a[248:251], v[40:43]
  v_mfma_f32_16x16x32_bf16 v[36:39], a[120:123], a[244:247], v[36:39]
  ds_read_b128 a[236:239], v4 offset:3072
  v_mfma_f32_16x16x32_bf16 v[32:35], a[120:123], a[240:243], v[32:35]
  v_mfma_f32_16x16x32_bf16 v[48:51], a[124:127], a[240:243], v[48:51]
  s_add_u32 s92, s92, 9216
  s_cmp_eq_u32 s92, s91
  s_cselect_b32 s92, s90, s92
  v_mfma_f32_16x16x32_bf16 v[52:55], a[124:127], a[244:247], v[52:55]
  buffer_load_dwordx4 a[120:123], v12, s[60:63], s92 offen offset:0 sc1
  v_mfma_f32_16x16x32_bf16 v[56:59], a[124:127], a[248:251], v[56:59]
  v_mfma_f32_16x16x32_bf16 v[60:63], a[124:127], a[252:255], v[60:63]
  v_mfma_f32_16x16x32_bf16 v[76:79], a[128:131], a[252:255], v[76:79]
  buffer_load_dwordx4 a[124:127], v12, s[60:63], s92 offen offset:1024 sc1
  v_mfma_f32_16x16x32_bf16 v[72:75], a[128:131], a[248:251], v[72:75]
  v_mfma_f32_16x16x32_bf16 v[68:71], a[128:131], a[244:247], v[68:71]
  v_mfma_f32_16x16x32_bf16 v[64:67], a[128:131], a[240:243], v[64:67]
  v_mfma_f32_16x16x32_bf16 v[80:83], a[132:135], a[240:243], v[80:83]
  buffer_load_dwordx4 a[128:131], v12, s[60:63], s92 offen offset:2048 sc1
  v_mfma_f32_16x16x32_bf16 v[84:87], a[132:135], a[244:247], v[84:87]
  v_mfma_f32_16x16x32_bf16 v[88:91], a[132:135], a[248:251], v[88:91]
  v_mfma_f32_16x16x32_bf16 v[92:95], a[132:135], a[252:255], v[92:95]
  s_waitcnt vmcnt(51) lgkmcnt(0)
  v_mfma_f32_16x16x32_bf16 v[96:99], a[136:139], a[224:227], v[160:163]
  ds_read_b128 a[240:243], v4 offset:4096
  buffer_load_dwordx4 a[132:135], v12, s[60:63], s92 offen offset:3072 sc1
  v_mfma_f32_16x16x32_bf16 v[100:103], a[136:139], a[228:231], v[160:163]
  v_mfma_f32_16x16x32_bf16 v[104:107], a[136:139], a[232:235], v[160:163]
  ds_read_b128 a[244:247], v4 offset:5120
  v_mfma_f32_16x16x32_bf16 v[108:111], a[136:139], a[236:239], v[160:163]
  v_mul_f32 v16, v16, |v16|
  v_mul_f32 v17, v17, |v17|
  v_mfma_f32_16x16x32_bf16 v[124:127], a[140:143], a[236:239], v[164:167]
  ds_read_b128 a[248:251], v4 offset:6144
  buffer_load_dword v249, v15, s[60:63], 0 offen sc1
  v_mfma_f32_16x16x32_bf16 v[120:123], a[140:143], a[232:235], v[164:167]
  s_add_u32 s92, s92, 9216
  s_cmp_eq_u32 s92, s91
  s_cselect_b32 s92, s90, s92
  v_mfma_f32_16x16x32_bf16 v[116:119], a[140:143], a[228:231], v[164:167]
  ds_read_b128 a[252:255], v4 offset:7168
  buffer_load_dwordx4 a[136:139], v12, s[60:63], s92 offen offset:0 sc1
  v_mfma_f32_16x16x32_bf16 v[112:115], a[140:143], a[224:227], v[164:167]
  v_mul_f32 v18, v18, |v18|
  v_mul_f32 v19, v19, |v19|
  v_mfma_f32_16x16x32_bf16 v[128:131], a[144:147], a[224:227], v[168:171]
  buffer_load_dwordx4 a[140:143], v12, s[60:63], s92 offen offset:1024 sc1
  v_mul_f32 v32, v32, |v32|
  v_mfma_f32_16x16x32_bf16 v[132:135], a[144:147], a[228:231], v[168:171]
  v_mul_f32 v33, v33, |v33|
  v_mul_f32 v34, v34, |v34|
  v_mfma_f32_16x16x32_bf16 v[136:139], a[144:147], a[232:235], v[168:171]
  v_mul_f32 v35, v35, |v35|
  v_cvt_pk_bf16_f32 v176, v16, v17
  v_mfma_f32_16x16x32_bf16 v[140:143], a[144:147], a[236:239], v[168:171]
  v_cvt_pk_bf16_f32 v177, v18, v19
  v_cvt_pk_bf16_f32 v178, v32, v33
  v_mfma_f32_16x16x32_bf16 v[156:159], a[148:151], a[236:239], v[172:175]
  buffer_load_dwordx4 a[144:147], v12, s[60:63], s92 offen offset:2048 sc1
  v_cvt_pk_bf16_f32 v179, v34, v35
  v_mfma_f32_16x16x32_bf16 v[152:155], a[148:151], a[232:235], v[172:175]
  v_pk_max_i16 v176, v176, 0
  v_pk_max_i16 v177, v177, 0
  v_mfma_f32_16x16x32_bf16 v[148:151], a[148:151], a[228:231], v[172:175]
  v_pk_max_i16 v178, v178, 0
  v_pk_max_i16 v179, v179, 0
  v_mfma_f32_16x16x32_bf16 v[144:147], a[148:151], a[224:227], v[172:175]
  s_waitcnt vmcnt(52) lgkmcnt(0)
  ds_write_b128 v192, v[176:179] offset:0
  v_mfma_f32_16x16x32_bf16 v[96:99], a[152:155], a[240:243], v[96:99]
  ds_read_b128 a[224:227], v4 offset:8192
  buffer_load_dwordx4 a[148:151], v12, s[60:63], s92 offen offset:3072 sc1
  v_mfma_f32_16x16x32_bf16 v[100:103], a[152:155], a[244:247], v[100:103]
  v_mul_f32 v20, v20, |v20|
  v_mul_f32 v21, v21, |v21|
  v_mfma_f32_16x16x32_bf16 v[104:107], a[152:155], a[248:251], v[104:107]
  ds_read_b128 a[228:231], v4 offset:9216
  v_mul_f32 v22, v22, |v22|
  v_mfma_f32_16x16x32_bf16 v[108:111], a[152:155], a[252:255], v[108:111]
  v_mul_f32 v23, v23, |v23|
  v_mul_f32 v36, v36, |v36|
  v_mfma_f32_16x16x32_bf16 v[124:127], a[156:159], a[252:255], v[124:127]
  ds_read_b128 a[232:235], v4 offset:10240
  v_mul_f32 v37, v37, |v37|
  v_mfma_f32_16x16x32_bf16 v[120:123], a[156:159], a[248:251], v[120:123]
  s_add_u32 s92, s92, 9216
  s_cmp_eq_u32 s92, s91
  s_cselect_b32 s92, s90, s92
  v_mfma_f32_16x16x32_bf16 v[116:119], a[156:159], a[244:247], v[116:119]
  ds_read_b128 a[236:239], v4 offset:11264
  buffer_load_dwordx4 a[152:155], v12, s[60:63], s92 offen offset:0 sc1
  v_mfma_f32_16x16x32_bf16 v[112:115], a[156:159], a[240:243], v[112:115]
  v_mul_f32 v38, v38, |v38|
  v_mul_f32 v39, v39, |v39|
  v_mfma_f32_16x16x32_bf16 v[128:131], a[160:163], a[240:243], v[128:131]
  buffer_load_dwordx4 a[156:159], v12, s[60:63], s92 offen offset:1024 sc1
  v_cvt_pk_bf16_f32 v180, v20, v21
  v_mfma_f32_16x16x32_bf16 v[132:135], a[160:163], a[244:247], v[132:135]
  v_cvt_pk_bf16_f32 v181, v22, v23
  v_cvt_pk_bf16_f32 v182, v36, v37
  v_mfma_f32_16x16x32_bf16 v[136:139], a[160:163], a[248:251], v[136:139]
  v_cvt_pk_bf16_f32 v183, v38, v39
  v_pk_max_i16 v180, v180, 0
  v_mfma_f32_16x16x32_bf16 v[140:143], a[160:163], a[252:255], v[140:143]
  v_pk_max_i16 v181, v181, 0
  v_pk_max_i16 v182, v182, 0
  v_mfma_f32_16x16x32_bf16 v[156:159], a[164:167], a[252:255], v[156:159]
  buffer_load_dwordx4 a[160:163], v12, s[60:63], s92 offen offset:2048 sc1
  v_pk_max_i16 v183, v183, 0
  v_mfma_f32_16x16x32_bf16 v[152:155], a[164:167], a[248:251], v[152:155]
  ds_write_b128 v192, v[180:183] offset:1024
  v_mfma_f32_16x16x32_bf16 v[148:151], a[164:167], a[244:247], v[148:151]
  v_mul_f32 v24, v24, |v24|
  v_mul_f32 v25, v25, |v25|
  v_mfma_f32_16x16x32_bf16 v[144:147], a[164:167], a[240:243], v[144:147]
  s_waitcnt vmcnt(52) lgkmcnt(1)
  v_mul_f32 v26, v26, |v26|
  v_mul_f32 v27, v27, |v27|
  v_mfma_f32_16x16x32_bf16 v[96:99], a[168:171], a[224:227], v[96:99]
  ds_read_b128 a[240:243], v4 offset:12288
  buffer_load_dwordx4 a[164:167], v12, s[60:63], s92 offen offset:3072 sc1
  v_mfma_f32_16x16x32_bf16 v[100:103], a[168:171], a[228:231], v[100:103]
  v_mul_f32 v40, v40, |v40|
  v_mul_f32 v41, v41, |v41|
  v_mfma_f32_16x16x32_bf16 v[104:107], a[168:171], a[232:235], v[104:107]
  ds_read_b128 a[244:247], v4 offset:13312
  v_mul_f32 v42, v42, |v42|
  v_mfma_f32_16x16x32_bf16 v[108:111], a[168:171], a[236:239], v[108:111]
  v_mul_f32 v43, v43, |v43|
  v_cvt_pk_bf16_f32 v184, v24, v25
  v_mfma_f32_16x16x32_bf16 v[124:127], a[172:175], a[236:239], v[124:127]
  ds_read_b128 a[248:251], v4 offset:14336
  v_cvt_pk_bf16_f32 v185, v26, v27
  v_mfma_f32_16x16x32_bf16 v[120:123], a[172:175], a[232:235], v[120:123]
  s_add_u32 s92, s92, 9216
  s_cmp_eq_u32 s92, s91
  s_cselect_b32 s92, s90, s92
  v_mfma_f32_16x16x32_bf16 v[116:119], a[172:175], a[228:231], v[116:119]
  ds_read_b128 a[252:255], v4 offset:15360
  buffer_load_dwordx4 a[168:171], v12, s[60:63], s92 offen offset:0 sc1
  v_mfma_f32_16x16x32_bf16 v[112:115], a[172:175], a[224:227], v[112:115]
  v_cvt_pk_bf16_f32 v186, v40, v41
  v_cvt_pk_bf16_f32 v187, v42, v43
  v_mfma_f32_16x16x32_bf16 v[128:131], a[176:179], a[224:227], v[128:131]
  buffer_load_dwordx4 a[172:175], v12, s[60:63], s92 offen offset:1024 sc1
  v_pk_max_i16 v184, v184, 0
  v_mfma_f32_16x16x32_bf16 v[132:135], a[176:179], a[228:231], v[132:135]
  v_pk_max_i16 v185, v185, 0
  v_pk_max_i16 v186, v186, 0
  v_mfma_f32_16x16x32_bf16 v[136:139], a[176:179], a[232:235], v[136:139]
  v_pk_max_i16 v187, v187, 0
  v_mfma_f32_16x16x32_bf16 v[140:143], a[176:179], a[236:239], v[140:143]
  ds_write_b128 v192, v[184:187] offset:2048
  v_mfma_f32_16x16x32_bf16 v[156:159], a[180:183], a[236:239], v[156:159]
  buffer_load_dwordx4 a[176:179], v12, s[60:63], s92 offen offset:2048 sc1
  v_mul_f32 v28, v28, |v28|
  v_mfma_f32_16x16x32_bf16 v[152:155], a[180:183], a[232:235], v[152:155]
  v_mul_f32 v29, v29, |v29|
  v_mul_f32 v30, v30, |v30|
  v_mfma_f32_16x16x32_bf16 v[148:151], a[180:183], a[228:231], v[148:151]
  v_mul_f32 v31, v31, |v31|
  v_mul_f32 v44, v44, |v44|
  v_mfma_f32_16x16x32_bf16 v[144:147], a[180:183], a[224:227], v[144:147]
  s_waitcnt vmcnt(52) lgkmcnt(1)
  v_mul_f32 v45, v45, |v45|
  v_mul_f32 v46, v46, |v46|
  v_mfma_f32_16x16x32_bf16 v[96:99], a[184:187], a[240:243], v[96:99]
  ds_read_b128 a[224:227], v4 offset:16384
  buffer_load_dwordx4 a[180:183], v12, s[60:63], s92 offen offset:3072 sc1
  v_mfma_f32_16x16x32_bf16 v[100:103], a[184:187], a[244:247], v[100:103]
  v_mul_f32 v47, v47, |v47|
  v_cvt_pk_bf16_f32 v188, v28, v29
  v_mfma_f32_16x16x32_bf16 v[104:107], a[184:187], a[248:251], v[104:107]
  ds_read_b128 a[228:231], v4 offset:17408
  v_cvt_pk_bf16_f32 v189, v30, v31
  v_mfma_f32_16x16x32_bf16 v[108:111], a[184:187], a[252:255], v[108:111]
  v_cvt_pk_bf16_f32 v190, v44, v45
  v_cvt_pk_bf16_f32 v191, v46, v47
  v_mfma_f32_16x16x32_bf16 v[124:127], a[188:191], a[252:255], v[124:127]
  ds_read_b128 a[232:235], v4 offset:18432
  v_pk_max_i16 v188, v188, 0
  v_mfma_f32_16x16x32_bf16 v[120:123], a[188:191], a[248:251], v[120:123]
  s_add_u32 s92, s92, 9216
  s_cmp_eq_u32 s92, s91
  s_cselect_b32 s92, s90, s92
  v_mfma_f32_16x16x32_bf16 v[116:119], a[188:191], a[244:247], v[116:119]
  ds_read_b128 a[236:239], v4 offset:19456
  buffer_load_dwordx4 a[184:187], v12, s[60:63], s92 offen offset:0 sc1
  v_mfma_f32_16x16x32_bf16 v[112:115], a[188:191], a[240:243], v[112:115]
  v_pk_max_i16 v189, v189, 0
  v_pk_max_i16 v190, v190, 0
  v_mfma_f32_16x16x32_bf16 v[128:131], a[192:195], a[240:243], v[128:131]
  buffer_load_dwordx4 a[188:191], v12, s[60:63], s92 offen offset:1024 sc1
  v_pk_max_i16 v191, v191, 0
  v_mfma_f32_16x16x32_bf16 v[132:135], a[192:195], a[244:247], v[132:135]
  ds_write_b128 v192, v[188:191] offset:3072
  v_mfma_f32_16x16x32_bf16 v[136:139], a[192:195], a[248:251], v[136:139]
  v_mul_f32 v48, v48, |v48|
  v_mul_f32 v49, v49, |v49|
  v_mfma_f32_16x16x32_bf16 v[140:143], a[192:195], a[252:255], v[140:143]
  v_mul_f32 v50, v50, |v50|
  v_mul_f32 v51, v51, |v51|
  v_mfma_f32_16x16x32_bf16 v[156:159], a[196:199], a[252:255], v[156:159]
  buffer_load_dwordx4 a[192:195], v12, s[60:63], s92 offen offset:2048 sc1
  v_mul_f32 v64, v64, |v64|
  v_mfma_f32_16x16x32_bf16 v[152:155], a[196:199], a[248:251], v[152:155]
  v_mul_f32 v65, v65, |v65|
  v_mul_f32 v66, v66, |v66|
  v_mfma_f32_16x16x32_bf16 v[148:151], a[196:199], a[244:247], v[148:151]
  v_mul_f32 v67, v67, |v67|
  v_cvt_pk_bf16_f32 v176, v48, v49
  v_mfma_f32_16x16x32_bf16 v[144:147], a[196:199], a[240:243], v[144:147]
  s_waitcnt vmcnt(52) lgkmcnt(1)
  v_cvt_pk_bf16_f32 v177, v50, v51
  v_cvt_pk_bf16_f32 v178, v64, v65
  v_mfma_f32_16x16x32_bf16 v[96:99], a[200:203], a[224:227], v[96:99]
  ds_read_b128 a[240:243], v4 offset:20480
  buffer_load_dwordx4 a[196:199], v12, s[60:63], s92 offen offset:3072 sc1
  v_mfma_f32_16x16x32_bf16 v[100:103], a[200:203], a[228:231], v[100:103]
  v_cvt_pk_bf16_f32 v179, v66, v67
  v_pk_max_i16 v176, v176, 0
  v_mfma_f32_16x16x32_bf16 v[104:107], a[200:203], a[232:235], v[104:107]
  ds_read_b128 a[244:247], v4 offset:21504
  v_pk_max_i16 v177, v177, 0
  v_mfma_f32_16x16x32_bf16 v[108:111], a[200:203], a[236:239], v[108:111]
  v_pk_max_i16 v178, v178, 0
  v_pk_max_i16 v179, v179, 0
  v_mfma_f32_16x16x32_bf16 v[124:127], a[204:207], a[236:239], v[124:127]
  ds_read_b128 a[248:251], v4 offset:22528
  v_mfma_f32_16x16x32_bf16 v[120:123], a[204:207], a[232:235], v[120:123]
  s_waitcnt vmcnt(16)
  v_cmp_ne_u32 vcc, s73, v249
  s_cbranch_vccnz L_slow4
L_back4:
  v_mfma_f32_16x16x32_bf16 v[116:119], a[204:207], a[228:231], v[116:119]
  ds_read_b128 a[252:255], v4 offset:23552
  v_mfma_f32_16x16x32_bf16 v[112:115], a[204:207], a[224:227], v[112:115]
  s_add_u32 s90, s89, 0
  s_add_u32 s91, s89, 92160
  v_mfma_f32_16x16x32_bf16 v[128:131], a[208:211], a[224:227], v[128:131]
  s_mul_i32 s92, s93, 9216
  s_add_u32 s92, s92, s90
  v_mfma_f32_16x16x32_bf16 v[132:135], a[208:211], a[228:231], v[132:135]
  buffer_load_dwordx4 a[200:203], v4, s[60:63], s92 offen offset:0 sc1
  v_mfma_f32_16x16x32_bf16 v[136:139], a[208:211], a[232:235], v[136:139]
  buffer_load_dwordx4 a[204:207], v4, s[60:63], s92 offen offset:1024 sc1
  v_mfma_f32_16x16x32_bf16 v[140:143], a[208:211], a[236:239], v[140:143]
  ds_write_b128 v193, v[176:179] offset:0
  v_mfma_f32_16x16x32_bf16 v[156:159], a[212:215], a[236:239], v[156:159]
  buffer_load_dwordx4 a[208:211], v4, s[60:63], s92 offen offset:2048 sc1
  v_mul_f32 v52, v52, |v52|
  v_mfma_f32_16x16x32_bf16 v[152:155], a[212:215], a[232:235], v[152:155]
  v_mul_f32 v53, v53, |v53|
  v_mul_f32 v54, v54, |v54|
  v_mfma_f32_16x16x32_bf16 v[148:151], a[212:215], a[228:231], v[148:151]
  v_mul_f32 v55, v55, |v55|
  v_mul_f32 v68, v68, |v68|
  v_mfma_f32_16x16x32_bf16 v[144:147], a[212:215], a[224:227], v[144:147]
  s_waitcnt lgkmcnt(1)
  v_mul_f32 v69, v69, |v69|
  v_mul_f32 v70, v70, |v70|
  v_mfma_f32_16x16x32_bf16 v[96:99], a[216:219], a[240:243], v[96:99]
  ds_read_b128 a[224:227], v4 offset:24576
  buffer_load_dwordx4 a[212:215], v4, s[60:63], s92 offen offset:3072 sc1
  v_mfma_f32_16x16x32_bf16 v[100:103], a[216:219], a[244:247], v[100:103]
  v_mul_f32 v71, v71, |v71|
  v_cvt_pk_bf16_f32 v180, v52, v53
  v_mfma_f32_16x16x32_bf16 v[104:107], a[216:219], a[248:251], v[104:107]
  ds_read_b128 a[228:231], v4 offset:25600
  v_cvt_pk_bf16_f32 v181, v54, v55
  v_mfma_f32_16x16x32_bf16 v[108:111], a[216:219], a[252:255], v[108:111]
  v_cvt_pk_bf16_f32 v182, v68, v69
  v_cvt_pk_bf16_f32 v183, v70, v71
  v_mfma_f32_16x16x32_bf16 v[124:127], a[220:223], a[252:255], v[124:127]
  ds_read_b128 a[232:235], v4 offset:26624
  buffer_load_dwordx4 a[216:219], v255, s[60:63], s92 offen offset:0 sc1
  v_mfma_f32_16x16x32_bf16 v[120:123], a[220:223], a[248:251], v[120:123]
  v_pk_max_i16 v180, v180, 0
  v_pk_max_i16 v181, v181, 0
  v_mfma_f32_16x16x32_bf16 v[116:119], a[220:223], a[244:247], v[116:119]
  ds_read_b128 a[236:239], v4 offset:27648
  v_pk_max_i16 v182, v182, 0
  v_mfma_f32_16x16x32_bf16 v[112:115], a[220:223], a[240:243], v[112:115]
  v_pk_max_i16 v183, v183, 0
  v_mfma_f32_16x16x32_bf16 v[128:131], a[0:3], a[240:243], v[128:131]
  s_add_u32 s92, s92, 9216
  s_cmp_eq_u32 s92, s91
  s_cselect_b32 s92, s90, s92
  v_mfma_f32_16x16x32_bf16 v[132:135], a[0:3], a[244:247], v[132:135]
  buffer_load_dwordx4 a[220:223], v4, s[60:63], s92 offen offset:0 sc1
  v_mfma_f32_16x16x32_bf16 v[136:139], a[0:3], a[248:251], v[136:139]
  ds_write_b128 v193, v[180:183] offset:1024
  v_mfma_f32_16x16x32_bf16 v[140:143], a[0:3], a[252:255], v[140:143]
  v_mul_f32 v56, v56, |v56|
  v_mul_f32 v57, v57, |v57|
  v_mfma_f32_16x16x32_bf16 v[156:159], a[4:7], a[252:255], v[156:159]
  buffer_load_dwordx4 a[0:3], v4, s[60:63], s92 offen offset:1024 sc1
  v_mul_f32 v58, v58, |v58|
  v_mfma_f32_16x16x32_bf16 v[152:155], a[4:7], a[248:251], v[152:155]
  v_mul_f32 v59, v59, |v59|
  v_mul_f32 v72, v72, |v72|
  v_mfma_f32_16x16x32_bf16 v[148:151], a[4:7], a[244:247], v[148:151]
  v_mul_f32 v73, v73, |v73|
  v_mul_f32 v74, v74, |v74|
  v_mfma_f32_16x16x32_bf16 v[144:147], a[4:7], a[240:243], v[144:147]
  s_waitcnt lgkmcnt(1)
  v_mul_f32 v75, v75, |v75|
  v_cvt_pk_bf16_f32 v184, v56, v57
  v_mfma_f32_16x16x32_bf16 v[96:99], a[8:11], a[224:227], v[96:99]
  ds_read_b128 a[240:243], v4 offset:28672
  buffer_load_dwordx4 a[4:7], v4, s[60:63], s92 offen offset:2048 sc1
  v_mfma_f32_16x16x32_bf16 v[100:103], a[8:11], a[228:231], v[100:103]
  v_cvt_pk_bf16_f32 v185, v58, v59
  v_cvt_pk_bf16_f32 v186, v72, v73
  v_mfma_f32_16x16x32_bf16 v[104:107], a[8:11], a[232:235], v[104:107]
  ds_read_b128 a[244:247], v4 offset:29696
  v_cvt_pk_bf16_f32 v187, v74, v75
  v_mfma_f32_16x16x32_bf16 v[108:111], a[8:11], a[236:239], v[108:111]
  v_pk_max_i16 v184, v184, 0
  v_pk_max_i16 v185, v185, 0
  v_mfma_f32_16x16x32_bf16 v[124:127], a[12:15], a[236:239], v[124:127]
  ds_read_b128 a[248:251], v4 offset:30720
  buffer_load_dwordx4 a[8:11], v4, s[60:63], s92 offen offset:3072 sc1
  v_mfma_f32_16x16x32_bf16 v[120:123], a[12:15], a[232:235], v[120:123]
  v_pk_max_i16 v186, v186, 0
  v_pk_max_i16 v187, v187, 0
  v_mfma_f32_16x16x32_bf16 v[116:119], a[12:15], a[228:231], v[116:119]
  ds_read_b128 a[252:255], v4 offset:31744
  v_mfma_f32_16x16x32_bf16 v[112:115], a[12:15], a[224:227], v[112:115]
  ds_write_b128 v193, v[184:187] offset:2048
  v_mfma_f32_16x16x32_bf16 v[128:131], a[16:19], a[224:227], v[128:131]
  buffer_load_dwordx4 a[12:15], v255, s[60:63], s92 offen offset:0 sc1
  v_mul_f32 v60, v60, |v60|
  v_mfma_f32_16x16x32_bf16 v[132:135], a[16:19], a[228:231], v[132:135]
  v_mul_f32 v61, v61, |v61|
  v_mul_f32 v62, v62, |v62|
  v_mfma_f32_16x16x32_bf16 v[136:139], a[16:19], a[232:235], v[136:139]
  v_mul_f32 v63, v63, |v63|
  v_mul_f32 v76, v76, |v76|
  v_mfma_f32_16x16x32_bf16 v[140:143], a[16:19], a[236:239], v[140:143]
  v_mul_f32 v77, v77, |v77|
  v_mul_f32 v78, v78, |v78|
  v_mfma_f32_16x16x32_bf16 v[156:159], a[20:23], a[236:239], v[156:159]
  s_add_u32 s92, s92, 9216
  s_cmp_eq_u32 s92, s91
  s_cselect_b32 s92, s90, s92
  v_mfma_f32_16x16x32_bf16 v[152:155], a[20:23], a[232:235], v[152:155]
  buffer_load_dwordx4 a[16:19], v4, s[60:63], s92 offen offset:0 sc1
  v_mul_f32 v79, v79, |v79|
  v_mfma_f32_16x16x32_bf16 v[148:151], a[20:23], a[228:231], v[148:151]
  v_cvt_pk_bf16_f32 v188, v60, v61
  v_cvt_pk_bf16_f32 v189, v62, v63
  v_mfma_f32_16x16x32_bf16 v[144:147], a[20:23], a[224:227], v[144:147]
  s_waitcnt lgkmcnt(1)
  v_cvt_pk_bf16_f32 v190, v76, v77
  v_cvt_pk_bf16_f32 v191, v78, v79
  v_mfma_f32_16x16x32_bf16 v[96:99], a[24:27], a[240:243], v[96:99]
  ds_read_b128 a[224:227], v4 offset:32768
  buffer_load_dwordx4 a[20:23], v4, s[60:63], s92 offen offset:1024 sc1
  v_mfma_f32_16x16x32_bf16 v[100:103], a[24:27], a[244:247], v[100:103]
  v_pk_max_i16 v188, v188, 0
  v_pk_max_i16 v189, v189, 0
  v_mfma_f32_16x16x32_bf16 v[104:107], a[24:27], a[248:251], v[104:107]
  ds_read_b128 a[228:231], v4 offset:33792
  v_pk_max_i16 v190, v190, 0
  v_mfma_f32_16x16x32_bf16 v[108:111], a[24:27], a[252:255], v[108:111]
  v_pk_max_i16 v191, v191, 0
  v_mfma_f32_16x16x32_bf16 v[124:127], a[28:31], a[252:255], v[124:127]
  ds_read_b128 a[232:235], v4 offset:34816
  buffer_load_dwordx4 a[24:27], v4, s[60:63], s92 offen offset:2048 sc1
  v_mfma_f32_16x16x32_bf16 v[120:123], a[28:31], a[248:251], v[120:123]
  ds_write_b128 v193, v[188:191] offset:3072
  v_mfma_f32_16x16x32_bf16 v[116:119], a[28:31], a[244:247], v[116:119]
  ds_read_b128 a[236:239], v4 offset:35840
  v_mul_f32 v80, v80, |v80|
  v_mfma_f32_16x16x32_bf16 v[112:115], a[28:31], a[240:243], v[112:115]
  v_mul_f32 v81, v81, |v81|
  v_mul_f32 v82, v82, |v82|
  v_mfma_f32_16x16x32_bf16 v[128:131], a[32:35], a[240:243], v[128:131]
  buffer_load_dwordx4 a[28:31], v4, s[60:63], s92 offen offset:3072 sc1
  v_mul_f32 v83, v83, |v83|
  v_mfma_f32_16x16x32_bf16 v[132:135], a[32:35], a[244:247], v[132:135]
  v_cvt_pk_bf16_f32 v176, v80, v81
  v_cvt_pk_bf16_f32 v177, v82, v83
  v_mfma_f32_16x16x32_bf16 v[136:139], a[32:35], a[248:251], v[136:139]
  v_pk_max_i16 v176, v176, 0
  v_pk_max_i16 v177, v177, 0
  v_mfma_f32_16x16x32_bf16 v[140:143], a[32:35], a[252:255], v[140:143]
  ds_write_b64 v194, v[176:177] offset:0
  v_mul_f32 v84, v84, |v84|
  v_mfma_f32_16x16x32_bf16 v[156:159], a[36:39], a[252:255], v[156:159]
  buffer_load_dwordx4 a[32:35], v255, s[60:63], s92 offen offset:0 sc1
  v_mul_f32 v85, v85, |v85|
  v_mfma_f32_16x16x32_bf16 v[152:155], a[36:39], a[248:251], v[152:155]
  v_mul_f32 v86, v86, |v86|
  v_mul_f32 v87, v87, |v87|
  v_mfma_f32_16x16x32_bf16 v[148:151], a[36:39], a[244:247], v[148:151]
  v_cvt_pk_bf16_f32 v180, v84, v85
  v_cvt_pk_bf16_f32 v181, v86, v87
  v_mfma_f32_16x16x32_bf16 v[144:147], a[36:39], a[240:243], v[144:147]
  s_waitcnt lgkmcnt(1)
  v_pk_max_i16 v180, v180, 0
  v_pk_max_i16 v181, v181, 0
  v_mfma_f32_16x16x32_bf16 v[96:99], a[40:43], a[224:227], v[96:99]
  ds_read_b128 a[240:243], v8 offset:0
  ds_write_b64 v194, v[180:181] offset:1024
  v_mfma_f32_16x16x32_bf16 v[100:103], a[40:43], a[228:231], v[100:103]
  s_add_u32 s92, s92, 9216
  s_cmp_eq_u32 s92, s91
  s_cselect_b32 s92, s90, s92
  v_mfma_f32_16x16x32_bf16 v[104:107], a[40:43], a[232:235], v[104:107]
  ds_read_b128 a[244:247], v8 offset:1024
  buffer_load_dwordx4 a[36:39], v4, s[60:63], s92 offen offset:0 sc1
  v_mfma_f32_16x16x32_bf16 v[108:111], a[40:43], a[236:239], v[108:111]
  v_mul_f32 v88, v88, |v88|
  v_mul_f32 v89, v89, |v89|
  v_mfma_f32_16x16x32_bf16 v[124:127], a[44:47], a[236:239], v[124:127]
  ds_read_b128 a[248:251], v8 offset:2048
  buffer_load_dwordx4 a[40:43], v4, s[60:63], s92 offen offset:1024 sc1
  v_mfma_f32_16x16x32_bf16 v[120:123], a[44:47], a[232:235], v[120:123]
  v_mul_f32 v90, v90, |v90|
  v_mul_f32 v91, v91, |v91|
  v_mfma_f32_16x16x32_bf16 v[116:119], a[44:47], a[228:231], v[116:119]
  ds_read_b128 a[252:255], v8 offset:3072
  v_cvt_pk_bf16_f32 v184, v88, v89
  v_mfma_f32_16x16x32_bf16 v[112:115], a[44:47], a[224:227], v[112:115]
  v_cvt_pk_bf16_f32 v185, v90, v91
  v_pk_max_i16 v184, v184, 0
  v_mfma_f32_16x16x32_bf16 v[128:131], a[48:51], a[224:227], v[128:131]
  buffer_load_dwordx4 a[44:47], v4, s[60:63], s92 offen offset:2048 sc1
  v_pk_max_i16 v185, v185, 0
  v_mfma_f32_16x16x32_bf16 v[132:135], a[48:51], a[228:231], v[132:135]
  ds_write_b64 v194, v[184:185] offset:2048
  v_mul_f32 v92, v92, |v92|
  v_mfma_f32_16x16x32_bf16 v[136:139], a[48:51], a[232:235], v[136:139]
  v_mul_f32 v93, v93, |v93|
  v_mul_f32 v94, v94, |v94|
  v_mfma_f32_16x16x32_bf16 v[140:143], a[48:51], a[236:239], v[140:143]
  v_mul_f32 v95, v95, |v95|
  v_cvt_pk_bf16_f32 v188, v92, v93
  v_mfma_f32_16x16x32_bf16 v[156:159], a[52:55], a[236:239], v[156:159]
  buffer_load_dwordx4 a[48:51], v4, s[60:63], s92 offen offset:3072 sc1
  v_cvt_pk_bf16_f32 v189, v94, v95
  v_mfma_f32_16x16x32_bf16 v[152:155], a[52:55], a[232:235], v[152:155]
  v_pk_max_i16 v188, v188, 0
  v_pk_max_i16 v189, v189, 0
  v_mfma_f32_16x16x32_bf16 v[148:151], a[52:55], a[228:231], v[148:151]
  ds_write_b64 v194, v[188:189] offset:3072
  v_mfma_f32_16x16x32_bf16 v[144:147], a[52:55], a[224:227], v[144:147]
  s_waitcnt lgkmcnt(2)
  v_mfma_f32_16x16x32_bf16 v[96:99], a[56:59], a[240:243], v[96:99]
  ds_read_b128 a[224:227], v8 offset:4096
  buffer_load_dwordx4 a[52:55], v255, s[60:63], s92 offen offset:0 sc1
  v_mfma_f32_16x16x32_bf16 v[100:103], a[56:59], a[244:247], v[100:103]
  v_mfma_f32_16x16x32_bf16 v[104:107], a[56:59], a[248:251], v[104:107]
  ds_read_b128 a[228:231], v8 offset:5120
  v_mfma_f32_16x16x32_bf16 v[108:111], a[56:59], a[252:255], v[108:111]
  v_mfma_f32_16x16x32_bf16 v[124:127], a[60:63], a[252:255], v[124:127]
  ds_read_b128 a[232:235], v8 offset:6144
  v_mfma_f32_16x16x32_bf16 v[120:123], a[60:63], a[248:251], v[120:123]
  s_add_u32 s92, s92, 9216
  s_cmp_eq_u32 s92, s91
  s_cselect_b32 s92, s90, s92
  v_mfma_f32_16x16x32_bf16 v[116:119], a[60:63], a[244:247], v[116:119]
  ds_read_b128 a[236:239], v8 offset:7168
  buffer_load_dwordx4 a[56:59], v4, s[60:63], s92 offen offset:0 sc1
  v_mfma_f32_16x16x32_bf16 v[112:115], a[60:63], a[240:243], v[112:115]
  v_mfma_f32_16x16x32_bf16 v[128:131], a[64:67], a[240:243], v[128:131]
  buffer_load_dwordx4 a[60:63], v4, s[60:63], s92 offen offset:1024 sc1
  v_mfma_f32_16x16x32_bf16 v[132:135], a[64:67], a[244:247], v[132:135]
  v_mfma_f32_16x16x32_bf16 v[136:139], a[64:67], a[248:251], v[136:139]
  v_mfma_f32_16x16x32_bf16 v[140:143], a[64:67], a[252:255], v[140:143]
  v_mfma_f32_16x16x32_bf16 v[156:159], a[68:71], a[252:255], v[156:159]
  buffer_load_dwordx4 a[64:67], v4, s[60:63], s92 offen offset:2048 sc1
  v_mfma_f32_16x16x32_bf16 v[152:155], a[68:71], a[248:251], v[152:155]
  v_mfma_f32_16x16x32_bf16 v[148:151], a[68:71], a[244:247], v[148:151]
  v_mfma_f32_16x16x32_bf16 v[144:147], a[68:71], a[240:243], v[144:147]
  s_waitcnt lgkmcnt(0)
  v_mfma_f32_16x16x32_bf16 v[96:99], a[72:75], a[224:227], v[96:99]
  ds_read_b128 a[240:243], v8 offset:8192
  buffer_load_dwordx4 a[68:71], v4, s[60:63], s92 offen offset:3072 sc1
  v_mfma_f32_16x16x32_bf16 v[100:103], a[72:75], a[228:231], v[100:103]
  v_mfma_f32_16x16x32_bf16 v[104:107], a[72:75], a[232:235], v[104:107]
  ds_read_b128 a[244:247], v8 offset:9216
  v_mfma_f32_16x16x32_bf16 v[108:111], a[72:75], a[236:239], v[108:111]
  v_mfma_f32_16x16x32_bf16 v[124:127], a[76:79], a[236:239], v[124:127]
  ds_read_b128 a[248:251], v8 offset:10240
  buffer_load_dwordx4 a[72:75], v255, s[60:63], s92 offen offset:0 sc1
  v_mfma_f32_16x16x32_bf16 v[120:123], a[76:79], a[232:235], v[120:123]
  v_mfma_f32_16x16x32_bf16 v[116:119], a[76:79], a[228:231], v[116:119]
  ds_read_b128 a[252:255], v8 offset:11264
  v_mfma_f32_16x16x32_bf16 v[112:115], a[76:79], a[224:227], v[112:115]
  v_mfma_f32_16x16x32_bf16 v[128:131], a[80:83], a[224:227], v[128:131]
  s_add_u32 s92, s92, 9216
  s_cmp_eq_u32 s92, s91
  s_cselect_b32 s92, s90, s92
  v_mfma_f32_16x16x32_bf16 v[132:135], a[80:83], a[228:231], v[132:135]
  buffer_load_dwordx4 a[76:79], v4, s[60:63], s92 offen offset:0 sc1
  v_mfma_f32_16x16x32_bf16 v[136:139], a[80:83], a[232:235], v[136:139]
  v_mfma_f32_16x16x32_bf16 v[140:143], a[80:83], a[236:239], v[140:143]
  v_mfma_f32_16x16x32_bf16 v[156:159], a[84:87], a[236:239], v[156:159]
  buffer_load_dwordx4 a[80:83], v4, s[60:63], s92 offen offset:1024 sc1
  v_mfma_f32_16x16x32_bf16 v[152:155], a[84:87], a[232:235], v[152:155]
  v_mfma_f32_16x16x32_bf16 v[148:151], a[84:87], a[228:231], v[148:151]
  v_mfma_f32_16x16x32_bf16 v[144:147], a[84:87], a[224:227], v[144:147]
  s_waitcnt lgkmcnt(0)
  v_mfma_f32_16x16x32_bf16 v[96:99], a[88:91], a[240:243], v[96:99]
  ds_read_b128 a[224:227], v8 offset:12288
  buffer_load_dwordx4 a[84:87], v4, s[60:63], s92 offen offset:2048 sc1
  v_mfma_f32_16x16x32_bf16 v[100:103], a[88:91], a[244:247], v[100:103]
  v_mfma_f32_16x16x32_bf16 v[104:107], a[88:91], a[248:251], v[104:107]
  ds_read_b128 a[228:231], v8 offset:13312
  v_mfma_f32_16x16x32_bf16 v[108:111], a[88:91], a[252:255], v[108:111]
  v_mfma_f32_16x16x32_bf16 v[124:127], a[92:95], a[252:255], v[124:127]
  ds_read_b128 a[232:235], v8 offset:14336
  buffer_load_dwordx4 a[88:91], v4, s[60:63], s92 offen offset:3072 sc1
  v_mfma_f32_16x16x32_bf16 v[120:123], a[92:95], a[248:251], v[120:123]
  v_mfma_f32_16x16x32_bf16 v[116:119], a[92:95], a[244:247], v[116:119]
  ds_read_b128 a[236:239], v8 offset:15360
  v_mfma_f32_16x16x32_bf16 v[112:115], a[92:95], a[240:243], v[112:115]
  v_mfma_f32_16x16x32_bf16 v[128:131], a[96:99], a[240:243], v[128:131]
  buffer_load_dwordx4 a[92:95], v255, s[60:63], s92 offen offset:0 sc1
  v_mfma_f32_16x16x32_bf16 v[132:135], a[96:99], a[244:247], v[132:135]
  v_mfma_f32_16x16x32_bf16 v[136:139], a[96:99], a[248:251], v[136:139]
  v_mfma_f32_16x16x32_bf16 v[140:143], a[96:99], a[252:255], v[140:143]
  v_mfma_f32_16x16x32_bf16 v[156:159], a[100:103], a[252:255], v[156:159]
  s_add_u32 s92, s92, 9216
  s_cmp_eq_u32 s92, s91
  s_cselect_b32 s92, s90, s92
  v_mfma_f32_16x16x32_bf16 v[152:155], a[100:103], a[248:251], v[152:155]
  buffer_load_dwordx4 a[96:99], v4, s[60:63], s92 offen offset:0 sc1
  v_mfma_f32_16x16x32_bf16 v[148:151], a[100:103], a[244:247], v[148:151]
  v_mfma_f32_16x16x32_bf16 v[144:147], a[100:103], a[240:243], v[144:147]
  s_waitcnt lgkmcnt(0)
  v_mfma_f32_16x16x32_bf16 v[96:99], a[104:107], a[224:227], v[96:99]
  ds_read_b128 a[240:243], v8 offset:16384
  buffer_load_dwordx4 a[100:103], v4, s[60:63], s92 offen offset:1024 sc1
  v_mfma_f32_16x16x32_bf16 v[100:103], a[104:107], a[228:231], v[100:103]
  v_mfma_f32_16x16x32_bf16 v[104:107], a[104:107], a[232:235], v[104:107]
  ds_read_b128 a[244:247], v8 offset:17408
  v_mfma_f32_16x16x32_bf16 v[108:111], a[104:107], a[236:239], v[108:111]
  v_mfma_f32_16x16x32_bf16 v[124:127], a[108:111], a[236:239], v[124:127]
  ds_read_b128 a[248:251], v8 offset:18432
  buffer_load_dwordx4 a[104:107], v4, s[60:63], s92 offen offset:2048 sc1
  v_mfma_f32_16x16x32_bf16 v[120:123], a[108:111], a[232:235], v[120:123]
  v_mfma_f32_16x16x32_bf16 v[116:119], a[108:111], a[228:231], v[116:119]
  ds_read_b128 a[252:255], v8 offset:19456
  v_mfma_f32_16x16x32_bf16 v[112:115], a[108:111], a[224:227], v[112:115]
  v_mfma_f32_16x16x32_bf16 v[128:131], a[112:115], a[224:227], v[128:131]
  buffer_load_dwordx4 a[108:111], v4, s[60:63], s92 offen offset:3072 sc1
  v_mfma_f32_16x16x32_bf16 v[132:135], a[112:115], a[228:231], v[132:135]
  v_mfma_f32_16x16x32_bf16 v[136:139], a[112:115], a[232:235], v[136:139]
  v_mfma_f32_16x16x32_bf16 v[140:143], a[112:115], a[236:239], v[140:143]
  v_mfma_f32_16x16x32_bf16 v[156:159], a[116:119], a[236:239], v[156:159]
  buffer_load_dwordx4 a[112:115], v255, s[60:63], s92 offen offset:0 sc1
  v_mfma_f32_16x16x32_bf16 v[152:155], a[116:119], a[232:235], v[152:155]
  v_mfma_f32_16x16x32_bf16 v[148:151], a[116:119], a[228:231], v[148:151]
  v_mfma_f32_16x16x32_bf16 v[144:147], a[116:119], a[224:227], v[144:147]
  s_waitcnt lgkmcnt(0)
  v_mfma_f32_16x16x32_bf16 v[96:99], a[120:123], a[240:243], v[96:99]
  ds_read_b128 a[224:227], v8 offset:20480
  v_mfma_f32_16x16x32_bf16 v[100:103], a[120:123], a[244:247], v[100:103]
  s_add_u32 s92, s92, 9216
  s_cmp_eq_u32 s92, s91
  s_cselect_b32 s92, s90, s92
  v_mfma_f32_16x16x32_bf16 v[104:107], a[120:123], a[248:251], v[104:107]
  ds_read_b128 a[228:231], v8 offset:21504
  buffer_load_dwordx4 a[116:119], v4, s[60:63], s92 offen offset:0 sc1
  v_mfma_f32_16x16x32_bf16 v[108:111], a[120:123], a[252:255], v[108:111]
  v_mfma_f32_16x16x32_bf16 v[124:127], a[124:127], a[252:255], v[124:127]
  ds_read_b128 a[232:235], v8 offset:22528
  buffer_load_dwordx4 a[120:123], v4, s[60:63], s92 offen offset:1024 sc1
  v_mfma_f32_16x16x32_bf16 v[120:123], a[124:127], a[248:251], v[120:123]
  v_mfma_f32_16x16x32_bf16 v[116:119], a[124:127], a[244:247], v[116:119]
  ds_read_b128 a[236:239], v8 offset:23552
  v_mfma_f32_16x16x32_bf16 v[112:115], a[124:127], a[240:243], v[112:115]
  v_mfma_f32_16x16x32_bf16 v[128:131], a[128:131], a[240:243], v[128:131]
  buffer_load_dwordx4 a[124:127], v4, s[60:63], s92 offen offset:2048 sc1
  v_mfma_f32_16x16x32_bf16 v[132:135], a[128:131], a[244:247], v[132:135]
  v_mfma_f32_16x16x32_bf16 v[136:139], a[128:131], a[248:251], v[136:139]
  v_mfma_f32_16x16x32_bf16 v[140:143], a[128:131], a[252:255], v[140:143]
  v_mfma_f32_16x16x32_bf16 v[156:159], a[132:135], a[252:255], v[156:159]
  buffer_load_dwordx4 a[128:131], v4, s[60:63], s92 offen offset:3072 sc1
  v_mfma_f32_16x16x32_bf16 v[152:155], a[132:135], a[248:251], v[152:155]
  v_mfma_f32_16x16x32_bf16 v[148:151], a[132:135], a[244:247], v[148:151]
  v_mfma_f32_16x16x32_bf16 v[144:147], a[132:135], a[240:243], v[144:147]
  s_waitcnt vmcnt(51) lgkmcnt(0)
  v_mfma_f32_16x16x32_bf16 v[96:99], a[136:139], a[224:227], v[96:99]
  ds_read_b128 a[240:243], v8 offset:24576
  buffer_load_dwordx4 a[132:135], v255, s[60:63], s92 offen offset:0 sc1
  v_mfma_f32_16x16x32_bf16 v[100:103], a[136:139], a[228:231], v[100:103]
  v_mfma_f32_16x16x32_bf16 v[104:107], a[136:139], a[232:235], v[104:107]
  ds_read_b128 a[244:247], v8 offset:25600
  v_mfma_f32_16x16x32_bf16 v[108:111], a[136:139], a[236:239], v[108:111]
  v_mfma_f32_16x16x32_bf16 v[124:127], a[140:143], a[236:239], v[124:127]
  ds_read_b128 a[248:251], v8 offset:26624
  v_mfma_f32_16x16x32_bf16 v[120:123], a[140:143], a[232:235], v[120:123]
  s_add_u32 s92, s92, 9216
  s_cmp_eq_u32 s92, s91
  s_cselect_b32 s92, s90, s92
  v_mfma_f32_16x16x32_bf16 v[116:119], a[140:143], a[228:231], v[116:119]
  ds_read_b128 a[252:255], v8 offset:27648
  buffer_load_dwordx4 a[136:139], v4, s[60:63], s92 offen offset:0 sc1
  v_mfma_f32_16x16x32_bf16 v[112:115], a[140:143], a[224:227], v[112:115]
  v_mfma_f32_16x16x32_bf16 v[128:131], a[144:147], a[224:227], v[128:131]
  buffer_load_dwordx4 a[140:143], v4, s[60:63], s92 offen offset:1024 sc1
  v_mfma_f32_16x16x32_bf16 v[132:135], a[144:147], a[228:231], v[132:135]
  v_mfma_f32_16x16x32_bf16 v[136:139], a[144:147], a[232:235], v[136:139]
  v_mfma_f32_16x16x32_bf16 v[140:143], a[144:147], a[236:239], v[140:143]
  v_mfma_f32_16x16x32_bf16 v[156:159], a[148:151], a[236:239], v[156:159]
  buffer_load_dwordx4 a[144:147], v4, s[60:63], s92 offen offset:2048 sc1
  v_mfma_f32_16x16x32_bf16 v[152:155], a[148:151], a[232:235], v[152:155]
  v_mfma_f32_16x16x32_bf16 v[148:151], a[148:151], a[228:231], v[148:151]
  v_mfma_f32_16x16x32_bf16 v[144:147], a[148:151], a[224:227], v[144:147]
  s_waitcnt vmcnt(51) lgkmcnt(0)
  v_mfma_f32_16x16x32_bf16 v[96:99], a[152:155], a[240:243], v[96:99]
  ds_read_b128 a[224:227], v8 offset:28672
  buffer_load_dwordx4 a[148:151], v4, s[60:63], s92 offen offset:3072 sc1
  v_mfma_f32_16x16x32_bf16 v[100:103], a[152:155], a[244:247], v[100:103]
  v_mfma_f32_16x16x32_bf16 v[104:107], a[152:155], a[248:251], v[104:107]
  ds_read_b128 a[228:231], v8 offset:29696
  v_mfma_f32_16x16x32_bf16 v[108:111], a[152:155], a[252:255], v[108:111]
  v_mfma_f32_16x16x32_bf16 v[124:127], a[156:159], a[252:255], v[124:127]
  ds_read_b128 a[232:235], v8 offset:30720
  buffer_load_dwordx4 a[152:155], v255, s[60:63], s92 offen offset:0 sc1
  v_mfma_f32_16x16x32_bf16 v[120:123], a[156:159], a[248:251], v[120:123]
  v_mfma_f32_16x16x32_bf16 v[116:119], a[156:159], a[244:247], v[116:119]
  ds_read_b128 a[236:239], v8 offset:31744
  v_mfma_f32_16x16x32_bf16 v[112:115], a[156:159], a[240:243], v[112:115]
  v_mfma_f32_16x16x32_bf16 v[128:131], a[160:163], a[240:243], v[128:131]
  s_add_u32 s92, s92, 9216
  s_cmp_eq_u32 s92, s91
  s_cselect_b32 s92, s90, s92
  v_mfma_f32_16x16x32_bf16 v[132:135], a[160:163], a[244:247], v[132:135]
  buffer_load_dwordx4 a[156:159], v4, s[60:63], s92 offen offset:0 sc1
  v_mfma_f32_16x16x32_bf16 v[136:139], a[160:163], a[248:251], v[136:139]
  v_mfma_f32_16x16x32_bf16 v[140:143], a[160:163], a[252:255], v[140:143]
  v_mfma_f32_16x16x32_bf16 v[156:159], a[164:167], a[252:255], v[156:159]
  buffer_load_dwordx4 a[160:163], v4, s[60:63], s92 offen offset:1024 sc1
  v_mfma_f32_16x16x32_bf16 v[152:155], a[164:167], a[248:251], v[152:155]
  v_mfma_f32_16x16x32_bf16 v[148:151], a[164:167], a[244:247], v[148:151]
  v_mfma_f32_16x16x32_bf16 v[144:147], a[164:167], a[240:243], v[144:147]
  s_waitcnt vmcnt(51) lgkmcnt(0)
  v_mfma_f32_16x16x32_bf16 v[96:99], a[168:171], a[224:227], v[96:99]
  ds_read_b128 a[240:243], v8 offset:32768
  buffer_load_dwordx4 a[164:167], v4, s[60:63], s92 offen offset:2048 sc1
  v_mfma_f32_16x16x32_bf16 v[100:103], a[168:171], a[228:231], v[100:103]
  v_mfma_f32_16x16x32_bf16 v[104:107], a[168:171], a[232:235], v[104:107]
  ds_read_b128 a[244:247], v8 offset:33792
  v_mfma_f32_16x16x32_bf16 v[108:111], a[168:171], a[236:239], v[108:111]
  v_mfma_f32_16x16x32_bf16 v[124:127], a[172:175], a[236:239], v[124:127]
  ds_read_b128 a[248:251], v8 offset:34816
  buffer_load_dwordx4 a[168:171], v4, s[60:63], s92 offen offset:3072 sc1
  v_mfma_f32_16x16x32_bf16 v[120:123], a[172:175], a[232:235], v[120:123]
  v_mfma_f32_16x16x32_bf16 v[116:119], a[172:175], a[228:231], v[116:119]
  ds_read_b128 a[252:255], v8 offset:35840
  v_mfma_f32_16x16x32_bf16 v[112:115], a[172:175], a[224:227], v[112:115]
  v_mfma_f32_16x16x32_bf16 v[128:131], a[176:179], a[224:227], v[128:131]
  buffer_load_dwordx4 a[172:175], v255, s[60:63], s92 offen offset:0 sc1
  v_mfma_f32_16x16x32_bf16 v[132:135], a[176:179], a[228:231], v[132:135]
  v_mfma_f32_16x16x32_bf16 v[136:139], a[176:179], a[232:235], v[136:139]
  v_mfma_f32_16x16x32_bf16 v[140:143], a[176:179], a[236:239], v[140:143]
  v_mfma_f32_16x16x32_bf16 v[156:159], a[180:183], a[236:239], v[156:159]
  s_add_u32 s90, s89, 92160
  s_add_u32 s91, s89, 165888
  v_mfma_f32_16x16x32_bf16 v[152:155], a[180:183], a[232:235], v[152:155]
  s_mul_i32 s92, s94, 9216
  s_add_u32 s92, s92, s90
  v_mfma_f32_16x16x32_bf16 v[148:151], a[180:183], a[228:231], v[148:151]
  buffer_load_dwordx4 a[176:179], v4, s[60:63], s92 offen offset:0 sc1
  v_mfma_f32_16x16x32_bf16 v[144:147], a[180:183], a[224:227], v[144:147]
  s_waitcnt vmcnt(51) lgkmcnt(0)
  v_mfma_f32_16x16x32_bf16 v[96:99], a[184:187], a[240:243], v[96:99]
  s_barrier
  buffer_load_dwordx4 a[180:183], v4, s[60:63], s92 offen offset:1024 sc1
  v_mfma_f32_16x16x32_bf16 v[100:103], a[184:187], a[244:247], v[100:103]
  ds_read_b128 a[224:227], v9 offset:0
  v_mfma_f32_16x16x32_bf16 v[104:107], a[184:187], a[248:251], v[104:107]
  v_mfma_f32_16x16x32_bf16 v[108:111], a[184:187], a[252:255], v[108:111]
  ds_read_b128 a[228:231], v9 offset:1024
  v_mfma_f32_16x16x32_bf16 v[124:127], a[188:191], a[252:255], v[124:127]
  buffer_load_dwordx4 a[184:187], v4, s[60:63], s92 offen offset:2048 sc1
  v_mfma_f32_16x16x32_bf16 v[120:123], a[188:191], a[248:251], v[120:123]
  ds_read_b128 a[232:235], v9 offset:2048
  v_mfma_f32_16x16x32_bf16 v[116:119], a[188:191], a[244:247], v[116:119]
  v_mfma_f32_16x16x32_bf16 v[112:115], a[188:191], a[240:243], v[112:115]
  ds_read_b128 a[236:239], v9 offset:3072
  v_mfma_f32_16x16x32_bf16 v[128:131], a[192:195], a[240:243], v[128:131]
  buffer_load_dwordx4 a[188:191], v4, s[60:63], s92 offen offset:3072 sc1
  v_mfma_f32_16x16x32_bf16 v[132:135], a[192:195], a[244:247], v[132:135]
  v_mfma_f32_16x16x32_bf16 v[136:139], a[192:195], a[248:251], v[136:139]
  v_mfma_f32_16x16x32_bf16 v[140:143], a[192:195], a[252:255], v[140:143]
  v_mfma_f32_16x16x32_bf16 v[156:159], a[196:199], a[252:255], v[156:159]
  buffer_load_dwordx4 a[192:195], v255, s[60:63], s92 offen offset:0 sc1
  v_mfma_f32_16x16x32_bf16 v[152:155], a[196:199], a[248:251], v[152:155]
  v_mfma_f32_16x16x32_bf16 v[148:151], a[196:199], a[244:247], v[148:151]
  v_mfma_f32_16x16x32_bf16 v[144:147], a[196:199], a[240:243], v[144:147]
  s_waitcnt vmcnt(50) lgkmcnt(0)
  v_mfma_f32_16x16x32_bf16 v[16:19], a[200:203], a[224:227], 0
  ds_read_b128 a[240:243], v9 offset:4096
  v_mfma_f32_16x16x32_bf16 v[20:23], a[200:203], a[228:231], 0
  s_add_u32 s92, s92, 9216
  s_cmp_eq_u32 s92, s91
  s_cselect_b32 s92, s90, s92
  v_mfma_f32_16x16x32_bf16 v[24:27], a[200:203], a[232:235], 0
  ds_read_b128 a[244:247], v9 offset:5120
  buffer_load_dwordx4 a[196:199], v4, s[60:63], s92 offen offset:0 sc1
  v_mfma_f32_16x16x32_bf16 v[28:31], a[200:203], a[236:239], 0
  v_mul_f32 v96, v96, |v96|
  v_mul_f32 v97, v97, |v97|
  v_mfma_f32_16x16x32_bf16 v[44:47], a[204:207], a[236:239], 0
  ds_read_b128 a[248:251], v9 offset:6144
  buffer_load_dwordx4 a[200:203], v4, s[60:63], s92 offen offset:1024 sc1
  v_mfma_f32_16x16x32_bf16 v[40:43], a[204:207], a[232:235], 0
  v_mul_f32 v98, v98, |v98|
  v_mul_f32 v99, v99, |v99|
  v_mfma_f32_16x16x32_bf16 v[36:39], a[204:207], a[228:231], 0
  ds_read_b128 a[252:255], v9 offset:7168
  v_mul_f32 v112, v112, |v112|
  v_mfma_f32_16x16x32_bf16 v[32:35], a[204:207], a[224:227], 0
  v_mul_f32 v113, v113, |v113|
  v_mul_f32 v114, v114, |v114|
  v_mfma_f32_16x16x32_bf16 v[48:51], a[208:211], a[224:227], 0
  buffer_load_dwordx4 a[204:207], v4, s[60:63], s92 offen offset:2048 sc1
  v_mul_f32 v115, v115, |v115|
  v_mfma_f32_16x16x32_bf16 v[52:55], a[208:211], a[228:231], 0
  v_cvt_pk_bf16_f32 v176, v96, v97
  v_cvt_pk_bf16_f32 v177, v98, v99
  v_mfma_f32_16x16x32_bf16 v[56:59], a[208:211], a[232:235], 0
  v_cvt_pk_bf16_f32 v178, v112, v113
  v_cvt_pk_bf16_f32 v179, v114, v115
  v_mfma_f32_16x16x32_bf16 v[60:63], a[208:211], a[236:239], 0
  v_pk_max_i16 v176, v176, 0
  v_pk_max_i16 v177, v177, 0
  v_mfma_f32_16x16x32_bf16 v[76:79], a[212:215], a[236:239], 0
  buffer_load_dwordx4 a[208:211], v4, s[60:63], s92 offen offset:3072 sc1
  v_pk_max_i16 v178, v178, 0
  v_mfma_f32_16x16x32_bf16 v[72:75], a[212:215], a[232:235], 0
  v_pk_max_i16 v179, v179, 0
  v_mfma_f32_16x16x32_bf16 v[68:71], a[212:215], a[228:231], 0
  ds_write_b128 v195, v[176:179] offset:0
  v_mfma_f32_16x16x32_bf16 v[64:67], a[212:215], a[224:227], 0
  v_mul_f32 v100, v100, |v100|
  v_mul_f32 v101, v101, |v101|
  v_mfma_f32_16x16x32_bf16 v[80:83], a[216:219], a[224:227], 0
  buffer_load_dwordx4 a[212:215], v255, s[60:63], s92 offen offset:0 sc1
  v_mul_f32 v102, v102, |v102|
  v_mfma_f32_16x16x32_bf16 v[84:87], a[216:219], a[228:231], 0
  v_mul_f32 v103, v103, |v103|
  v_mul_f32 v116, v116, |v116|
  v_mfma_f32_16x16x32_bf16 v[88:91], a[216:219], a[232:235], 0
  v_mul_f32 v117, v117, |v117|
  v_mul_f32 v118, v118, |v118|
  v_mfma_f32_16x16x32_bf16 v[92:95], a[216:219], a[236:239], 0
  s_waitcnt vmcnt(50) lgkmcnt(1)
  v_mul_f32 v119, v119, |v119|
  v_cvt_pk_bf16_f32 v180, v100, v101
  v_mfma_f32_16x16x32_bf16 v[16:19], a[220:223], a[240:243], v[16:19]
  ds_read_b128 a[224:227], v9 offset:8192
  v_cvt_pk_bf16_f32 v181, v102, v103
  v_mfma_f32_16x16x32_bf16 v[20:23], a[220:223], a[244:247], v[20:23]
  s_add_u32 s92, s92, 9216
  s_cmp_eq_u32 s92, s91
  s_cselect_b32 s92, s90, s92
  v_mfma_f32_16x16x32_bf16 v[24:27], a[220:223], a[248:251], v[24:27]
  ds_read_b128 a[228:231], v9 offset:9216
  buffer_load_dwordx4 a[216:219], v4, s[60:63], s92 offen offset:0 sc1
  v_mfma_f32_16x16x32_bf16 v[28:31], a[220:223], a[252:255], v[28:31]
  v_cvt_pk_bf16_f32 v182, v116, v117
  v_cvt_pk_bf16_f32 v183, v118, v119
  v_mfma_f32_16x16x32_bf16 v[44:47], a[0:3], a[252:255], v[44:47]
  ds_read_b128 a[232:235], v9 offset:10240
  buffer_load_dwordx4 a[220:223], v4, s[60:63], s92 offen offset:1024 sc1
  v_mfma_f32_16x16x32_bf16 v[40:43], a[0:3], a[248:251], v[40:43]
  v_pk_max_i16 v180, v180, 0
  v_pk_max_i16 v181, v181, 0
  v_mfma_f32_16x16x32_bf16 v[36:39], a[0:3], a[244:247], v[36:39]
  ds_read_b128 a[236:239], v9 offset:11264
  v_pk_max_i16 v182, v182, 0
  v_mfma_f32_16x16x32_bf16 v[32:35], a[0:3], a[240:243], v[32:35]
  v_pk_max_i16 v183, v183, 0
  v_mfma_f32_16x16x32_bf16 v[48:51], a[4:7], a[240:243], v[48:51]
  buffer_load_dwordx4 a[0:3], v4, s[60:63], s92 offen offset:2048 sc1
  v_mfma_f32_16x16x32_bf16 v[52:55], a[4:7], a[244:247], v[52:55]
  ds_write_b128 v195, v[180:183] offset:1024
  v_mfma_f32_16x16x32_bf16 v[56:59], a[4:7], a[248:251], v[56:59]
  v_mul_f32 v104, v104, |v104|
  v_mul_f32 v105, v105, |v105|
  v_mfma_f32_16x16x32_bf16 v[60:63], a[4:7], a[252:255], v[60:63]
  v_mul_f32 v106, v106, |v106|
  v_mul_f32 v107, v107, |v107|
  v_mfma_f32_16x16x32_bf16 v[76:79], a[8:11], a[252:255], v[76:79]
  buffer_load_dwordx4 a[4:7], v4, s[60:63], s92 offen offset:3072 sc1
  v_mul_f32 v120, v120, |v120|
  v_mfma_f32_16x16x32_bf16 v[72:75], a[8:11], a[248:251], v[72:75]
  v_mul_f32 v121, v121, |v121|
  v_mul_f32 v122, v122, |v122|
  v_mfma_f32_16x16x32_bf16 v[68:71], a[8:11], a[244:247], v[68:71]
  v_mul_f32 v123, v123, |v123|
  v_cvt_pk_bf16_f32 v184, v104, v105
  v_mfma_f32_16x16x32_bf16 v[64:67], a[8:11], a[240:243], v[64:67]
  v_cvt_pk_bf16_f32 v185, v106, v107
  v_cvt_pk_bf16_f32 v186, v120, v121
  v_mfma_f32_16x16x32_bf16 v[80:83], a[12:15], a[240:243], v[80:83]
  buffer_load_dwordx4 a[8:11], v255, s[60:63], s92 offen offset:0 sc1
  v_cvt_pk_bf16_f32 v187, v122, v123
  v_mfma_f32_16x16x32_bf16 v[84:87], a[12:15], a[244:247], v[84:87]
  v_pk_max_i16 v184, v184, 0
  v_pk_max_i16 v185, v185, 0
  v_mfma_f32_16x16x32_bf16 v[88:91], a[12:15], a[248:251], v[88:91]
  v_pk_max_i16 v186, v186, 0
  v_pk_max_i16 v187, v187, 0
  v_mfma_f32_16x16x32_bf16 v[92:95], a[12:15], a[252:255], v[92:95]
  s_waitcnt vmcnt(50) lgkmcnt(1)
  ds_write_b128 v195, v[184:187] offset:2048
  v_mfma_f32_16x16x32_bf16 v[16:19], a[16:19], a[224:227], v[16:19]
  ds_read_b128 a[240:243], v9 offset:12288
  v_mul_f32 v108, v108, |v108|
  v_mfma_f32_16x16x32_bf16 v[20:23], a[16:19], a[228:231], v[20:23]
  s_add_u32 s92, s92, 9216
  s_cmp_eq_u32 s92, s91
  s_cselect_b32 s92, s90, s92
  v_mfma_f32_16x16x32_bf16 v[24:27], a[16:19], a[232:235], v[24:27]
  ds_read_b128 a[244:247], v9 offset:13312
  buffer_load_dwordx4 a[12:15], v4, s[60:63], s92 offen offset:0 sc1
  v_mfma_f32_16x16x32_bf16 v[28:31], a[16:19], a[236:239], v[28:31]
  v_mul_f32 v109, v109, |v109|
  v_mul_f32 v110, v110, |v110|
  v_mfma_f32_16x16x32_bf16 v[44:47], a[20:23], a[236:239], v[44:47]
  ds_read_b128 a[248:251], v9 offset:14336
  buffer_load_dwordx4 a[16:19], v4, s[60:63], s92 offen offset:1024 sc1
  v_mfma_f32_16x16x32_bf16 v[40:43], a[20:23], a[232:235], v[40:43]
  v_mul_f32 v111, v111, |v111|
  v_mul_f32 v124, v124, |v124|
  v_mfma_f32_16x16x32_bf16 v[36:39], a[20:23], a[228:231], v[36:39]
  ds_read_b128 a[252:255], v9 offset:15360
  v_mul_f32 v125, v125, |v125|
  v_mfma_f32_16x16x32_bf16 v[32:35], a[20:23], a[224:227], v[32:35]
  v_mul_f32 v126, v126, |v126|
  v_mul_f32 v127, v127, |v127|
  v_mfma_f32_16x16x32_bf16 v[48:51], a[24:27], a[224:227], v[48:51]
  buffer_load_dwordx4 a[20:23], v4, s[60:63], s92 offen offset:2048 sc1
  v_cvt_pk_bf16_f32 v188, v108, v109
  v_mfma_f32_16x16x32_bf16 v[52:55], a[24:27], a[228:231], v[52:55]
  v_cvt_pk_bf16_f32 v189, v110, v111
  v_cvt_pk_bf16_f32 v190, v124, v125
  v_mfma_f32_16x16x32_bf16 v[56:59], a[24:27], a[232:235], v[56:59]
  v_cvt_pk_bf16_f32 v191, v126, v127
  v_pk_max_i16 v188, v188, 0
  v_mfma_f32_16x16x32_bf16 v[60:63], a[24:27], a[236:239], v[60:63]
  v_pk_max_i16 v189, v189, 0
  v_pk_max_i16 v190, v190, 0
  v_mfma_f32_16x16x32_bf16 v[76:79], a[28:31], a[236:239], v[76:79]
  buffer_load_dwordx4 a[24:27], v4, s[60:63], s92 offen offset:3072 sc1
  v_pk_max_i16 v191, v191, 0
  v_mfma_f32_16x16x32_bf16 v[72:75], a[28:31], a[232:235], v[72:75]
  ds_write_b128 v195, v[188:191] offset:3072
  v_mfma_f32_16x16x32_bf16 v[68:71], a[28:31], a[228:231], v[68:71]
  v_mul_f32 v128, v128, |v128|
  v_mul_f32 v129, v129, |v129|
  v_mfma_f32_16x16x32_bf16 v[64:67], a[28:31], a[224:227], v[64:67]
  v_mul_f32 v130, v130, |v130|
  v_mul_f32 v131, v131, |v131|
  v_mfma_f32_16x16x32_bf16 v[80:83], a[32:35], a[224:227], v[80:83]
  buffer_load_dwordx4 a[28:31], v255, s[60:63], s92 offen offset:0 sc1
  v_mul_f32 v144, v144, |v144|
  v_mfma_f32_16x16x32_bf16 v[84:87], a[32:35], a[228:231], v[84:87]
  v_mul_f32 v145, v145, |v145|
  v_mul_f32 v146, v146, |v146|
  v_mfma_f32_16x16x32_bf16 v[88:91], a[32:35], a[232:235], v[88:91]
  v_mul_f32 v147, v147, |v147|
  v_cvt_pk_bf16_f32 v176, v128, v129
  v_mfma_f32_16x16x32_bf16 v[92:95], a[32:35], a[236:239], v[92:95]
  s_waitcnt vmcnt(50) lgkmcnt(1)
  v_cvt_pk_bf16_f32 v177, v130, v131
  v_cvt_pk_bf16_f32 v178, v144, v145
  v_mfma_f32_16x16x32_bf16 v[16:19], a[36:39], a[240:243], v[16:19]
  ds_read_b128 a[224:227], v9 offset:16384
  v_cvt_pk_bf16_f32 v179, v146, v147
  v_mfma_f32_16x16x32_bf16 v[20:23], a[36:39], a[244:247], v[20:23]
  s_add_u32 s92, s92, 9216
  s_cmp_eq_u32 s92, s91
  s_cselect_b32 s92, s90, s92
  v_mfma_f32_16x16x32_bf16 v[24:27], a[36:39], a[248:251], v[24:27]
  ds_read_b128 a[228:231], v9 offset:17408
  buffer_load_dwordx4 a[32:35], v4, s[60:63], s92 offen offset:0 sc1
  v_mfma_f32_16x16x32_bf16 v[28:31], a[36:39], a[252:255], v[28:31]
  v_pk_max_i16 v176, v176, 0
  v_pk_max_i16 v177, v177, 0
  v_mfma_f32_16x16x32_bf16 v[44:47], a[40:43], a[252:255], v[44:47]
  ds_read_b128 a[232:235], v9 offset:18432
  buffer_load_dwordx4 a[36:39], v4, s[60:63], s92 offen offset:1024 sc1
  v_mfma_f32_16x16x32_bf16 v[40:43], a[40:43], a[248:251], v[40:43]
  v_pk_max_i16 v178, v178, 0
  v_pk_max_i16 v179, v179, 0
  v_mfma_f32_16x16x32_bf16 v[36:39], a[40:43], a[244:247], v[36:39]
  ds_read_b128 a[236:239], v9 offset:19456
  v_mfma_f32_16x16x32_bf16 v[32:35], a[40:43], a[240:243], v[32:35]
  ds_write_b128 v196, v[176:179] offset:0
  v_mfma_f32_16x16x32_bf16 v[48:51], a[44:47], a[240:243], v[48:51]
  buffer_load_dwordx4 a[40:43], v4, s[60:63], s92 offen offset:2048 sc1
  v_mul_f32 v132, v132, |v132|
  v_mfma_f32_16x16x32_bf16 v[52:55], a[44:47], a[244:247], v[52:55]
  v_mul_f32 v133, v133, |v133|
  v_mul_f32 v134, v134, |v134|
  v_mfma_f32_16x16x32_bf16 v[56:59], a[44:47], a[248:251], v[56:59]
  v_mul_f32 v135, v135, |v135|
  v_mul_f32 v148, v148, |v148|
  v_mfma_f32_16x16x32_bf16 v[60:63], a[44:47], a[252:255], v[60:63]
  v_mul_f32 v149, v149, |v149|
  v_mul_f32 v150, v150, |v150|
  v_mfma_f32_16x16x32_bf16 v[76:79], a[48:51], a[252:255], v[76:79]
  buffer_load_dwordx4 a[44:47], v4, s[60:63], s92 offen offset:3072 sc1
  v_mul_f32 v151, v151, |v151|
  v_mfma_f32_16x16x32_bf16 v[72:75], a[48:51], a[248:251], v[72:75]
  v_cvt_pk_bf16_f32 v180, v132, v133
  v_cvt_pk_bf16_f32 v181, v134, v135
  v_mfma_f32_16x16x32_bf16 v[68:71], a[48:51], a[244:247], v[68:71]
  v_cvt_pk_bf16_f32 v182, v148, v149
  v_cvt_pk_bf16_f32 v183, v150, v151
  v_mfma_f32_16x16x32_bf16 v[64:67], a[48:51], a[240:243], v[64:67]
  v_pk_max_i16 v180, v180, 0
  v_pk_max_i16 v181, v181, 0
  v_mfma_f32_16x16x32_bf16 v[80:83], a[52:55], a[240:243], v[80:83]
  buffer_load_dwordx4 a[48:51], v255, s[60:63], s92 offen offset:0 sc1
  v_pk_max_i16 v182, v182, 0
  v_mfma_f32_16x16x32_bf16 v[84:87], a[52:55], a[244:247], v[84:87]
  v_pk_max_i16 v183, v183, 0
  v_mfma_f32_16x16x32_bf16 v[88:91], a[52:55], a[248:251], v[88:91]
  ds_write_b128 v196, v[180:183] offset:1024
  v_mfma_f32_16x16x32_bf16 v[92:95], a[52:55], a[252:255], v[92:95]
  s_waitcnt vmcnt(50) lgkmcnt(2)
  v_mul_f32 v136, v136, |v136|
  v_mul_f32 v137, v137, |v137|
  v_mfma_f32_16x16x32_bf16 v[16:19], a[56:59], a[224:227], v[16:19]
  ds_read_b128 a[240:243], v9 offset:20480
  v_mul_f32 v138, v138, |v138|
  v_mfma_f32_16x16x32_bf16 v[20:23], a[56:59], a[228:231], v[20:23]
  s_add_u32 s92, s92, 9216
  s_cmp_eq_u32 s92, s91
  s_cselect_b32 s92, s90, s92
  v_mfma_f32_16x16x32_bf16 v[24:27], a[56:59], a[232:235], v[24:27]
  ds_read_b128 a[244:247], v9 offset:21504
  buffer_load_dwordx4 a[52:55], v4, s[60:63], s92 offen offset:0 sc1
  v_mfma_f32_16x16x32_bf16 v[28:31], a[56:59], a[236:239], v[28:31]
  v_mul_f32 v139, v139, |v139|
  v_mul_f32 v152, v152, |v152|
  v_mfma_f32_16x16x32_bf16 v[44:47], a[60:63], a[236:239], v[44:47]
  ds_read_b128 a[248:251], v9 offset:22528
  buffer_load_dwordx4 a[56:59], v4, s[60:63], s92 offen offset:1024 sc1
  v_mfma_f32_16x16x32_bf16 v[40:43], a[60:63], a[232:235], v[40:43]
  v_mul_f32 v153, v153, |v153|
  v_mul_f32 v154, v154, |v154|
  v_mfma_f32_16x16x32_bf16 v[36:39], a[60:63], a[228:231], v[36:39]
  ds_read_b128 a[252:255], v9 offset:23552
  v_mul_f32 v155, v155, |v155|
  v_mfma_f32_16x16x32_bf16 v[32:35], a[60:63], a[224:227], v[32:35]
  v_cvt_pk_bf16_f32 v184, v136, v137
  v_cvt_pk_bf16_f32 v185, v138, v139
  v_mfma_f32_16x16x32_bf16 v[48:51], a[64:67], a[224:227], v[48:51]
  buffer_load_dwordx4 a[60:63], v4, s[60:63], s92 offen offset:2048 sc1
  v_cvt_pk_bf16_f32 v186, v152, v153
  v_mfma_f32_16x16x32_bf16 v[52:55], a[64:67], a[228:231], v[52:55]
  v_cvt_pk_bf16_f32 v187, v154, v155
  v_pk_max_i16 v184, v184, 0
  v_mfma_f32_16x16x32_bf16 v[56:59], a[64:67], a[232:235], v[56:59]
  v_pk_max_i16 v185, v185, 0
  v_pk_max_i16 v186, v186, 0
  v_mfma_f32_16x16x32_bf16 v[60:63], a[64:67], a[236:239], v[60:63]
  v_pk_max_i16 v187, v187, 0
  v_mfma_f32_16x16x32_bf16 v[76:79], a[68:71], a[236:239], v[76:79]
  buffer_load_dwordx4 a[64:67], v4, s[60:63], s92 offen offset:3072 sc1
  v_mfma_f32_16x16x32_bf16 v[72:75], a[68:71], a[232:235], v[72:75]
  ds_write_b128 v196, v[184:187] offset:2048
  v_mfma_f32_16x16x32_bf16 v[68:71], a[68:71], a[228:231], v[68:71]
  v_mul_f32 v140, v140, |v140|
  v_mul_f32 v141, v141, |v141|
  v_mfma_f32_16x16x32_bf16 v[64:67], a[68:71], a[224:227], v[64:67]
  v_mul_f32 v142, v142, |v142|
  v_mul_f32 v143, v143, |v143|
  v_mfma_f32_16x16x32_bf16 v[80:83], a[72:75], a[224:227], v[80:83]
  buffer_load_dwordx4 a[68:71], v255, s[60:63], s92 offen offset:0 sc1
  v_mul_f32 v156, v156, |v156|
  v_mfma_f32_16x16x32_bf16 v[84:87], a[72:75], a[228:231], v[84:87]
  v_mul_f32 v157, v157, |v157|
  v_mul_f32 v158, v158, |v158|
  v_mfma_f32_16x16x32_bf16 v[88:91], a[72:75], a[232:235], v[88:91]
  v_mul_f32 v159, v159, |v159|
  v_cvt_pk_bf16_f32 v188, v140, v141
  v_mfma_f32_16x16x32_bf16 v[92:95], a[72:75], a[236:239], v[92:95]
  s_waitcnt vmcnt(50) lgkmcnt(1)
  v_cvt_pk_bf16_f32 v189, v142, v143
  v_cvt_pk_bf16_f32 v190, v156, v157
  v_mfma_f32_16x16x32_bf16 v[16:19], a[76:79], a[240:243], v[16:19]
  ds_read_b128 a[224:227], v9 offset:24576
  v_cvt_pk_bf16_f32 v191, v158, v159
  v_mfma_f32_16x16x32_bf16 v[20:23], a[76:79], a[244:247], v[20:23]
  s_add_u32 s92, s92, 9216
  s_cmp_eq_u32 s92, s91
  s_cselect_b32 s92, s90, s92
  v_mfma_f32_16x16x32_bf16 v[24:27], a[76:79], a[248:251], v[24:27]
  ds_read_b128 a[228:231], v9 offset:25600
  buffer_load_dwordx4 a[72:75], v4, s[60:63], s92 offen offset:0 sc1
  v_mfma_f32_16x16x32_bf16 v[28:31], a[76:79], a[252:255], v[28:31]
  v_pk_max_i16 v188, v188, 0
  v_pk_max_i16 v189, v189, 0
  v_mfma_f32_16x16x32_bf16 v[44:47], a[80:83], a[252:255], v[44:47]
  ds_read_b128 a[232:235], v9 offset:26624
  buffer_load_dwordx4 a[76:79], v4, s[60:63], s92 offen offset:1024 sc1
  v_mfma_f32_16x16x32_bf16 v[40:43], a[80:83], a[248:251], v[40:43]
  v_pk_max_i16 v190, v190, 0
  v_pk_max_i16 v191, v191, 0
  v_mfma_f32_16x16x32_bf16 v[36:39], a[80:83], a[244:247], v[36:39]
  ds_read_b128 a[236:239], v9 offset:27648
  v_mfma_f32_16x16x32_bf16 v[32:35], a[80:83], a[240:243], v[32:35]
  ds_write_b128 v196, v[188:191] offset:3072
  v_mfma_f32_16x16x32_bf16 v[48:51], a[84:87], a[240:243], v[48:51]
  buffer_load_dwordx4 a[80:83], v4, s[60:63], s92 offen offset:2048 sc1
  v_mfma_f32_16x16x32_bf16 v[52:55], a[84:87], a[244:247], v[52:55]
  v_mfma_f32_16x16x32_bf16 v[56:59], a[84:87], a[248:251], v[56:59]
  v_mfma_f32_16x16x32_bf16 v[60:63], a[84:87], a[252:255], v[60:63]
  v_mfma_f32_16x16x32_bf16 v[76:79], a[88:91], a[252:255], v[76:79]
  buffer_load_dwordx4 a[84:87], v4, s[60:63], s92 offen offset:3072 sc1
  v_mfma_f32_16x16x32_bf16 v[72:75], a[88:91], a[248:251], v[72:75]
  v_mfma_f32_16x16x32_bf16 v[68:71], a[88:91], a[244:247], v[68:71]
  v_mfma_f32_16x16x32_bf16 v[64:67], a[88:91], a[240:243], v[64:67]
  v_mfma_f32_16x16x32_bf16 v[80:83], a[92:95], a[240:243], v[80:83]
  buffer_load_dwordx4 a[88:91], v255, s[60:63], s92 offen offset:0 sc1
  v_mfma_f32_16x16x32_bf16 v[84:87], a[92:95], a[244:247], v[84:87]
  v_mfma_f32_16x16x32_bf16 v[88:91], a[92:95], a[248:251], v[88:91]
  v_mfma_f32_16x16x32_bf16 v[92:95], a[92:95], a[252:255], v[92:95]
  s_waitcnt vmcnt(50) lgkmcnt(1)
  v_mfma_f32_16x16x32_bf16 v[16:19], a[96:99], a[224:227], v[16:19]
  ds_read_b128 a[240:243], v9 offset:28672
  v_mfma_f32_16x16x32_bf16 v[20:23], a[96:99], a[228:231], v[20:23]
  s_add_u32 s92, s92, 9216
  s_cmp_eq_u32 s92, s91
  s_cselect_b32 s92, s90, s92
  v_mfma_f32_16x16x32_bf16 v[24:27], a[96:99], a[232:235], v[24:27]
  ds_read_b128 a[244:247], v9 offset:29696
  buffer_load_dwordx4 a[92:95], v4, s[60:63], s92 offen offset:0 sc1
  v_mfma_f32_16x16x32_bf16 v[28:31], a[96:99], a[236:239], v[28:31]
  v_mfma_f32_16x16x32_bf16 v[44:47], a[100:103], a[236:239], v[44:47]
  ds_read_b128 a[248:251], v9 offset:30720
  buffer_load_dwordx4 a[96:99], v4, s[60:63], s92 offen offset:1024 sc1
  v_mfma_f32_16x16x32_bf16 v[40:43], a[100:103], a[232:235], v[40:43]
  v_mfma_f32_16x16x32_bf16 v[36:39], a[100:103], a[228:231], v[36:39]
  ds_read_b128 a[252:255], v9 offset:31744
  v_mfma_f32_16x16x32_bf16 v[32:35], a[100:103], a[224:227], v[32:35]
  v_mfma_f32_16x16x32_bf16 v[48:51], a[104:107], a[224:227], v[48:51]
  buffer_load_dwordx4 a[100:103], v4, s[60:63], s92 offen offset:2048 sc1
  v_mfma_f32_16x16x32_bf16 v[52:55], a[104:107], a[228:231], v[52:55]
  v_mfma_f32_16x16x32_bf16 v[56:59], a[104:107], a[232:235], v[56:59]
  v_mfma_f32_16x16x32_bf16 v[60:63], a[104:107], a[236:239], v[60:63]
  v_mfma_f32_16x16x32_bf16 v[76:79], a[108:111], a[236:239], v[76:79]
  buffer_load_dwordx4 a[104:107], v4, s[60:63], s92 offen offset:3072 sc1
  v_mfma_f32_16x16x32_bf16 v[72:75], a[108:111], a[232:235], v[72:75]
  v_mfma_f32_16x16x32_bf16 v[68:71], a[108:111], a[228:231], v[68:71]
  v_mfma_f32_16x16x32_bf16 v[64:67], a[108:111], a[224:227], v[64:67]
  v_mfma_f32_16x16x32_bf16 v[80:83], a[112:115], a[224:227], v[80:83]
  buffer_load_dwordx4 a[108:111], v255, s[60:63], s92 offen offset:0 sc1
  v_mfma_f32_16x16x32_bf16 v[84:87], a[112:115], a[228:231], v[84:87]
  v_mfma_f32_16x16x32_bf16 v[88:91], a[112:115], a[232:235], v[88:91]
  v_mfma_f32_16x16x32_bf16 v[92:95], a[112:115], a[236:239], v[92:95]
  s_waitcnt vmcnt(50) lgkmcnt(0)
  v_mfma_f32_16x16x32_bf16 v[16:19], a[116:119], a[240:243], v[16:19]
  ds_read_b128 a[224:227], v9 offset:32768
  v_mfma_f32_16x16x32_bf16 v[20:23], a[116:119], a[244:247], v[20:23]
  s_add_u32 s90, s89, 0
  s_add_u32 s91, s89, 92160
  v_mfma_f32_16x16x32_bf16 v[24:27], a[116:119], a[248:251], v[24:27]
  ds_read_b128 a[228:231], v9 offset:33792
  v_mfma_f32_16x16x32_bf16 v[28:31], a[116:119], a[252:255], v[28:31]
  s_mul_i32 s92, s93, 9216
  s_add_u32 s92, s92, s90
  v_mfma_f32_16x16x32_bf16 v[44:47], a[120:123], a[252:255], v[44:47]
  ds_read_b128 a[232:235], v9 offset:34816
  buffer_load_dwordx4 a[112:115], v12, s[60:63], s92 offen offset:0 sc1
  v_mfma_f32_16x16x32_bf16 v[40:43], a[120:123], a[248:251], v[40:43]
  buffer_load_dwordx4 a[116:119], v12, s[60:63], s92 offen offset:1024 sc1
  v_mfma_f32_16x16x32_bf16 v[36:39], a[120:123], a[244:247], v[36:39]
  ds_read_b128 a[236:239], v9 offset:35840
  v_mfma_f32_16x16x32_bf16 v[32:35], a[120:123], a[240:243], v[32:35]
  v_mfma_f32_16x16x32_bf16 v[48:51], a[124:127], a[240:243], v[48:51]
  s_add_u32 s92, s92, 9216
  s_cmp_eq_u32 s92, s91
  s_cselect_b32 s92, s90, s92
  v_mfma_f32_16x16x32_bf16 v[52:55], a[124:127], a[244:247], v[52:55]
  buffer_load_dwordx4 a[120:123], v12, s[60:63], s92 offen offset:0 sc1
  v_mfma_f32_16x16x32_bf16 v[56:59], a[124:127], a[248:251], v[56:59]
  v_mfma_f32_16x16x32_bf16 v[60:63], a[124:127], a[252:255], v[60:63]
  v_mfma_f32_16x16x32_bf16 v[76:79], a[128:131], a[252:255], v[76:79]
  buffer_load_dwordx4 a[124:127], v12, s[60:63], s92 offen offset:1024 sc1
  v_mfma_f32_16x16x32_bf16 v[72:75], a[128:131], a[248:251], v[72:75]
  v_mfma_f32_16x16x32_bf16 v[68:71], a[128:131], a[244:247], v[68:71]
  v_mfma_f32_16x16x32_bf16 v[64:67], a[128:131], a[240:243], v[64:67]
  v_mfma_f32_16x16x32_bf16 v[80:83], a[132:135], a[240:243], v[80:83]
  s_add_u32 s92, s92, 9216
  s_cmp_eq_u32 s92, s91
  s_cselect_b32 s92, s90, s92
  v_mfma_f32_16x16x32_bf16 v[84:87], a[132:135], a[244:247], v[84:87]
  buffer_load_dwordx4 a[128:131], v12, s[60:63], s92 offen offset:0 sc1
  v_mfma_f32_16x16x32_bf16 v[88:91], a[132:135], a[248:251], v[88:91]
  v_mfma_f32_16x16x32_bf16 v[92:95], a[132:135], a[252:255], v[92:95]
  s_waitcnt vmcnt(50) lgkmcnt(0)
  v_mfma_f32_16x16x32_bf16 v[16:19], a[136:139], a[224:227], v[16:19]
  ds_read_b128 a[240:243], v10 offset:0
  buffer_load_dwordx4 a[132:135], v12, s[60:63], s92 offen offset:1024 sc1
  v_mfma_f32_16x16x32_bf16 v[20:23], a[136:139], a[228:231], v[20:23]
  v_mfma_f32_16x16x32_bf16 v[24:27], a[136:139], a[232:235], v[24:27]
  ds_read_b128 a[244:247], v10 offset:1024
  v_mfma_f32_16x16x32_bf16 v[28:31], a[136:139], a[236:239], v[28:31]
  v_mfma_f32_16x16x32_bf16 v[44:47], a[140:143], a[236:239], v[44:47]
  ds_read_b128 a[248:251], v10 offset:2048
  v_mfma_f32_16x16x32_bf16 v[40:43], a[140:143], a[232:235], v[40:43]
  s_add_u32 s92, s92, 9216
  s_cmp_eq_u32 s92, s91
  s_cselect_b32 s92, s90, s92
  v_mfma_f32_16x16x32_bf16 v[36:39], a[140:143], a[228:231], v[36:39]
  ds_read_b128 a[252:255], v10 offset:3072
  buffer_load_dwordx4 a[136:139], v12, s[60:63], s92 offen offset:0 sc1
  v_mfma_f32_16x16x32_bf16 v[32:35], a[140:143], a[224:227], v[32:35]
  v_mfma_f32_16x16x32_bf16 v[48:51], a[144:147], a[224:227], v[48:51]
  buffer_load_dwordx4 a[140:143], v12, s[60:63], s92 offen offset:1024 sc1
  v_mfma_f32_16x16x32_bf16 v[52:55], a[144:147], a[228:231], v[52:55]
  v_mfma_f32_16x16x32_bf16 v[56:59], a[144:147], a[232:235], v[56:59]
  v_mfma_f32_16x16x32_bf16 v[60:63], a[144:147], a[236:239], v[60:63]
  v_mfma_f32_16x16x32_bf16 v[76:79], a[148:151], a[236:239], v[76:79]
  s_add_u32 s92, s92, 9216
  s_cmp_eq_u32 s92, s91
  s_cselect_b32 s92, s90, s92
  v_mfma_f32_16x16x32_bf16 v[72:75], a[148:151], a[232:235], v[72:75]
  buffer_load_dwordx4 a[144:147], v12, s[60:63], s92 offen offset:0 sc1
  v_mfma_f32_16x16x32_bf16 v[68:71], a[148:151], a[228:231], v[68:71]
  v_mfma_f32_16x16x32_bf16 v[64:67], a[148:151], a[224:227], v[64:67]
  v_mfma_f32_16x16x32_bf16 v[80:83], a[152:155], a[224:227], v[80:83]
  buffer_load_dwordx4 a[148:151], v12, s[60:63], s92 offen offset:1024 sc1
  v_mfma_f32_16x16x32_bf16 v[84:87], a[152:155], a[228:231], v[84:87]
  v_mfma_f32_16x16x32_bf16 v[88:91], a[152:155], a[232:235], v[88:91]
  v_mfma_f32_16x16x32_bf16 v[92:95], a[152:155], a[236:239], v[92:95]
  s_waitcnt vmcnt(50) lgkmcnt(0)
  v_mfma_f32_16x16x32_bf16 v[16:19], a[156:159], a[240:243], v[16:19]
  s_barrier
  v_mfma_f32_16x16x32_bf16 v[20:23], a[156:159], a[244:247], v[20:23]
  ds_read_b128 a[224:227], v10 offset:4096
  v_mfma_f32_16x16x32_bf16 v[24:27], a[156:159], a[248:251], v[24:27]
  s_add_u32 s92, s92, 9216
  s_cmp_eq_u32 s92, s91
  s_cselect_b32 s92, s90, s92
  v_mfma_f32_16x16x32_bf16 v[28:31], a[156:159], a[252:255], v[28:31]
  ds_read_b128 a[228:231], v10 offset:5120
  buffer_load_dwordx4 a[152:155], v12, s[60:63], s92 offen offset:0 sc1
  v_mfma_f32_16x16x32_bf16 v[44:47], a[160:163], a[252:255], v[44:47]
  buffer_load_dwordx4 a[156:159], v12, s[60:63], s92 offen offset:1024 sc1
  v_mfma_f32_16x16x32_bf16 v[40:43], a[160:163], a[248:251], v[40:43]
  ds_read_b128 a[232:235], v10 offset:6144
  v_mfma_f32_16x16x32_bf16 v[36:39], a[160:163], a[244:247], v[36:39]
  v_mfma_f32_16x16x32_bf16 v[32:35], a[160:163], a[240:243], v[32:35]
  ds_read_b128 a[236:239], v10 offset:7168
  v_mfma_f32_16x16x32_bf16 v[48:51], a[164:167], a[240:243], v[48:51]
  s_add_u32 s92, s92, 9216
  s_cmp_eq_u32 s92, s91
  s_cselect_b32 s92, s90, s92
  v_mfma_f32_16x16x32_bf16 v[52:55], a[164:167], a[244:247], v[52:55]
  buffer_load_dwordx4 a[160:163], v12, s[60:63], s92 offen offset:0 sc1
  v_mfma_f32_16x16x32_bf16 v[56:59], a[164:167], a[248:251], v[56:59]
  v_mfma_f32_16x16x32_bf16 v[60:63], a[164:167], a[252:255], v[60:63]
  v_mfma_f32_16x16x32_bf16 v[76:79], a[168:171], a[252:255], v[76:79]
  buffer_load_dwordx4 a[164:167], v12, s[60:63], s92 offen offset:1024 sc1
  v_mfma_f32_16x16x32_bf16 v[72:75], a[168:171], a[248:251], v[72:75]
  v_mfma_f32_16x16x32_bf16 v[68:71], a[168:171], a[244:247], v[68:71]
  v_mfma_f32_16x16x32_bf16 v[64:67], a[168:171], a[240:243], v[64:67]
  v_mfma_f32_16x16x32_bf16 v[80:83], a[172:175], a[240:243], v[80:83]
  s_add_u32 s92, s92, 9216
  s_cmp_eq_u32 s92, s91
  s_cselect_b32 s92, s90, s92
  v_mfma_f32_16x16x32_bf16 v[84:87], a[172:175], a[244:247], v[84:87]
  buffer_load_dwordx4 a[168:171], v12, s[60:63], s92 offen offset:0 sc1
  v_mfma_f32_16x16x32_bf16 v[88:91], a[172:175], a[248:251], v[88:91]
  v_mfma_f32_16x16x32_bf16 v[92:95], a[172:175], a[252:255], v[92:95]
  s_waitcnt vmcnt(50) lgkmcnt(0)
  v_mfma_f32_16x16x32_bf16 v[16:19], a[176:179], a[224:227], v[16:19]
  ds_read_b128 a[240:243], v10 offset:8192
  buffer_load_dwordx4 a[172:175], v12, s[60:63], s92 offen offset:1024 sc1
  v_mfma_f32_16x16x32_bf16 v[20:23], a[176:179], a[228:231], v[20:23]
  s_and_b32 s85, s72, 1
  v_lshrrev_b32 v6, 3, v2
  v_mfma_f32_16x16x32_bf16 v[24:27], a[176:179], a[232:235], v[24:27]
  ds_read_b128 a[244:247], v10 offset:9216
  v_cmp_eq_u32 s[64:65], s85, v6
  v_mfma_f32_16x16x32_bf16 v[28:31], a[176:179], a[236:239], v[28:31]
  s_mul_i32 s85, s68, 2560
  v_and_b32 v6, 7, v2
  v_mfma_f32_16x16x32_bf16 v[44:47], a[180:183], a[236:239], v[44:47]
  ds_read_b128 a[248:251], v10 offset:10240
  v_lshl_add_u32 v6, v3, 3, v6
  v_mfma_f32_16x16x32_bf16 v[40:43], a[180:183], a[232:235], v[40:43]
  s_add_u32 s92, s92, 9216
  s_cmp_eq_u32 s92, s91
  s_cselect_b32 s92, s90, s92
  v_mfma_f32_16x16x32_bf16 v[36:39], a[180:183], a[228:231], v[36:39]
  ds_read_b128 a[252:255], v10 offset:11264
  buffer_load_dwordx4 a[176:179], v12, s[60:63], s92 offen offset:0 sc1
  v_mfma_f32_16x16x32_bf16 v[32:35], a[180:183], a[224:227], v[32:35]
  v_lshl_add_u32 v7, v6, 3, s85
  v_lshl_add_u32 v6, v6, 4, s85
  v_mfma_f32_16x16x32_bf16 v[48:51], a[184:187], a[224:227], v[48:51]
  buffer_load_dwordx4 a[180:183], v12, s[60:63], s92 offen offset:1024 sc1
  v_add_u32 v8, s85, v4
  v_mfma_f32_16x16x32_bf16 v[52:55], a[184:187], a[228:231], v[52:55]
  v_lshl_add_u32 v11, v1, 3, s85
  v_add_u32 v14, 16384, v4
  v_mfma_f32_16x16x32_bf16 v[56:59], a[184:187], a[232:235], v[56:59]
  s_lshr_b32 s85, s72, 1
  s_cmp_eq_u32 s85, 0
  s_cselect_b64 s[66:67], s[64:65], 0
  v_mfma_f32_16x16x32_bf16 v[60:63], a[184:187], a[236:239], v[60:63]
  v_cndmask_b32 v160, v240, v13, s[66:67]
  v_cndmask_b32 v164, v241, v13, s[66:67]
  v_mfma_f32_16x16x32_bf16 v[76:79], a[188:191], a[236:239], v[76:79]
  s_add_u32 s92, s92, 9216
  s_cmp_eq_u32 s92, s91
  s_cselect_b32 s92, s90, s92
  v_mfma_f32_16x16x32_bf16 v[72:75], a[188:191], a[232:235], v[72:75]
  buffer_load_dwordx4 a[184:187], v12, s[60:63], s92 offen offset:0 sc1
  v_cndmask_b32 v168, v14, v6, s[66:67]
  v_mfma_f32_16x16x32_bf16 v[68:71], a[188:191], a[228:231], v[68:71]
  v_cndmask_b32 v172, v14, v7, s[66:67]
  v_mfma_f32_16x16x32_bf16 v[64:67], a[188:191], a[224:227], v[64:67]
  s_cmp_eq_u32 s85, 1
  s_cselect_b64 s[66:67], s[64:65], 0
  v_mfma_f32_16x16x32_bf16 v[80:83], a[192:195], a[224:227], v[80:83]
  buffer_load_dwordx4 a[188:191], v12, s[60:63], s92 offen offset:1024 sc1
  v_cndmask_b32 v161, v240, v13, s[66:67]
  v_mfma_f32_16x16x32_bf16 v[84:87], a[192:195], a[228:231], v[84:87]
  v_cndmask_b32 v165, v241, v13, s[66:67]
  v_cndmask_b32 v169, v14, v6, s[66:67]
  v_mfma_f32_16x16x32_bf16 v[88:91], a[192:195], a[232:235], v[88:91]
  v_cndmask_b32 v173, v14, v7, s[66:67]
  v_mfma_f32_16x16x32_bf16 v[92:95], a[192:195], a[236:239], v[92:95]
  s_waitcnt vmcnt(50) lgkmcnt(0)
  s_cmp_eq_u32 s85, 2
  s_cselect_b64 s[66:67], s[64:65], 0
  v_mfma_f32_16x16x32_bf16 v[16:19], a[196:199], a[240:243], v[16:19]
  ds_read_b128 a[224:227], v10 offset:12288
  v_cndmask_b32 v162, v240, v13, s[66:67]
  v_mfma_f32_16x16x32_bf16 v[20:23], a[196:199], a[244:247], v[20:23]
  s_add_u32 s90, s89, 92160
  s_add_u32 s91, s89, 165888
  v_mfma_f32_16x16x32_bf16 v[24:27], a[196:199], a[248:251], v[24:27]
  ds_read_b128 a[228:231], v10 offset:13312
  v_cndmask_b32 v166, v241, v13, s[66:67]
  v_mfma_f32_16x16x32_bf16 v[28:31], a[196:199], a[252:255], v[28:31]
  s_mul_i32 s92, s94, 9216
  s_add_u32 s92, s92, s90
  v_mfma_f32_16x16x32_bf16 v[44:47], a[200:203], a[252:255], v[44:47]
  ds_read_b128 a[232:235], v10 offset:14336
  buffer_load_dwordx4 a[192:195], v12, s[60:63], s92 offen offset:0 sc1
  v_mfma_f32_16x16x32_bf16 v[40:43], a[200:203], a[248:251], v[40:43]
  buffer_load_dwordx4 v[200:203], v247, s[60:63], s32 offen sc1
  v_cndmask_b32 v170, v14, v6, s[66:67]
  v_mfma_f32_16x16x32_bf16 v[36:39], a[200:203], a[244:247], v[36:39]
  ds_read_b128 a[236:239], v10 offset:15360
  v_cndmask_b32 v174, v14, v7, s[66:67]
  v_mfma_f32_16x16x32_bf16 v[32:35], a[200:203], a[240:243], v[32:35]
  s_cmp_eq_u32 s85, 3
  s_cselect_b64 s[66:67], s[64:65], 0
  v_mfma_f32_16x16x32_bf16 v[48:51], a[204:207], a[240:243], v[48:51]
  buffer_load_dwordx4 v[204:207], v250, s[52:55], s38 offen offset:0
  v_cndmask_b32 v163, v240, v13, s[66:67]
  v_mfma_f32_16x16x32_bf16 v[52:55], a[204:207], a[244:247], v[52:55]
  buffer_load_dwordx4 a[196:199], v12, s[60:63], s92 offen offset:1024 sc1
  v_cndmask_b32 v167, v241, v13, s[66:67]
  v_mfma_f32_16x16x32_bf16 v[56:59], a[204:207], a[248:251], v[56:59]
  v_cndmask_b32 v171, v14, v6, s[66:67]
  v_cndmask_b32 v175, v14, v7, s[66:67]
  v_mfma_f32_16x16x32_bf16 v[60:63], a[204:207], a[252:255], v[60:63]
  s_add_u32 s86, s72, 1
  s_and_b32 s86, s86, 7
  s_mul_i32 s24, s86, 9216
  v_mfma_f32_16x16x32_bf16 v[76:79], a[208:211], a[252:255], v[76:79]
  s_add_u32 s92, s92, 9216
  s_cmp_eq_u32 s92, s91
  s_cselect_b32 s92, s90, s92
  v_mfma_f32_16x16x32_bf16 v[72:75], a[208:211], a[248:251], v[72:75]
  buffer_load_dwordx4 v[208:211], v247, s[60:63], s33 offen sc1
  buffer_load_dwordx4 a[200:203], v12, s[60:63], s92 offen offset:0 sc1
  v_mfma_f32_16x16x32_bf16 v[68:71], a[208:211], a[244:247], v[68:71]
  s_add_u32 s86, s72, 2
  s_and_b32 s86, s86, 7
  s_mul_i32 s25, s86, 9216
  v_mfma_f32_16x16x32_bf16 v[64:67], a[208:211], a[240:243], v[64:67]
  s_add_u32 s86, s72, 3
  s_and_b32 s86, s86, 7
  s_mul_i32 s26, s86, 9216
  v_mfma_f32_16x16x32_bf16 v[80:83], a[212:215], a[240:243], v[80:83]
  buffer_load_dwordx4 v[212:215], v250, s[52:55], s38 offen offset:128
  v_mfma_f32_16x16x32_bf16 v[84:87], a[212:215], a[244:247], v[84:87]
  s_add_u32 s86, s72, 4
  s_and_b32 s86, s86, 7
  s_mul_i32 s27, s86, 9216
  v_mfma_f32_16x16x32_bf16 v[88:91], a[212:215], a[248:251], v[88:91]
  s_add_u32 s86, s72, 5
  s_and_b32 s86, s86, 7
  s_mul_i32 s34, s86, 9216
  v_mfma_f32_16x16x32_bf16 v[92:95], a[212:215], a[252:255], v[92:95]
  s_waitcnt vmcnt(52) lgkmcnt(0)
  s_add_u32 s86, s72, 6
  s_and_b32 s86, s86, 7
  s_mul_i32 s35, s86, 9216
  v_mfma_f32_16x16x32_bf16 v[16:19], a[216:219], a[224:227], v[16:19]
  ds_read_b128 a[240:243], v10 offset:16384
  buffer_load_dwordx4 a[204:207], v12, s[60:63], s92 offen offset:1024 sc1
  v_mfma_f32_16x16x32_bf16 v[20:23], a[216:219], a[228:231], v[20:23]
  buffer_load_dwordx2 v[216:217], v247, s[60:63], s36 offen sc1
  v_mfma_f32_16x16x32_bf16 v[24:27], a[216:219], a[232:235], v[24:27]
  ds_read_b128 a[244:247], v10 offset:17408
  v_mfma_f32_16x16x32_bf16 v[28:31], a[216:219], a[236:239], v[28:31]
  s_add_u32 s86, s72, 7
  s_and_b32 s86, s86, 7
  s_mul_i32 s37, s86, 9216
  v_mfma_f32_16x16x32_bf16 v[44:47], a[220:223], a[236:239], v[44:47]
  ds_read_b128 a[248:251], v10 offset:18432
  buffer_load_dwordx2 v[218:219], v250, s[52:55], s39 offen offset:0
  v_mfma_f32_16x16x32_bf16 v[40:43], a[220:223], a[232:235], v[40:43]
  v_mfma_f32_16x16x32_bf16 v[36:39], a[220:223], a[228:231], v[36:39]
  ds_read_b128 a[252:255], v10 offset:19456
  v_mfma_f32_16x16x32_bf16 v[32:35], a[220:223], a[224:227], v[32:35]
  v_mfma_f32_16x16x32_bf16 v[48:51], a[0:3], a[224:227], v[48:51]
  s_add_u32 s92, s92, 9216
  s_cmp_eq_u32 s92, s91
  s_cselect_b32 s92, s90, s92
  v_mfma_f32_16x16x32_bf16 v[52:55], a[0:3], a[228:231], v[52:55]
  buffer_load_dwordx4 a[208:211], v12, s[60:63], s92 offen offset:0 sc1
  v_mfma_f32_16x16x32_bf16 v[56:59], a[0:3], a[232:235], v[56:59]
  v_mfma_f32_16x16x32_bf16 v[60:63], a[0:3], a[236:239], v[60:63]
  v_mfma_f32_16x16x32_bf16 v[76:79], a[4:7], a[236:239], v[76:79]
  buffer_load_dwordx4 a[212:215], v12, s[60:63], s92 offen offset:1024 sc1
  v_mfma_f32_16x16x32_bf16 v[72:75], a[4:7], a[232:235], v[72:75]
  v_mfma_f32_16x16x32_bf16 v[68:71], a[4:7], a[228:231], v[68:71]
  v_mfma_f32_16x16x32_bf16 v[64:67], a[4:7], a[224:227], v[64:67]
  s_add_u32 s92, s92, 9216
  s_cmp_eq_u32 s92, s91
  s_cselect_b32 s92, s90, s92
  v_mfma_f32_16x16x32_bf16 v[80:83], a[8:11], a[224:227], v[80:83]
  buffer_load_dwordx4 a[216:219], v12, s[60:63], s92 offen offset:0 sc1
  v_mfma_f32_16x16x32_bf16 v[84:87], a[8:11], a[228:231], v[84:87]
  v_mfma_f32_16x16x32_bf16 v[88:91], a[8:11], a[232:235], v[88:91]
  buffer_load_dwordx4 a[220:223], v12, s[60:63], s92 offen offset:1024 sc1
  v_mfma_f32_16x16x32_bf16 v[92:95], a[8:11], a[236:239], v[92:95]
  s_waitcnt vmcnt(54) lgkmcnt(0)
  v_mfma_f32_16x16x32_bf16 v[16:19], a[12:15], a[240:243], v[16:19]
  ds_read_b128 a[224:227], v10 offset:20480
  v_mfma_f32_16x16x32_bf16 v[20:23], a[12:15], a[244:247], v[20:23]
  s_add_u32 s92, s92, 9216
  s_cmp_eq_u32 s92, s91
  s_cselect_b32 s92, s90, s92
  v_mfma_f32_16x16x32_bf16 v[24:27], a[12:15], a[248:251], v[24:27]
  ds_read_b128 a[228:231], v10 offset:21504
  buffer_load_dwordx4 a[0:3], v12, s[60:63], s92 offen offset:0 sc1
  v_mfma_f32_16x16x32_bf16 v[28:31], a[12:15], a[252:255], v[28:31]
  v_mfma_f32_16x16x32_bf16 v[44:47], a[16:19], a[252:255], v[44:47]
  ds_read_b128 a[232:235], v10 offset:22528
  buffer_load_dwordx4 a[4:7], v12, s[60:63], s92 offen offset:1024 sc1
  v_mfma_f32_16x16x32_bf16 v[40:43], a[16:19], a[248:251], v[40:43]
  v_mfma_f32_16x16x32_bf16 v[36:39], a[16:19], a[244:247], v[36:39]
  ds_read_b128 a[236:239], v10 offset:23552
  v_mfma_f32_16x16x32_bf16 v[32:35], a[16:19], a[240:243], v[32:35]
  v_mfma_f32_16x16x32_bf16 v[48:51], a[20:23], a[240:243], v[48:51]
  s_add_u32 s92, s92, 9216
  s_cmp_eq_u32 s92, s91
  s_cselect_b32 s92, s90, s92
  v_mfma_f32_16x16x32_bf16 v[52:55], a[20:23], a[244:247], v[52:55]
  buffer_load_dwordx4 a[8:11], v12, s[60:63], s92 offen offset:0 sc1
  v_mfma_f32_16x16x32_bf16 v[56:59], a[20:23], a[248:251], v[56:59]
  v_mfma_f32_16x16x32_bf16 v[60:63], a[20:23], a[252:255], v[60:63]
  buffer_load_dwordx4 a[12:15], v12, s[60:63], s92 offen offset:1024 sc1
  v_mfma_f32_16x16x32_bf16 v[76:79], a[24:27], a[252:255], v[76:79]
  v_mfma_f32_16x16x32_bf16 v[72:75], a[24:27], a[248:251], v[72:75]
  v_mfma_f32_16x16x32_bf16 v[68:71], a[24:27], a[244:247], v[68:71]
  s_add_u32 s92, s92, 9216
  s_cmp_eq_u32 s92, s91
  s_cselect_b32 s92, s90, s92
  v_mfma_f32_16x16x32_bf16 v[64:67], a[24:27], a[240:243], v[64:67]
  buffer_load_dwordx4 a[16:19], v12, s[60:63], s92 offen offset:0 sc1
  v_mfma_f32_16x16x32_bf16 v[80:83], a[28:31], a[240:243], v[80:83]
  v_mfma_f32_16x16x32_bf16 v[84:87], a[28:31], a[244:247], v[84:87]
  buffer_load_dwordx4 a[20:23], v12, s[60:63], s92 offen offset:1024 sc1
  v_mfma_f32_16x16x32_bf16 v[88:91], a[28:31], a[248:251], v[88:91]
  v_mfma_f32_16x16x32_bf16 v[92:95], a[28:31], a[252:255], v[92:95]
  s_waitcnt vmcnt(55) lgkmcnt(0)
  v_mfma_f32_16x16x32_bf16 v[16:19], a[32:35], a[224:227], v[16:19]
  ds_read_b128 a[240:243], v10 offset:24576
  v_mfma_f32_16x16x32_bf16 v[20:23], a[32:35], a[228:231], v[20:23]
  s_add_u32 s92, s92, 9216
  s_cmp_eq_u32 s92, s91
  s_cselect_b32 s92, s90, s92
  v_mfma_f32_16x16x32_bf16 v[24:27], a[32:35], a[232:235], v[24:27]
  ds_read_b128 a[244:247], v10 offset:25600
  buffer_load_dwordx4 a[24:27], v12, s[60:63], s92 offen offset:0 sc1
  v_mfma_f32_16x16x32_bf16 v[28:31], a[32:35], a[236:239], v[28:31]
  v_mfma_f32_16x16x32_bf16 v[44:47], a[36:39], a[236:239], v[44:47]
  ds_read_b128 a[248:251], v10 offset:26624
  buffer_load_dwordx4 a[28:31], v12, s[60:63], s92 offen offset:1024 sc1
  v_mfma_f32_16x16x32_bf16 v[40:43], a[36:39], a[232:235], v[40:43]
  v_mfma_f32_16x16x32_bf16 v[36:39], a[36:39], a[228:231], v[36:39]
  ds_read_b128 a[252:255], v10 offset:27648
  v_mfma_f32_16x16x32_bf16 v[32:35], a[36:39], a[224:227], v[32:35]
  s_add_u32 s90, s89, 0
  s_add_u32 s91, s89, 92160
  v_mfma_f32_16x16x32_bf16 v[48:51], a[40:43], a[224:227], v[48:51]
  s_mul_i32 s92, s93, 9216
  s_add_u32 s92, s92, s90
  v_mfma_f32_16x16x32_bf16 v[52:55], a[40:43], a[228:231], v[52:55]
  buffer_load_dwordx4 a[32:35], v12, s[60:63], s92 offen offset:2048 sc1
  v_mfma_f32_16x16x32_bf16 v[56:59], a[40:43], a[232:235], v[56:59]
  buffer_load_dwordx4 a[36:39], v12, s[60:63], s92 offen offset:3072 sc1
  v_mfma_f32_16x16x32_bf16 v[60:63], a[40:43], a[236:239], v[60:63]
  v_mfma_f32_16x16x32_bf16 v[76:79], a[44:47], a[236:239], v[76:79]
  v_mfma_f32_16x16x32_bf16 v[72:75], a[44:47], a[232:235], v[72:75]
  v_mfma_f32_16x16x32_bf16 v[68:71], a[44:47], a[228:231], v[68:71]
  s_add_u32 s92, s92, 9216
  s_cmp_eq_u32 s92, s91
  s_cselect_b32 s92, s90, s92
  v_mfma_f32_16x16x32_bf16 v[64:67], a[44:47], a[224:227], v[64:67]
  buffer_load_dwordx4 a[40:43], v12, s[60:63], s92 offen offset:2048 sc1
  v_mfma_f32_16x16x32_bf16 v[80:83], a[48:51], a[224:227], v[80:83]
  v_mfma_f32_16x16x32_bf16 v[84:87], a[48:51], a[228:231], v[84:87]
  buffer_load_dwordx4 a[44:47], v12, s[60:63], s92 offen offset:3072 sc1
  v_mfma_f32_16x16x32_bf16 v[88:91], a[48:51], a[232:235], v[88:91]
  v_mfma_f32_16x16x32_bf16 v[92:95], a[48:51], a[236:239], v[92:95]
  s_waitcnt vmcnt(56) lgkmcnt(0)
  v_mfma_f32_16x16x32_bf16 v[16:19], a[52:55], a[240:243], v[16:19]
  ds_read_b128 a[224:227], v10 offset:28672
  v_mfma_f32_16x16x32_bf16 v[20:23], a[52:55], a[244:247], v[20:23]
  s_add_u32 s92, s92, 9216
  s_cmp_eq_u32 s92, s91
  s_cselect_b32 s92, s90, s92
  v_mfma_f32_16x16x32_bf16 v[24:27], a[52:55], a[248:251], v[24:27]
  ds_read_b128 a[228:231], v10 offset:29696
  buffer_load_dwordx4 a[48:51], v12, s[60:63], s92 offen offset:2048 sc1
  v_mfma_f32_16x16x32_bf16 v[28:31], a[52:55], a[252:255], v[28:31]
  v_mfma_f32_16x16x32_bf16 v[44:47], a[56:59], a[252:255], v[44:47]
  ds_read_b128 a[232:235], v10 offset:30720
  buffer_load_dwordx4 a[52:55], v12, s[60:63], s92 offen offset:3072 sc1
  v_mfma_f32_16x16x32_bf16 v[40:43], a[56:59], a[248:251], v[40:43]
  v_mfma_f32_16x16x32_bf16 v[36:39], a[56:59], a[244:247], v[36:39]
  ds_read_b128 a[236:239], v10 offset:31744
  v_mfma_f32_16x16x32_bf16 v[32:35], a[56:59], a[240:243], v[32:35]
  v_mfma_f32_16x16x32_bf16 v[48:51], a[60:63], a[240:243], v[48:51]
  s_add_u32 s92, s92, 9216
  s_cmp_eq_u32 s92, s91
  s_cselect_b32 s92, s90, s92
  v_mfma_f32_16x16x32_bf16 v[52:55], a[60:63], a[244:247], v[52:55]
  buffer_load_dwordx4 a[56:59], v12, s[60:63], s92 offen offset:2048 sc1
  v_mfma_f32_16x16x32_bf16 v[56:59], a[60:63], a[248:251], v[56:59]
  v_mfma_f32_16x16x32_bf16 v[60:63], a[60:63], a[252:255], v[60:63]
  v_mfma_f32_16x16x32_bf16 v[76:79], a[64:67], a[252:255], v[76:79]
  buffer_load_dwordx4 a[60:63], v12, s[60:63], s92 offen offset:3072 sc1
  v_mfma_f32_16x16x32_bf16 v[72:75], a[64:67], a[248:251], v[72:75]
  v_mfma_f32_16x16x32_bf16 v[68:71], a[64:67], a[244:247], v[68:71]
  v_mfma_f32_16x16x32_bf16 v[64:67], a[64:67], a[240:243], v[64:67]
  v_mfma_f32_16x16x32_bf16 v[80:83], a[68:71], a[240:243], v[80:83]
  s_add_u32 s92, s92, 9216
  s_cmp_eq_u32 s92, s91
  s_cselect_b32 s92, s90, s92
  v_mfma_f32_16x16x32_bf16 v[84:87], a[68:71], a[244:247], v[84:87]
  buffer_load_dwordx4 a[64:67], v12, s[60:63], s92 offen offset:2048 sc1
  v_mfma_f32_16x16x32_bf16 v[88:91], a[68:71], a[248:251], v[88:91]
  v_mfma_f32_16x16x32_bf16 v[92:95], a[68:71], a[252:255], v[92:95]
  s_waitcnt vmcnt(56) lgkmcnt(0)
  v_mfma_f32_16x16x32_bf16 v[16:19], a[72:75], a[224:227], v[16:19]
  ds_read_b128 a[240:243], v10 offset:32768
  buffer_load_dwordx4 a[68:71], v12, s[60:63], s92 offen offset:3072 sc1
  v_mfma_f32_16x16x32_bf16 v[20:23], a[72:75], a[228:231], v[20:23]
  v_mfma_f32_16x16x32_bf16 v[24:27], a[72:75], a[232:235], v[24:27]
  ds_read_b128 a[244:247], v10 offset:33792
  v_mfma_f32_16x16x32_bf16 v[28:31], a[72:75], a[236:239], v[28:31]
  v_mfma_f32_16x16x32_bf16 v[44:47], a[76:79], a[236:239], v[44:47]
  ds_read_b128 a[248:251], v10 offset:34816
  v_mfma_f32_16x16x32_bf16 v[40:43], a[76:79], a[232:235], v[40:43]
  s_add_u32 s92, s92, 9216
  s_cmp_eq_u32 s92, s91
  s_cselect_b32 s92, s90, s92
  v_mfma_f32_16x16x32_bf16 v[36:39], a[76:79], a[228:231], v[36:39]
  ds_read_b128 a[252:255], v10 offset:35840
  buffer_load_dwordx4 a[72:75], v12, s[60:63], s92 offen offset:2048 sc1
  v_mfma_f32_16x16x32_bf16 v[32:35], a[76:79], a[224:227], v[32:35]
  v_mfma_f32_16x16x32_bf16 v[48:51], a[80:83], a[224:227], v[48:51]
  buffer_load_dwordx4 a[76:79], v12, s[60:63], s92 offen offset:3072 sc1
  v_mfma_f32_16x16x32_bf16 v[52:55], a[80:83], a[228:231], v[52:55]
  v_mfma_f32_16x16x32_bf16 v[56:59], a[80:83], a[232:235], v[56:59]
  v_mfma_f32_16x16x32_bf16 v[60:63], a[80:83], a[236:239], v[60:63]
  v_mfma_f32_16x16x32_bf16 v[76:79], a[84:87], a[236:239], v[76:79]
  s_add_u32 s92, s92, 9216
  s_cmp_eq_u32 s92, s91
  s_cselect_b32 s92, s90, s92
  v_mfma_f32_16x16x32_bf16 v[72:75], a[84:87], a[232:235], v[72:75]
  buffer_load_dwordx4 a[80:83], v12, s[60:63], s92 offen offset:2048 sc1
  v_mfma_f32_16x16x32_bf16 v[68:71], a[84:87], a[228:231], v[68:71]
  v_mfma_f32_16x16x32_bf16 v[64:67], a[84:87], a[224:227], v[64:67]
  v_mfma_f32_16x16x32_bf16 v[80:83], a[88:91], a[224:227], v[80:83]
  buffer_load_dwordx4 a[84:87], v12, s[60:63], s92 offen offset:3072 sc1
  v_mfma_f32_16x16x32_bf16 v[84:87], a[88:91], a[228:231], v[84:87]
  v_mfma_f32_16x16x32_bf16 v[88:91], a[88:91], a[232:235], v[88:91]
  v_mfma_f32_16x16x32_bf16 v[92:95], a[88:91], a[236:239], v[92:95]
  s_waitcnt vmcnt(56) lgkmcnt(0)
  v_mfma_f32_16x16x32_bf16 v[16:19], a[92:95], a[240:243], v[16:19]
  ds_read_b128 a[224:227], v9 offset:0
  v_mfma_f32_16x16x32_bf16 v[20:23], a[92:95], a[244:247], v[20:23]
  s_add_u32 s92, s92, 9216
  s_cmp_eq_u32 s92, s91
  s_cselect_b32 s92, s90, s92
  v_mfma_f32_16x16x32_bf16 v[24:27], a[92:95], a[248:251], v[24:27]
  ds_read_b128 a[228:231], v9 offset:1024
  buffer_load_dwordx4 a[88:91], v12, s[60:63], s92 offen offset:2048 sc1
  v_mfma_f32_16x16x32_bf16 v[28:31], a[92:95], a[252:255], v[28:31]
  v_mfma_f32_16x16x32_bf16 v[44:47], a[96:99], a[252:255], v[44:47]
  ds_read_b128 a[232:235], v9 offset:2048
  buffer_load_dwordx4 a[92:95], v12, s[60:63], s92 offen offset:3072 sc1
  v_mfma_f32_16x16x32_bf16 v[40:43], a[96:99], a[248:251], v[40:43]
  v_mfma_f32_16x16x32_bf16 v[36:39], a[96:99], a[244:247], v[36:39]
  ds_read_b128 a[236:239], v9 offset:3072
  v_mfma_f32_16x16x32_bf16 v[32:35], a[96:99], a[240:243], v[32:35]
  v_mfma_f32_16x16x32_bf16 v[48:51], a[100:103], a[240:243], v[48:51]
  s_add_u32 s92, s92, 9216
  s_cmp_eq_u32 s92, s91
  s_cselect_b32 s92, s90, s92
  v_mfma_f32_16x16x32_bf16 v[52:55], a[100:103], a[244:247], v[52:55]
  buffer_load_dwordx4 a[96:99], v12, s[60:63], s92 offen offset:2048 sc1
  v_mfma_f32_16x16x32_bf16 v[56:59], a[100:103], a[248:251], v[56:59]
  v_mfma_f32_16x16x32_bf16 v[60:63], a[100:103], a[252:255], v[60:63]
  v_mfma_f32_16x16x32_bf16 v[76:79], a[104:107], a[252:255], v[76:79]
  buffer_load_dwordx4 a[100:103], v12, s[60:63], s92 offen offset:3072 sc1
  v_mfma_f32_16x16x32_bf16 v[72:75], a[104:107], a[248:251], v[72:75]
  v_mfma_f32_16x16x32_bf16 v[68:71], a[104:107], a[244:247], v[68:71]
  v_mfma_f32_16x16x32_bf16 v[64:67], a[104:107], a[240:243], v[64:67]
  v_mfma_f32_16x16x32_bf16 v[80:83], a[108:111], a[240:243], v[80:83]
  s_add_u32 s92, s92, 9216
  s_cmp_eq_u32 s92, s91
  s_cselect_b32 s92, s90, s92
  v_mfma_f32_16x16x32_bf16 v[84:87], a[108:111], a[244:247], v[84:87]
  buffer_load_dwordx4 a[104:107], v12, s[60:63], s92 offen offset:2048 sc1
  v_mfma_f32_16x16x32_bf16 v[88:91], a[108:111], a[248:251], v[88:91]
  v_mfma_f32_16x16x32_bf16 v[92:95], a[108:111], a[252:255], v[92:95]
  s_waitcnt vmcnt(59) lgkmcnt(0)
  v_mfma_f32_16x16x32_bf16 v[96:99], a[112:115], a[224:227], 0
  ds_read_b128 a[240:243], v9 offset:4096
  buffer_load_dwordx4 a[108:111], v12, s[60:63], s92 offen offset:3072 sc1
  v_mfma_f32_16x16x32_bf16 v[100:103], a[112:115], a[228:231], 0
  ds_read_b128 a[244:247], v9 offset:5120
  s_waitcnt vmcnt(40)
  v_lshlrev_b32 v220, 16, v200
  v_mfma_f32_16x16x32_bf16 v[104:107], a[112:115], a[232:235], 0
  ds_read_b128 a[248:251], v9 offset:6144
  v_and_b32 v221, s98, v200
  v_mfma_f32_16x16x32_bf16 v[108:111], a[112:115], a[236:239], 0
  ds_read_b128 a[252:255], v9 offset:7168
  v_lshlrev_b32 v222, 16, v201
  v_mfma_f32_16x16x32_bf16 v[124:127], a[116:119], a[236:239], 0
  v_cvt_pk_bf16_f32 v176, v16, v17
  v_cvt_pk_bf16_f32 v177, v18, v19
  v_mfma_f32_16x16x32_bf16 v[120:123], a[116:119], a[232:235], 0
  v_cvt_pk_bf16_f32 v178, v32, v33
  v_cvt_pk_bf16_f32 v179, v34, v35
  v_mfma_f32_16x16x32_bf16 v[116:119], a[116:119], a[228:231], 0
  buffer_store_dwordx4 v[176:179], v160, s[60:63], s80 offen offset:0 sc1
  v_and_b32 v223, s98, v201
  v_mfma_f32_16x16x32_bf16 v[112:115], a[116:119], a[224:227], 0
  s_waitcnt lgkmcnt(0)
  s_add_u32 s90, s89, 92160
  s_add_u32 s91, s89, 165888
  v_mfma_f32_16x16x32_bf16 v[96:99], a[120:123], a[240:243], v[96:99]
  ds_read_b128 a[224:227], v9 offset:8192
  v_lshlrev_b32 v224, 16, v202
  v_mfma_f32_16x16x32_bf16 v[100:103], a[120:123], a[244:247], v[100:103]
  ds_read_b128 a[228:231], v9 offset:9216
  v_and_b32 v225, s98, v202
  v_mfma_f32_16x16x32_bf16 v[104:107], a[120:123], a[248:251], v[104:107]
  ds_read_b128 a[232:235], v9 offset:10240
  v_lshlrev_b32 v226, 16, v203
  v_mfma_f32_16x16x32_bf16 v[108:111], a[120:123], a[252:255], v[108:111]
  ds_read_b128 a[236:239], v9 offset:11264
  v_and_b32 v227, s98, v203
  v_mfma_f32_16x16x32_bf16 v[124:127], a[124:127], a[252:255], v[124:127]
  ds_write_b128 v168, v[176:179] offset:0
  v_mfma_f32_16x16x32_bf16 v[120:123], a[124:127], a[248:251], v[120:123]
  s_mul_i32 s92, s94, 9216
  s_add_u32 s92, s92, s90
  v_mfma_f32_16x16x32_bf16 v[116:119], a[124:127], a[244:247], v[116:119]
  buffer_load_dwordx4 a[112:115], v12, s[60:63], s92 offen offset:2048 sc1
  s_waitcnt vmcnt(41)
  v_lshlrev_b32 v192, 16, v204
  v_mfma_f32_16x16x32_bf16 v[112:115], a[124:127], a[240:243], v[112:115]
  s_waitcnt lgkmcnt(1)
  buffer_load_dwordx4 a[116:119], v12, s[60:63], s92 offen offset:3072 sc1
  v_and_b32 v193, s98, v204
  v_mfma_f32_16x16x32_bf16 v[96:99], a[128:131], a[224:227], v[96:99]
  ds_read_b128 a[240:243], v9 offset:12288
  v_lshlrev_b32 v194, 16, v205
  v_mfma_f32_16x16x32_bf16 v[100:103], a[128:131], a[228:231], v[100:103]
  ds_read_b128 a[244:247], v9 offset:13312
  v_and_b32 v195, s98, v205
  v_mfma_f32_16x16x32_bf16 v[104:107], a[128:131], a[232:235], v[104:107]
  ds_read_b128 a[248:251], v9 offset:14336
  v_lshlrev_b32 v196, 16, v206
  v_mfma_f32_16x16x32_bf16 v[108:111], a[128:131], a[236:239], v[108:111]
  ds_read_b128 a[252:255], v9 offset:15360
  v_and_b32 v197, s98, v206
  v_mfma_f32_16x16x32_bf16 v[124:127], a[132:135], a[236:239], v[124:127]
  v_cvt_pk_bf16_f32 v180, v48, v49
  v_cvt_pk_bf16_f32 v181, v50, v51
  v_mfma_f32_16x16x32_bf16 v[120:123], a[132:135], a[232:235], v[120:123]
  v_cvt_pk_bf16_f32 v182, v64, v65
  v_cvt_pk_bf16_f32 v183, v66, v67
  v_mfma_f32_16x16x32_bf16 v[116:119], a[132:135], a[228:231], v[116:119]
  buffer_store_dwordx4 v[180:183], v160, s[60:63], s80 offen offset:512 sc1
  v_lshlrev_b32 v198, 16, v207
  v_mfma_f32_16x16x32_bf16 v[112:115], a[132:135], a[224:227], v[112:115]
  s_waitcnt lgkmcnt(0)
  v_and_b32 v199, s98, v207
  v_add_f32 v220, v220, v192
  v_mfma_f32_16x16x32_bf16 v[96:99], a[136:139], a[240:243], v[96:99]
  ds_read_b128 a[224:227], v9 offset:16384
  v_add_f32 v221, v221, v193
  v_mfma_f32_16x16x32_bf16 v[100:103], a[136:139], a[244:247], v[100:103]
  ds_read_b128 a[228:231], v9 offset:17408
  v_add_f32 v222, v222, v194
  v_mfma_f32_16x16x32_bf16 v[104:107], a[136:139], a[248:251], v[104:107]
  ds_read_b128 a[232:235], v9 offset:18432
  v_add_f32 v223, v223, v195
  v_mfma_f32_16x16x32_bf16 v[108:111], a[136:139], a[252:255], v[108:111]
  ds_read_b128 a[236:239], v9 offset:19456
  v_add_f32 v224, v224, v196
  v_mfma_f32_16x16x32_bf16 v[124:127], a[140:143], a[252:255], v[124:127]
  ds_write_b128 v168, v[180:183] offset:512
  v_mfma_f32_16x16x32_bf16 v[120:123], a[140:143], a[248:251], v[120:123]
  s_add_u32 s92, s92, 9216
  s_cmp_eq_u32 s92, s91
  s_cselect_b32 s92, s90, s92
  v_mfma_f32_16x16x32_bf16 v[116:119], a[140:143], a[244:247], v[116:119]
  buffer_load_dwordx4 a[120:123], v12, s[60:63], s92 offen offset:2048 sc1
  v_add_f32 v225, v225, v197
  v_mfma_f32_16x16x32_bf16 v[112:115], a[140:143], a[240:243], v[112:115]
  s_waitcnt lgkmcnt(1)
  buffer_load_dwordx4 a[124:127], v12, s[60:63], s92 offen offset:3072 sc1
  v_add_f32 v226, v226, v198
  v_mfma_f32_16x16x32_bf16 v[96:99], a[144:147], a[224:227], v[96:99]
  ds_read_b128 a[240:243], v9 offset:20480
  v_add_f32 v227, v227, v199
  v_mfma_f32_16x16x32_bf16 v[100:103], a[144:147], a[228:231], v[100:103]
  ds_read_b128 a[244:247], v9 offset:21504
  s_waitcnt vmcnt(43)
  v_lshlrev_b32 v228, 16, v208
  v_mfma_f32_16x16x32_bf16 v[104:107], a[144:147], a[232:235], v[104:107]
  ds_read_b128 a[248:251], v9 offset:22528
  v_and_b32 v229, s98, v208
  v_mfma_f32_16x16x32_bf16 v[108:111], a[144:147], a[236:239], v[108:111]
  ds_read_b128 a[252:255], v9 offset:23552
  v_lshlrev_b32 v230, 16, v209
  v_mfma_f32_16x16x32_bf16 v[124:127], a[148:151], a[236:239], v[124:127]
  v_cvt_pk_bf16_f32 v184, v20, v21
  v_cvt_pk_bf16_f32 v185, v22, v23
  v_mfma_f32_16x16x32_bf16 v[120:123], a[148:151], a[232:235], v[120:123]
  v_cvt_pk_bf16_f32 v186, v36, v37
  v_cvt_pk_bf16_f32 v187, v38, v39
  v_mfma_f32_16x16x32_bf16 v[116:119], a[148:151], a[228:231], v[116:119]
  buffer_store_dwordx4 v[184:187], v161, s[60:63], s81 offen offset:0 sc1
  v_and_b32 v231, s98, v209
  v_mfma_f32_16x16x32_bf16 v[112:115], a[148:151], a[224:227], v[112:115]
  s_waitcnt lgkmcnt(0)
  v_lshlrev_b32 v232, 16, v210
  v_and_b32 v233, s98, v210
  v_mfma_f32_16x16x32_bf16 v[96:99], a[152:155], a[240:243], v[96:99]
  ds_read_b128 a[224:227], v9 offset:24576
  v_lshlrev_b32 v234, 16, v211
  v_mfma_f32_16x16x32_bf16 v[100:103], a[152:155], a[244:247], v[100:103]
  ds_read_b128 a[228:231], v9 offset:25600
  v_and_b32 v235, s98, v211
  v_mfma_f32_16x16x32_bf16 v[104:107], a[152:155], a[248:251], v[104:107]
  ds_read_b128 a[232:235], v9 offset:26624
  s_waitcnt vmcnt(42)
  v_lshlrev_b32 v192, 16, v212
  v_mfma_f32_16x16x32_bf16 v[108:111], a[152:155], a[252:255], v[108:111]
  ds_read_b128 a[236:239], v9 offset:27648
  v_and_b32 v193, s98, v212
  v_mfma_f32_16x16x32_bf16 v[124:127], a[156:159], a[252:255], v[124:127]
  ds_write_b128 v169, v[184:187] offset:0
  v_mfma_f32_16x16x32_bf16 v[120:123], a[156:159], a[248:251], v[120:123]
  s_add_u32 s92, s92, 9216
  s_cmp_eq_u32 s92, s91
  s_cselect_b32 s92, s90, s92
  v_mfma_f32_16x16x32_bf16 v[116:119], a[156:159], a[244:247], v[116:119]
  buffer_load_dwordx4 a[128:131], v12, s[60:63], s92 offen offset:2048 sc1
  v_lshlrev_b32 v194, 16, v213
  v_mfma_f32_16x16x32_bf16 v[112:115], a[156:159], a[240:243], v[112:115]
  s_waitcnt lgkmcnt(1)
  buffer_load_dwordx4 a[132:135], v12, s[60:63], s92 offen offset:3072 sc1
  v_and_b32 v195, s98, v213
  v_mfma_f32_16x16x32_bf16 v[96:99], a[160:163], a[224:227], v[96:99]
  ds_read_b128 a[240:243], v9 offset:28672
  v_lshlrev_b32 v196, 16, v214
  v_mfma_f32_16x16x32_bf16 v[100:103], a[160:163], a[228:231], v[100:103]
  ds_read_b128 a[244:247], v9 offset:29696
  v_and_b32 v197, s98, v214
  v_mfma_f32_16x16x32_bf16 v[104:107], a[160:163], a[232:235], v[104:107]
  ds_read_b128 a[248:251], v9 offset:30720
  v_lshlrev_b32 v198, 16, v215
  v_mfma_f32_16x16x32_bf16 v[108:111], a[160:163], a[236:239], v[108:111]
  ds_read_b128 a[252:255], v9 offset:31744
  v_and_b32 v199, s98, v215
  v_mfma_f32_16x16x32_bf16 v[124:127], a[164:167], a[236:239], v[124:127]
  v_cvt_pk_bf16_f32 v188, v52, v53
  v_cvt_pk_bf16_f32 v189, v54, v55
  v_mfma_f32_16x16x32_bf16 v[120:123], a[164:167], a[232:235], v[120:123]
  v_cvt_pk_bf16_f32 v190, v68, v69
  v_cvt_pk_bf16_f32 v191, v70, v71
  v_mfma_f32_16x16x32_bf16 v[116:119], a[164:167], a[228:231], v[116:119]
  buffer_store_dwordx4 v[188:191], v161, s[60:63], s81 offen offset:512 sc1
  v_add_f32 v228, v228, v192
  v_mfma_f32_16x16x32_bf16 v[112:115], a[164:167], a[224:227], v[112:115]
  s_waitcnt lgkmcnt(0)
  v_add_f32 v229, v229, v193
  v_add_f32 v230, v230, v194
  v_mfma_f32_16x16x32_bf16 v[96:99], a[168:171], a[240:243], v[96:99]
  ds_read_b128 a[224:227], v9 offset:32768
  v_add_f32 v231, v231, v195
  v_mfma_f32_16x16x32_bf16 v[100:103], a[168:171], a[244:247], v[100:103]
  ds_read_b128 a[228:231], v9 offset:33792
  v_add_f32 v232, v232, v196
  v_mfma_f32_16x16x32_bf16 v[104:107], a[168:171], a[248:251], v[104:107]
  ds_read_b128 a[232:235], v9 offset:34816
  v_add_f32 v233, v233, v197
  v_mfma_f32_16x16x32_bf16 v[108:111], a[168:171], a[252:255], v[108:111]
  ds_read_b128 a[236:239], v9 offset:35840
  v_add_f32 v234, v234, v198
  v_mfma_f32_16x16x32_bf16 v[124:127], a[172:175], a[252:255], v[124:127]
  ds_write_b128 v169, v[188:191] offset:512
  v_mfma_f32_16x16x32_bf16 v[120:123], a[172:175], a[248:251], v[120:123]
  s_add_u32 s92, s92, 9216
  s_cmp_eq_u32 s92, s91
  s_cselect_b32 s92, s90, s92
  v_mfma_f32_16x16x32_bf16 v[116:119], a[172:175], a[244:247], v[116:119]
  buffer_load_dwordx4 a[136:139], v12, s[60:63], s92 offen offset:2048 sc1
  v_add_f32 v235, v235, v199
  v_mfma_f32_16x16x32_bf16 v[112:115], a[172:175], a[240:243], v[112:115]
  s_waitcnt lgkmcnt(1)
  buffer_load_dwordx4 a[140:143], v12, s[60:63], s92 offen offset:3072 sc1
  s_waitcnt vmcnt(45)
  v_lshlrev_b32 v236, 16, v216
  v_mfma_f32_16x16x32_bf16 v[96:99], a[176:179], a[224:227], v[96:99]
  ds_read_b128 a[240:243], v10 offset:0
  v_and_b32 v237, s98, v216
  v_mfma_f32_16x16x32_bf16 v[100:103], a[176:179], a[228:231], v[100:103]
  ds_read_b128 a[244:247], v10 offset:1024
  v_lshlrev_b32 v238, 16, v217
  v_mfma_f32_16x16x32_bf16 v[104:107], a[176:179], a[232:235], v[104:107]
  ds_read_b128 a[248:251], v10 offset:2048
  v_and_b32 v239, s98, v217
  v_mfma_f32_16x16x32_bf16 v[108:111], a[176:179], a[236:239], v[108:111]
  ds_read_b128 a[252:255], v10 offset:3072
  s_waitcnt vmcnt(44)
  v_lshlrev_b32 v192, 16, v218
  v_mfma_f32_16x16x32_bf16 v[124:127], a[180:183], a[236:239], v[124:127]
  v_cvt_pk_bf16_f32 v176, v24, v25
  v_cvt_pk_bf16_f32 v177, v26, v27
  v_mfma_f32_16x16x32_bf16 v[120:123], a[180:183], a[232:235], v[120:123]
  v_cvt_pk_bf16_f32 v178, v40, v41
  v_cvt_pk_bf16_f32 v179, v42, v43
  v_mfma_f32_16x16x32_bf16 v[116:119], a[180:183], a[228:231], v[116:119]
  buffer_store_dwordx4 v[176:179], v162, s[60:63], s82 offen offset:0 sc1
  v_and_b32 v193, s98, v218
  v_mfma_f32_16x16x32_bf16 v[112:115], a[180:183], a[224:227], v[112:115]
  s_waitcnt lgkmcnt(0)
  v_lshlrev_b32 v194, 16, v219
  v_and_b32 v195, s98, v219
  v_mfma_f32_16x16x32_bf16 v[96:99], a[184:187], a[240:243], v[96:99]
  ds_read_b128 a[224:227], v10 offset:4096
  v_add_f32 v236, v236, v192
  v_mfma_f32_16x16x32_bf16 v[100:103], a[184:187], a[244:247], v[100:103]
  ds_read_b128 a[228:231], v10 offset:5120
  v_add_f32 v237, v237, v193
  v_mfma_f32_16x16x32_bf16 v[104:107], a[184:187], a[248:251], v[104:107]
  ds_read_b128 a[232:235], v10 offset:6144
  v_add_f32 v238, v238, v194
  v_mfma_f32_16x16x32_bf16 v[108:111], a[184:187], a[252:255], v[108:111]
  ds_read_b128 a[236:239], v10 offset:7168
  v_add_f32 v239, v239, v195
  v_mfma_f32_16x16x32_bf16 v[124:127], a[188:191], a[252:255], v[124:127]
  ds_write_b128 v170, v[176:179] offset:0
  v_mfma_f32_16x16x32_bf16 v[120:123], a[188:191], a[248:251], v[120:123]
  s_add_u32 s92, s92, 9216
  s_cmp_eq_u32 s92, s91
  s_cselect_b32 s92, s90, s92
  v_mfma_f32_16x16x32_bf16 v[116:119], a[188:191], a[244:247], v[116:119]
  buffer_load_dwordx4 a[144:147], v12, s[60:63], s92 offen offset:2048 sc1
  v_mfma_f32_16x16x32_bf16 v[112:115], a[188:191], a[240:243], v[112:115]
  s_waitcnt lgkmcnt(1)
  buffer_load_dwordx4 a[148:151], v12, s[60:63], s92 offen offset:3072 sc1
  v_mfma_f32_16x16x32_bf16 v[96:99], a[192:195], a[224:227], v[96:99]
  ds_read_b128 a[240:243], v10 offset:8192
  v_mfma_f32_16x16x32_bf16 v[100:103], a[192:195], a[228:231], v[100:103]
  ds_read_b128 a[244:247], v10 offset:9216
  v_mfma_f32_16x16x32_bf16 v[104:107], a[192:195], a[232:235], v[104:107]
  ds_read_b128 a[248:251], v10 offset:10240
  v_mfma_f32_16x16x32_bf16 v[108:111], a[192:195], a[236:239], v[108:111]
  ds_read_b128 a[252:255], v10 offset:11264
  v_mfma_f32_16x16x32_bf16 v[124:127], a[196:199], a[236:239], v[124:127]
  v_cvt_pk_bf16_f32 v180, v56, v57
  v_cvt_pk_bf16_f32 v181, v58, v59
  v_mfma_f32_16x16x32_bf16 v[120:123], a[196:199], a[232:235], v[120:123]
  v_cvt_pk_bf16_f32 v182, v72, v73
  v_cvt_pk_bf16_f32 v183, v74, v75
  v_mfma_f32_16x16x32_bf16 v[116:119], a[196:199], a[228:231], v[116:119]
  buffer_store_dwordx4 v[180:183], v162, s[60:63], s82 offen offset:512 sc1
  v_mfma_f32_16x16x32_bf16 v[112:115], a[196:199], a[224:227], v[112:115]
  s_waitcnt lgkmcnt(0)
  v_mfma_f32_16x16x32_bf16 v[96:99], a[200:203], a[240:243], v[96:99]
  ds_read_b128 a[224:227], v10 offset:12288
  v_mfma_f32_16x16x32_bf16 v[100:103], a[200:203], a[244:247], v[100:103]
  ds_read_b128 a[228:231], v10 offset:13312
  v_mfma_f32_16x16x32_bf16 v[104:107], a[200:203], a[248:251], v[104:107]
  ds_read_b128 a[232:235], v10 offset:14336
  v_mfma_f32_16x16x32_bf16 v[108:111], a[200:203], a[252:255], v[108:111]
  ds_read_b128 a[236:239], v10 offset:15360
  v_mfma_f32_16x16x32_bf16 v[124:127], a[204:207], a[252:255], v[124:127]
  ds_write_b128 v170, v[180:183] offset:512
  v_mfma_f32_16x16x32_bf16 v[120:123], a[204:207], a[248:251], v[120:123]
  s_add_u32 s92, s92, 9216
  s_cmp_eq_u32 s92, s91
  s_cselect_b32 s92, s90, s92
  v_mfma_f32_16x16x32_bf16 v[116:119], a[204:207], a[244:247], v[116:119]
  buffer_load_dwordx4 a[152:155], v12, s[60:63], s92 offen offset:2048 sc1
  v_mfma_f32_16x16x32_bf16 v[112:115], a[204:207], a[240:243], v[112:115]
  s_waitcnt vmcnt(47) lgkmcnt(1)
  buffer_load_dwordx4 a[156:159], v12, s[60:63], s92 offen offset:3072 sc1
  v_mfma_f32_16x16x32_bf16 v[96:99], a[208:211], a[224:227], v[96:99]
  ds_read_b128 a[240:243], v10 offset:16384
  v_mfma_f32_16x16x32_bf16 v[100:103], a[208:211], a[228:231], v[100:103]
  ds_read_b128 a[244:247], v10 offset:17408
  v_mfma_f32_16x16x32_bf16 v[104:107], a[208:211], a[232:235], v[104:107]
  ds_read_b128 a[248:251], v10 offset:18432
  v_mfma_f32_16x16x32_bf16 v[108:111], a[208:211], a[236:239], v[108:111]
  ds_read_b128 a[252:255], v10 offset:19456
  v_mfma_f32_16x16x32_bf16 v[124:127], a[212:215], a[236:239], v[124:127]
  v_cvt_pk_bf16_f32 v184, v28, v29
  v_cvt_pk_bf16_f32 v185, v30, v31
  v_mfma_f32_16x16x32_bf16 v[120:123], a[212:215], a[232:235], v[120:123]
  v_cvt_pk_bf16_f32 v186, v44, v45
  v_cvt_pk_bf16_f32 v187, v46, v47
  v_mfma_f32_16x16x32_bf16 v[116:119], a[212:215], a[228:231], v[116:119]
  buffer_store_dwordx4 v[184:187], v163, s[60:63], s83 offen offset:0 sc1
  v_mfma_f32_16x16x32_bf16 v[112:115], a[212:215], a[224:227], v[112:115]
  s_waitcnt vmcnt(47) lgkmcnt(0)
  v_mfma_f32_16x16x32_bf16 v[96:99], a[216:219], a[240:243], v[96:99]
  ds_read_b128 a[224:227], v10 offset:20480
  v_mfma_f32_16x16x32_bf16 v[100:103], a[216:219], a[244:247], v[100:103]
  ds_read_b128 a[228:231], v10 offset:21504
  v_mfma_f32_16x16x32_bf16 v[104:107], a[216:219], a[248:251], v[104:107]
  ds_read_b128 a[232:235], v10 offset:22528
  v_mfma_f32_16x16x32_bf16 v[108:111], a[216:219], a[252:255], v[108:111]
  ds_read_b128 a[236:239], v10 offset:23552
  v_mfma_f32_16x16x32_bf16 v[124:127], a[220:223], a[252:255], v[124:127]
  ds_write_b128 v171, v[184:187] offset:0
  v_mfma_f32_16x16x32_bf16 v[120:123], a[220:223], a[248:251], v[120:123]
  s_add_u32 s92, s92, 9216
  s_cmp_eq_u32 s92, s91
  s_cselect_b32 s92, s90, s92
  v_mfma_f32_16x16x32_bf16 v[116:119], a[220:223], a[244:247], v[116:119]
  buffer_load_dwordx4 a[160:163], v12, s[60:63], s92 offen offset:2048 sc1
  v_mfma_f32_16x16x32_bf16 v[112:115], a[220:223], a[240:243], v[112:115]
  s_waitcnt vmcnt(46) lgkmcnt(1)
  buffer_load_dwordx4 a[164:167], v12, s[60:63], s92 offen offset:3072 sc1
  v_mfma_f32_16x16x32_bf16 v[96:99], a[0:3], a[224:227], v[96:99]
  ds_read_b128 a[240:243], v10 offset:24576
  v_mfma_f32_16x16x32_bf16 v[100:103], a[0:3], a[228:231], v[100:103]
  ds_read_b128 a[244:247], v10 offset:25600
  v_mfma_f32_16x16x32_bf16 v[104:107], a[0:3], a[232:235], v[104:107]
  ds_read_b128 a[248:251], v10 offset:26624
  v_mfma_f32_16x16x32_bf16 v[108:111], a[0:3], a[236:239], v[108:111]
  ds_read_b128 a[252:255], v10 offset:27648
  v_mfma_f32_16x16x32_bf16 v[124:127], a[4:7], a[236:239], v[124:127]
  v_cvt_pk_bf16_f32 v188, v60, v61
  v_cvt_pk_bf16_f32 v189, v62, v63
  v_mfma_f32_16x16x32_bf16 v[120:123], a[4:7], a[232:235], v[120:123]
  v_cvt_pk_bf16_f32 v190, v76, v77
  v_cvt_pk_bf16_f32 v191, v78, v79
  v_mfma_f32_16x16x32_bf16 v[116:119], a[4:7], a[228:231], v[116:119]
  buffer_store_dwordx4 v[188:191], v163, s[60:63], s83 offen offset:512 sc1
  v_mfma_f32_16x16x32_bf16 v[112:115], a[4:7], a[224:227], v[112:115]
  s_waitcnt vmcnt(46) lgkmcnt(0)
  v_mfma_f32_16x16x32_bf16 v[96:99], a[8:11], a[240:243], v[96:99]
  ds_read_b128 a[224:227], v10 offset:28672
  v_mfma_f32_16x16x32_bf16 v[100:103], a[8:11], a[244:247], v[100:103]
  ds_read_b128 a[228:231], v10 offset:29696
  v_mfma_f32_16x16x32_bf16 v[104:107], a[8:11], a[248:251], v[104:107]
  ds_read_b128 a[232:235], v10 offset:30720
  v_mfma_f32_16x16x32_bf16 v[108:111], a[8:11], a[252:255], v[108:111]
  ds_read_b128 a[236:239], v10 offset:31744
  v_mfma_f32_16x16x32_bf16 v[124:127], a[12:15], a[252:255], v[124:127]
  ds_write_b128 v171, v[188:191] offset:512
  v_mfma_f32_16x16x32_bf16 v[120:123], a[12:15], a[248:251], v[120:123]
  s_add_u32 s92, s92, 9216
  s_cmp_eq_u32 s92, s91
  s_cselect_b32 s92, s90, s92
  v_mfma_f32_16x16x32_bf16 v[116:119], a[12:15], a[244:247], v[116:119]
  buffer_load_dwordx4 a[168:171], v12, s[60:63], s92 offen offset:2048 sc1
  v_mfma_f32_16x16x32_bf16 v[112:115], a[12:15], a[240:243], v[112:115]
  s_waitcnt vmcnt(45) lgkmcnt(1)
  buffer_load_dwordx4 a[172:175], v12, s[60:63], s92 offen offset:3072 sc1
  v_mfma_f32_16x16x32_bf16 v[96:99], a[16:19], a[224:227], v[96:99]
  ds_read_b128 a[240:243], v10 offset:32768
  v_mfma_f32_16x16x32_bf16 v[100:103], a[16:19], a[228:231], v[100:103]
  ds_read_b128 a[244:247], v10 offset:33792
  v_mfma_f32_16x16x32_bf16 v[104:107], a[16:19], a[232:235], v[104:107]
  ds_read_b128 a[248:251], v10 offset:34816
  v_mfma_f32_16x16x32_bf16 v[108:111], a[16:19], a[236:239], v[108:111]
  ds_read_b128 a[252:255], v10 offset:35840
  v_mfma_f32_16x16x32_bf16 v[124:127], a[20:23], a[236:239], v[124:127]
  v_cvt_pk_bf16_f32 v176, v80, v81
  v_cvt_pk_bf16_f32 v177, v82, v83
  v_mfma_f32_16x16x32_bf16 v[120:123], a[20:23], a[232:235], v[120:123]
  buffer_store_dwordx2 v[176:177], v164, s[60:63], s80 offen sc1
  ds_write_b64 v172, v[176:177] offset:2048
  v_mfma_f32_16x16x32_bf16 v[116:119], a[20:23], a[228:231], v[116:119]
  v_mfma_f32_16x16x32_bf16 v[112:115], a[20:23], a[224:227], v[112:115]
  s_waitcnt vmcnt(45) lgkmcnt(1)
  v_mfma_f32_16x16x32_bf16 v[96:99], a[24:27], a[240:243], v[96:99]
  ds_read_b128 a[224:227], v9 offset:0
  v_mfma_f32_16x16x32_bf16 v[100:103], a[24:27], a[244:247], v[100:103]
  ds_read_b128 a[228:231], v9 offset:1024
  v_cvt_pk_bf16_f32 v180, v84, v85
  v_mfma_f32_16x16x32_bf16 v[104:107], a[24:27], a[248:251], v[104:107]
  ds_read_b128 a[232:235], v9 offset:2048
  v_cvt_pk_bf16_f32 v181, v86, v87
  v_mfma_f32_16x16x32_bf16 v[108:111], a[24:27], a[252:255], v[108:111]
  ds_read_b128 a[236:239], v9 offset:3072
  buffer_store_dwordx2 v[180:181], v165, s[60:63], s81 offen sc1
  v_mfma_f32_16x16x32_bf16 v[124:127], a[28:31], a[252:255], v[124:127]
  ds_write_b64 v173, v[180:181] offset:2048
  v_mfma_f32_16x16x32_bf16 v[120:123], a[28:31], a[248:251], v[120:123]
  v_mfma_f32_16x16x32_bf16 v[116:119], a[28:31], a[244:247], v[116:119]
  v_mfma_f32_16x16x32_bf16 v[112:115], a[28:31], a[240:243], v[112:115]
  s_waitcnt vmcnt(44) lgkmcnt(1)
  v_mfma_f32_16x16x32_bf16 v[128:131], a[32:35], a[224:227], 0
  ds_read_b128 a[240:243], v9 offset:4096
  v_cvt_pk_bf16_f32 v184, v88, v89
  v_mfma_f32_16x16x32_bf16 v[132:135], a[32:35], a[228:231], 0
  ds_read_b128 a[244:247], v9 offset:5120
  v_cvt_pk_bf16_f32 v185, v90, v91
  v_mfma_f32_16x16x32_bf16 v[136:139], a[32:35], a[232:235], 0
  ds_read_b128 a[248:251], v9 offset:6144
  buffer_store_dwordx2 v[184:185], v166, s[60:63], s82 offen sc1
  v_mfma_f32_16x16x32_bf16 v[140:143], a[32:35], a[236:239], 0
  ds_read_b128 a[252:255], v9 offset:7168
  ds_write_b64 v174, v[184:185] offset:2048
  v_mfma_f32_16x16x32_bf16 v[156:159], a[36:39], a[236:239], 0
  v_mfma_f32_16x16x32_bf16 v[152:155], a[36:39], a[232:235], 0
  v_mfma_f32_16x16x32_bf16 v[148:151], a[36:39], a[228:231], 0
  v_mfma_f32_16x16x32_bf16 v[144:147], a[36:39], a[224:227], 0
  s_waitcnt vmcnt(43) lgkmcnt(1)
  v_cvt_pk_bf16_f32 v188, v92, v93
  v_mfma_f32_16x16x32_bf16 v[128:131], a[40:43], a[240:243], v[128:131]
  ds_read_b128 a[224:227], v9 offset:8192
  v_cvt_pk_bf16_f32 v189, v94, v95
  v_mfma_f32_16x16x32_bf16 v[132:135], a[40:43], a[244:247], v[132:135]
  ds_read_b128 a[228:231], v9 offset:9216
  buffer_store_dwordx2 v[188:189], v167, s[60:63], s83 offen sc1
  v_mfma_f32_16x16x32_bf16 v[136:139], a[40:43], a[248:251], v[136:139]
  ds_read_b128 a[232:235], v9 offset:10240
  ds_write_b64 v175, v[188:189] offset:2048
  v_mfma_f32_16x16x32_bf16 v[140:143], a[40:43], a[252:255], v[140:143]
  ds_read_b128 a[236:239], v9 offset:11264
  v_mfma_f32_16x16x32_bf16 v[156:159], a[44:47], a[252:255], v[156:159]
  v_mfma_f32_16x16x32_bf16 v[152:155], a[44:47], a[248:251], v[152:155]
  v_mfma_f32_16x16x32_bf16 v[148:151], a[44:47], a[244:247], v[148:151]
  v_cvt_pk_bf16_f32 v176, v96, v97
  v_cvt_pk_bf16_f32 v177, v98, v99
  v_mfma_f32_16x16x32_bf16 v[144:147], a[44:47], a[240:243], v[144:147]
  s_waitcnt vmcnt(42) lgkmcnt(0)
  v_cvt_pk_bf16_f32 v178, v112, v113
  v_mfma_f32_16x16x32_bf16 v[128:131], a[48:51], a[224:227], v[128:131]
  ds_read_b128 a[240:243], v9 offset:12288
  v_cvt_pk_bf16_f32 v179, v114, v115
  v_mfma_f32_16x16x32_bf16 v[132:135], a[48:51], a[228:231], v[132:135]
  ds_read_b128 a[244:247], v9 offset:13312
  buffer_store_dwordx4 v[176:179], v160, s[60:63], s80 offen offset:1024 sc1
  v_mfma_f32_16x16x32_bf16 v[136:139], a[48:51], a[232:235], v[136:139]
  ds_read_b128 a[248:251], v9 offset:14336
  v_mfma_f32_16x16x32_bf16 v[140:143], a[48:51], a[236:239], v[140:143]
  ds_read_b128 a[252:255], v9 offset:15360
  v_mfma_f32_16x16x32_bf16 v[156:159], a[52:55], a[236:239], v[156:159]
  ds_write_b128 v168, v[176:179] offset:1024
  v_mfma_f32_16x16x32_bf16 v[152:155], a[52:55], a[232:235], v[152:155]
  v_mfma_f32_16x16x32_bf16 v[148:151], a[52:55], a[228:231], v[148:151]
  v_mfma_f32_16x16x32_bf16 v[144:147], a[52:55], a[224:227], v[144:147]
  s_waitcnt vmcnt(41) lgkmcnt(1)
  v_mfma_f32_16x16x32_bf16 v[128:131], a[56:59], a[240:243], v[128:131]
  ds_read_b128 a[224:227], v9 offset:16384
  v_mfma_f32_16x16x32_bf16 v[132:135], a[56:59], a[244:247], v[132:135]
  ds_read_b128 a[228:231], v9 offset:17408
  v_mfma_f32_16x16x32_bf16 v[136:139], a[56:59], a[248:251], v[136:139]
  ds_read_b128 a[232:235], v9 offset:18432
  v_mfma_f32_16x16x32_bf16 v[140:143], a[56:59], a[252:255], v[140:143]
  ds_read_b128 a[236:239], v9 offset:19456
  v_mfma_f32_16x16x32_bf16 v[156:159], a[60:63], a[252:255], v[156:159]
  v_cvt_pk_bf16_f32 v180, v100, v101
  v_cvt_pk_bf16_f32 v181, v102, v103
  v_mfma_f32_16x16x32_bf16 v[152:155], a[60:63], a[248:251], v[152:155]
  v_cvt_pk_bf16_f32 v182, v116, v117
  v_cvt_pk_bf16_f32 v183, v118, v119
  v_mfma_f32_16x16x32_bf16 v[148:151], a[60:63], a[244:247], v[148:151]
  buffer_store_dwordx4 v[180:183], v161, s[60:63], s81 offen offset:1024 sc1
  v_mfma_f32_16x16x32_bf16 v[144:147], a[60:63], a[240:243], v[144:147]
  s_waitcnt vmcnt(40) lgkmcnt(0)
  v_mfma_f32_16x16x32_bf16 v[128:131], a[64:67], a[224:227], v[128:131]
  ds_read_b128 a[240:243], v9 offset:20480
  v_mfma_f32_16x16x32_bf16 v[132:135], a[64:67], a[228:231], v[132:135]
  ds_read_b128 a[244:247], v9 offset:21504
  v_mfma_f32_16x16x32_bf16 v[136:139], a[64:67], a[232:235], v[136:139]
  ds_read_b128 a[248:251], v9 offset:22528
  v_mfma_f32_16x16x32_bf16 v[140:143], a[64:67], a[236:239], v[140:143]
  ds_read_b128 a[252:255], v9 offset:23552
  v_mfma_f32_16x16x32_bf16 v[156:159], a[68:71], a[236:239], v[156:159]
  ds_write_b128 v169, v[180:183] offset:1024
  v_mfma_f32_16x16x32_bf16 v[152:155], a[68:71], a[232:235], v[152:155]
  v_mfma_f32_16x16x32_bf16 v[148:151], a[68:71], a[228:231], v[148:151]
  v_mfma_f32_16x16x32_bf16 v[144:147], a[68:71], a[224:227], v[144:147]
  s_waitcnt vmcnt(38) lgkmcnt(1)
  v_mfma_f32_16x16x32_bf16 v[128:131], a[72:75], a[240:243], v[128:131]
  ds_read_b128 a[224:227], v9 offset:24576
  v_mfma_f32_16x16x32_bf16 v[132:135], a[72:75], a[244:247], v[132:135]
  ds_read_b128 a[228:231], v9 offset:25600
  v_mfma_f32_16x16x32_bf16 v[136:139], a[72:75], a[248:251], v[136:139]
  ds_read_b128 a[232:235], v9 offset:26624
  v_mfma_f32_16x16x32_bf16 v[140:143], a[72:75], a[252:255], v[140:143]
  ds_read_b128 a[236:239], v9 offset:27648
  v_mfma_f32_16x16x32_bf16 v[156:159], a[76:79], a[252:255], v[156:159]
  v_cvt_pk_bf16_f32 v184, v104, v105
  v_cvt_pk_bf16_f32 v185, v106, v107
  v_mfma_f32_16x16x32_bf16 v[152:155], a[76:79], a[248:251], v[152:155]
  v_cvt_pk_bf16_f32 v186, v120, v121
  v_cvt_pk_bf16_f32 v187, v122, v123
  v_mfma_f32_16x16x32_bf16 v[148:151], a[76:79], a[244:247], v[148:151]
  buffer_store_dwordx4 v[184:187], v162, s[60:63], s82 offen offset:1024 sc1
  v_mfma_f32_16x16x32_bf16 v[144:147], a[76:79], a[240:243], v[144:147]
  s_waitcnt vmcnt(37) lgkmcnt(0)
  v_mfma_f32_16x16x32_bf16 v[128:131], a[80:83], a[224:227], v[128:131]
  ds_read_b128 a[240:243], v9 offset:28672
  v_mfma_f32_16x16x32_bf16 v[132:135], a[80:83], a[228:231], v[132:135]
  ds_read_b128 a[244:247], v9 offset:29696
  v_mfma_f32_16x16x32_bf16 v[136:139], a[80:83], a[232:235], v[136:139]
  ds_read_b128 a[248:251], v9 offset:30720
  v_mfma_f32_16x16x32_bf16 v[140:143], a[80:83], a[236:239], v[140:143]
  ds_read_b128 a[252:255], v9 offset:31744
  v_mfma_f32_16x16x32_bf16 v[156:159], a[84:87], a[236:239], v[156:159]
  ds_write_b128 v170, v[184:187] offset:1024
  v_mfma_f32_16x16x32_bf16 v[152:155], a[84:87], a[232:235], v[152:155]
  v_mfma_f32_16x16x32_bf16 v[148:151], a[84:87], a[228:231], v[148:151]
  v_mfma_f32_16x16x32_bf16 v[144:147], a[84:87], a[224:227], v[144:147]
  s_waitcnt vmcnt(35) lgkmcnt(1)
  v_mfma_f32_16x16x32_bf16 v[128:131], a[88:91], a[240:243], v[128:131]
  ds_read_b128 a[224:227], v9 offset:32768
  v_mfma_f32_16x16x32_bf16 v[132:135], a[88:91], a[244:247], v[132:135]
  ds_read_b128 a[228:231], v9 offset:33792
  v_mfma_f32_16x16x32_bf16 v[136:139], a[88:91], a[248:251], v[136:139]
  ds_read_b128 a[232:235], v9 offset:34816
  v_mfma_f32_16x16x32_bf16 v[140:143], a[88:91], a[252:255], v[140:143]
  ds_read_b128 a[236:239], v9 offset:35840
  v_mfma_f32_16x16x32_bf16 v[156:159], a[92:95], a[252:255], v[156:159]
  v_cvt_pk_bf16_f32 v188, v108, v109
  v_cvt_pk_bf16_f32 v189, v110, v111
  v_mfma_f32_16x16x32_bf16 v[152:155], a[92:95], a[248:251], v[152:155]
  v_cvt_pk_bf16_f32 v190, v124, v125
  v_cvt_pk_bf16_f32 v191, v126, v127
  v_mfma_f32_16x16x32_bf16 v[148:151], a[92:95], a[244:247], v[148:151]
  buffer_store_dwordx4 v[188:191], v163, s[60:63], s83 offen offset:1024 sc1
  v_mfma_f32_16x16x32_bf16 v[144:147], a[92:95], a[240:243], v[144:147]
  s_waitcnt vmcnt(34) lgkmcnt(0)
  v_mfma_f32_16x16x32_bf16 v[128:131], a[96:99], a[224:227], v[128:131]
  ds_read_b128 a[240:243], v10 offset:0
  s_waitcnt vmcnt(4)
  s_barrier
  v_mov_b32 v5, s73
  buffer_store_dword v5, v242, s[60:63], 0 offen sc1
  v_add_u32 v242, 1024, v242
  v_mfma_f32_16x16x32_bf16 v[132:135], a[96:99], a[228:231], v[132:135]
  ds_read_b128 a[244:247], v10 offset:1024
  v_mfma_f32_16x16x32_bf16 v[136:139], a[96:99], a[232:235], v[136:139]
  ds_read_b128 a[248:251], v10 offset:2048
  v_mfma_f32_16x16x32_bf16 v[140:143], a[96:99], a[236:239], v[140:143]
  ds_read_b128 a[252:255], v10 offset:3072
  v_mfma_f32_16x16x32_bf16 v[156:159], a[100:103], a[236:239], v[156:159]
  ds_write_b128 v171, v[188:191] offset:1024
  v_mfma_f32_16x16x32_bf16 v[152:155], a[100:103], a[232:235], v[152:155]
  v_mfma_f32_16x16x32_bf16 v[148:151], a[100:103], a[228:231], v[148:151]
  v_mfma_f32_16x16x32_bf16 v[144:147], a[100:103], a[224:227], v[144:147]
  s_waitcnt lgkmcnt(1)
  v_mfma_f32_16x16x32_bf16 v[128:131], a[104:107], a[240:243], v[128:131]
  ds_read_b128 a[224:227], v10 offset:4096
  v_mfma_f32_16x16x32_bf16 v[132:135], a[104:107], a[244:247], v[132:135]
  ds_read_b128 a[228:231], v10 offset:5120
  v_mfma_f32_16x16x32_bf16 v[136:139], a[104:107], a[248:251], v[136:139]
  ds_read_b128 a[232:235], v10 offset:6144
  v_mfma_f32_16x16x32_bf16 v[140:143], a[104:107], a[252:255], v[140:143]
  ds_read_b128 a[236:239], v10 offset:7168
  v_mfma_f32_16x16x32_bf16 v[156:159], a[108:111], a[252:255], v[156:159]
  v_mfma_f32_16x16x32_bf16 v[152:155], a[108:111], a[248:251], v[152:155]
  v_mfma_f32_16x16x32_bf16 v[148:151], a[108:111], a[244:247], v[148:151]
  v_mfma_f32_16x16x32_bf16 v[144:147], a[108:111], a[240:243], v[144:147]
  s_waitcnt lgkmcnt(0)
  v_mfma_f32_16x16x32_bf16 v[128:131], a[112:115], a[224:227], v[128:131]
  ds_read_b128 a[240:243], v10 offset:8192
  v_mfma_f32_16x16x32_bf16 v[132:135], a[112:115], a[228:231], v[132:135]
  ds_read_b128 a[244:247], v10 offset:9216
  v_mfma_f32_16x16x32_bf16 v[136:139], a[112:115], a[232:235], v[136:139]
  ds_read_b128 a[248:251], v10 offset:10240
  v_mfma_f32_16x16x32_bf16 v[140:143], a[112:115], a[236:239], v[140:143]
  ds_read_b128 a[252:255], v10 offset:11264
  v_mfma_f32_16x16x32_bf16 v[156:159], a[116:119], a[236:239], v[156:159]
  v_mfma_f32_16x16x32_bf16 v[152:155], a[116:119], a[232:235], v[152:155]
  v_mfma_f32_16x16x32_bf16 v[148:151], a[116:119], a[228:231], v[148:151]
  v_mfma_f32_16x16x32_bf16 v[144:147], a[116:119], a[224:227], v[144:147]
  s_waitcnt lgkmcnt(0)
  v_mfma_f32_16x16x32_bf16 v[128:131], a[120:123], a[240:243], v[128:131]
  ds_read_b128 a[224:227], v10 offset:12288
  v_mfma_f32_16x16x32_bf16 v[132:135], a[120:123], a[244:247], v[132:135]
  ds_read_b128 a[228:231], v10 offset:13312
  v_mfma_f32_16x16x32_bf16 v[136:139], a[120:123], a[248:251], v[136:139]
  ds_read_b128 a[232:235], v10 offset:14336
  v_mfma_f32_16x16x32_bf16 v[140:143], a[120:123], a[252:255], v[140:143]
  ds_read_b128 a[236:239], v10 offset:15360
  v_mfma_f32_16x16x32_bf16 v[156:159], a[124:127], a[252:255], v[156:159]
  v_mfma_f32_16x16x32_bf16 v[152:155], a[124:127], a[248:251], v[152:155]
  v_mfma_f32_16x16x32_bf16 v[148:151], a[124:127], a[244:247], v[148:151]
  v_mfma_f32_16x16x32_bf16 v[144:147], a[124:127], a[240:243], v[144:147]
  s_waitcnt lgkmcnt(0)
  v_mfma_f32_16x16x32_bf16 v[128:131], a[128:131], a[224:227], v[128:131]
  ds_read_b128 a[240:243], v10 offset:16384
  v_mfma_f32_16x16x32_bf16 v[132:135], a[128:131], a[228:231], v[132:135]
  ds_read_b128 a[244:247], v10 offset:17408
  v_mfma_f32_16x16x32_bf16 v[136:139], a[128:131], a[232:235], v[136:139]
  ds_read_b128 a[248:251], v10 offset:18432
  v_mfma_f32_16x16x32_bf16 v[140:143], a[128:131], a[236:239], v[140:143]
  ds_read_b128 a[252:255], v10 offset:19456
  v_mfma_f32_16x16x32_bf16 v[156:159], a[132:135], a[236:239], v[156:159]
  v_mfma_f32_16x16x32_bf16 v[152:155], a[132:135], a[232:235], v[152:155]
  v_mfma_f32_16x16x32_bf16 v[148:151], a[132:135], a[228:231], v[148:151]
  v_mfma_f32_16x16x32_bf16 v[144:147], a[132:135], a[224:227], v[144:147]
  s_waitcnt lgkmcnt(0)
  v_mfma_f32_16x16x32_bf16 v[128:131], a[136:139], a[240:243], v[128:131]
  ds_read_b128 a[224:227], v10 offset:20480
  v_mfma_f32_16x16x32_bf16 v[132:135], a[136:139], a[244:247], v[132:135]
  ds_read_b128 a[228:231], v10 offset:21504
  v_mfma_f32_16x16x32_bf16 v[136:139], a[136:139], a[248:251], v[136:139]
  ds_read_b128 a[232:235], v10 offset:22528
  v_mfma_f32_16x16x32_bf16 v[140:143], a[136:139], a[252:255], v[140:143]
  ds_read_b128 a[236:239], v10 offset:23552
  v_mfma_f32_16x16x32_bf16 v[156:159], a[140:143], a[252:255], v[156:159]
  v_mfma_f32_16x16x32_bf16 v[152:155], a[140:143], a[248:251], v[152:155]
  v_mfma_f32_16x16x32_bf16 v[148:151], a[140:143], a[244:247], v[148:151]
  v_mfma_f32_16x16x32_bf16 v[144:147], a[140:143], a[240:243], v[144:147]
  s_waitcnt lgkmcnt(0)
  v_mfma_f32_16x16x32_bf16 v[128:131], a[144:147], a[224:227], v[128:131]
  ds_read_b128 a[240:243], v10 offset:24576
  v_mfma_f32_16x16x32_bf16 v[132:135], a[144:147], a[228:231], v[132:135]
  ds_read_b128 a[244:247], v10 offset:25600
  v_mfma_f32_16x16x32_bf16 v[136:139], a[144:147], a[232:235], v[136:139]
  ds_read_b128 a[248:251], v10 offset:26624
  v_mfma_f32_16x16x32_bf16 v[140:143], a[144:147], a[236:239], v[140:143]
  ds_read_b128 a[252:255], v10 offset:27648
  v_mfma_f32_16x16x32_bf16 v[156:159], a[148:151], a[236:239], v[156:159]
  v_mfma_f32_16x16x32_bf16 v[152:155], a[148:151], a[232:235], v[152:155]
  v_mfma_f32_16x16x32_bf16 v[148:151], a[148:151], a[228:231], v[148:151]
  v_mfma_f32_16x16x32_bf16 v[144:147], a[148:151], a[224:227], v[144:147]
  s_waitcnt lgkmcnt(0)
  v_mfma_f32_16x16x32_bf16 v[128:131], a[152:155], a[240:243], v[128:131]
  ds_read_b128 a[224:227], v10 offset:28672
  v_mfma_f32_16x16x32_bf16 v[132:135], a[152:155], a[244:247], v[132:135]
  ds_read_b128 a[228:231], v10 offset:29696
  v_mfma_f32_16x16x32_bf16 v[136:139], a[152:155], a[248:251], v[136:139]
  ds_read_b128 a[232:235], v10 offset:30720
  v_mfma_f32_16x16x32_bf16 v[140:143], a[152:155], a[252:255], v[140:143]
  ds_read_b128 a[236:239], v10 offset:31744
  v_mfma_f32_16x16x32_bf16 v[156:159], a[156:159], a[252:255], v[156:159]
  v_mfma_f32_16x16x32_bf16 v[152:155], a[156:159], a[248:251], v[152:155]
  v_mfma_f32_16x16x32_bf16 v[148:151], a[156:159], a[244:247], v[148:151]
  v_mfma_f32_16x16x32_bf16 v[144:147], a[156:159], a[240:243], v[144:147]
  s_waitcnt lgkmcnt(0)
  v_mfma_f32_16x16x32_bf16 v[128:131], a[160:163], a[224:227], v[128:131]
  ds_read_b128 a[240:243], v10 offset:32768
  v_mfma_f32_16x16x32_bf16 v[132:135], a[160:163], a[228:231], v[132:135]
  ds_read_b128 a[244:247], v10 offset:33792
  v_mfma_f32_16x16x32_bf16 v[136:139], a[160:163], a[232:235], v[136:139]
  ds_read_b128 a[248:251], v10 offset:34816
  v_mfma_f32_16x16x32_bf16 v[140:143], a[160:163], a[236:239], v[140:143]
  ds_read_b128 a[252:255], v10 offset:35840
  v_mfma_f32_16x16x32_bf16 v[156:159], a[164:167], a[236:239], v[156:159]
  v_mfma_f32_16x16x32_bf16 v[152:155], a[164:167], a[232:235], v[152:155]
  v_mfma_f32_16x16x32_bf16 v[148:151], a[164:167], a[228:231], v[148:151]
  v_mfma_f32_16x16x32_bf16 v[144:147], a[164:167], a[224:227], v[144:147]
  s_waitcnt lgkmcnt(0)
  v_mfma_f32_16x16x32_bf16 v[128:131], a[168:171], a[240:243], v[128:131]
  v_mfma_f32_16x16x32_bf16 v[132:135], a[168:171], a[244:247], v[132:135]
  v_mfma_f32_16x16x32_bf16 v[136:139], a[168:171], a[248:251], v[136:139]
  v_mfma_f32_16x16x32_bf16 v[140:143], a[168:171], a[252:255], v[140:143]
  v_mfma_f32_16x16x32_bf16 v[156:159], a[172:175], a[252:255], v[156:159]
  v_mfma_f32_16x16x32_bf16 v[152:155], a[172:175], a[248:251], v[152:155]
  v_mfma_f32_16x16x32_bf16 v[148:151], a[172:175], a[244:247], v[148:151]
  v_mfma_f32_16x16x32_bf16 v[144:147], a[172:175], a[240:243], v[144:147]
  s_nop 3
  v_cvt_pk_bf16_f32 v176, v140, v141
  v_cvt_pk_bf16_f32 v177, v142, v143
  v_cvt_pk_bf16_f32 v178, v156, v157
  v_cvt_pk_bf16_f32 v179, v158, v159
  buffer_store_dwordx4 v[176:179], v163, s[60:63], s83 offen offset:1536 sc1
  v_cvt_pk_bf16_f32 v180, v136, v137
  v_cvt_pk_bf16_f32 v181, v138, v139
  v_cvt_pk_bf16_f32 v182, v152, v153
  v_cvt_pk_bf16_f32 v183, v154, v155
  buffer_store_dwordx4 v[180:183], v162, s[60:63], s82 offen offset:1536 sc1
  v_cvt_pk_bf16_f32 v184, v132, v133
  v_cvt_pk_bf16_f32 v185, v134, v135
  v_cvt_pk_bf16_f32 v186, v148, v149
  v_cvt_pk_bf16_f32 v187, v150, v151
  buffer_store_dwordx4 v[184:187], v161, s[60:63], s81 offen offset:1536 sc1
  v_cvt_pk_bf16_f32 v188, v128, v129
  v_cvt_pk_bf16_f32 v189, v130, v131
  v_cvt_pk_bf16_f32 v190, v144, v145
  v_cvt_pk_bf16_f32 v191, v146, v147
  buffer_store_dwordx4 v[188:191], v160, s[60:63], s80 offen offset:1536 sc1
  ds_write_b128 v171, v[176:179] offset:1536
  ds_write_b128 v170, v[180:183] offset:1536
  ds_write_b128 v169, v[184:187] offset:1536
  ds_write_b128 v168, v[188:191] offset:1536
  buffer_load_dword v249, v243, s[60:63], 0 offen sc1
  s_waitcnt vmcnt(1)
  s_barrier
  v_mov_b32 v5, s73
  buffer_store_dword v5, v242, s[60:63], 0 offen sc1
  s_waitcnt vmcnt(1)
  v_cmp_ne_u32 vcc, s73, v249
  s_cbranch_vccnz L_slow5
L_back5:
  v_add_u32 v243, 1024, v243
  buffer_load_dwordx2 v[80:81], v246, s[60:63], s24 offen offset:0 sc1
  buffer_load_dwordx2 v[82:83], v246, s[60:63], s25 offen offset:0 sc1
  buffer_load_dwordx2 v[84:85], v246, s[60:63], s26 offen offset:0 sc1
  buffer_load_dwordx2 v[86:87], v246, s[60:63], s27 offen offset:0 sc1
  buffer_load_dwordx2 v[88:89], v246, s[60:63], s34 offen offset:0 sc1
  buffer_load_dwordx2 v[90:91], v246, s[60:63], s35 offen offset:0 sc1
  buffer_load_dwordx2 v[92:93], v246, s[60:63], s37 offen offset:0 sc1
  buffer_load_dwordx4 v[16:19], v244, s[60:63], s24 offen offset:0 sc1
  buffer_load_dwordx4 v[20:23], v244, s[60:63], s25 offen offset:0 sc1
  buffer_load_dwordx4 v[24:27], v244, s[60:63], s26 offen offset:0 sc1
  buffer_load_dwordx4 v[28:31], v244, s[60:63], s27 offen offset:0 sc1
  buffer_load_dword v249, v243, s[60:63], 0 offen sc1
  buffer_load_dwordx4 v[32:35], v244, s[60:63], s34 offen offset:0 sc1
  buffer_load_dwordx4 v[36:39], v244, s[60:63], s35 offen offset:0 sc1
  buffer_load_dwordx4 v[40:43], v244, s[60:63], s37 offen offset:0 sc1
  s_waitcnt lgkmcnt(0)
  ds_read_b128 v[44:47], v8
  ds_read_b128 v[76:79], v8 offset:1024
  ds_read_b64 v[94:95], v11 offset:2048
  s_waitcnt lgkmcnt(0)
  v_dot2_f32_bf16 v236, v94, s95, v236
  v_dot2_f32_bf16 v237, v94, s96, v237
  v_dot2_f32_bf16 v238, v95, s95, v238
  v_dot2_f32_bf16 v239, v95, s96, v239
  s_waitcnt vmcnt(14)
  v_dot2_f32_bf16 v236, v80, s95, v236
  v_dot2_f32_bf16 v237, v80, s96, v237
  v_dot2_f32_bf16 v238, v81, s95, v238
  v_dot2_f32_bf16 v239, v81, s96, v239
  s_waitcnt vmcnt(13)
  v_dot2_f32_bf16 v236, v82, s95, v236
  v_dot2_f32_bf16 v237, v82, s96, v237
  v_dot2_f32_bf16 v238, v83, s95, v238
  v_dot2_f32_bf16 v239, v83, s96, v239
  s_waitcnt vmcnt(12)
  v_dot2_f32_bf16 v236, v84, s95, v236
  v_dot2_f32_bf16 v237, v84, s96, v237
  v_dot2_f32_bf16 v238, v85, s95, v238
  v_dot2_f32_bf16 v239, v85, s96, v239
  s_waitcnt vmcnt(11)
  v_dot2_f32_bf16 v236, v86, s95, v236
  v_dot2_f32_bf16 v237, v86, s96, v237
  v_dot2_f32_bf16 v238, v87, s95, v238
  v_dot2_f32_bf16 v239, v87, s96, v239
  s_waitcnt vmcnt(10)
  v_dot2_f32_bf16 v236, v88, s95, v236
  v_dot2_f32_bf16 v237, v88, s96, v237
  v_dot2_f32_bf16 v238, v89, s95, v238
  v_dot2_f32_bf16 v239, v89, s96, v239
  s_waitcnt vmcnt(9)
  v_dot2_f32_bf16 v236, v90, s95, v236
  v_dot2_f32_bf16 v237, v90, s96, v237
  v_dot2_f32_bf16 v238, v91, s95, v238
  v_dot2_f32_bf16 v239, v91, s96, v239
  s_waitcnt vmcnt(8)
  v_dot2_f32_bf16 v236, v92, s95, v236
  v_dot2_f32_bf16 v237, v92, s96, v237
  v_dot2_f32_bf16 v238, v93, s95, v238
  v_dot2_f32_bf16 v239, v93, s96, v239
  s_nop 0
  v_cvt_pk_bf16_f32 v236, v236, v237
  s_nop 0
  v_cvt_pk_bf16_f32 v237, v238, v239
  s_waitcnt vmcnt(3)
  v_cmp_ne_u32 vcc, s73, v249
  s_cbranch_vccnz L_slow6
L_back6:
  buffer_load_dwordx4 v[48:51], v244, s[60:63], s24 offen offset:1024 sc1
  buffer_load_dwordx4 v[52:55], v244, s[60:63], s25 offen offset:1024 sc1
  buffer_load_dwordx4 v[56:59], v244, s[60:63], s26 offen offset:1024 sc1
  buffer_load_dwordx4 v[60:63], v244, s[60:63], s27 offen offset:1024 sc1
  buffer_load_dwordx4 v[64:67], v244, s[60:63], s34 offen offset:1024 sc1
  buffer_load_dwordx4 v[68:71], v244, s[60:63], s35 offen offset:1024 sc1
  buffer_load_dwordx4 v[72:75], v244, s[60:63], s37 offen offset:1024 sc1
  v_dot2_f32_bf16 v220, v44, s95, v220
  v_dot2_f32_bf16 v221, v44, s96, v221
  v_dot2_f32_bf16 v222, v45, s95, v222
  v_dot2_f32_bf16 v223, v45, s96, v223
  v_dot2_f32_bf16 v224, v46, s95, v224
  v_dot2_f32_bf16 v225, v46, s96, v225
  v_dot2_f32_bf16 v226, v47, s95, v226
  v_dot2_f32_bf16 v227, v47, s96, v227
  v_dot2_f32_bf16 v220, v16, s95, v220
  v_dot2_f32_bf16 v221, v16, s96, v221
  v_dot2_f32_bf16 v222, v17, s95, v222
  v_dot2_f32_bf16 v223, v17, s96, v223
  v_dot2_f32_bf16 v224, v18, s95, v224
  v_dot2_f32_bf16 v225, v18, s96, v225
  v_dot2_f32_bf16 v226, v19, s95, v226
  v_dot2_f32_bf16 v227, v19, s96, v227
  v_dot2_f32_bf16 v220, v20, s95, v220
  v_dot2_f32_bf16 v221, v20, s96, v221
  v_dot2_f32_bf16 v222, v21, s95, v222
  v_dot2_f32_bf16 v223, v21, s96, v223
  v_dot2_f32_bf16 v224, v22, s95, v224
  v_dot2_f32_bf16 v225, v22, s96, v225
  v_dot2_f32_bf16 v226, v23, s95, v226
  v_dot2_f32_bf16 v227, v23, s96, v227
  v_dot2_f32_bf16 v220, v24, s95, v220
  v_dot2_f32_bf16 v221, v24, s96, v221
  v_dot2_f32_bf16 v222, v25, s95, v222
  v_dot2_f32_bf16 v223, v25, s96, v223
  v_dot2_f32_bf16 v224, v26, s95, v224
  v_dot2_f32_bf16 v225, v26, s96, v225
  v_dot2_f32_bf16 v226, v27, s95, v226
  v_dot2_f32_bf16 v227, v27, s96, v227
  v_dot2_f32_bf16 v220, v28, s95, v220
  v_dot2_f32_bf16 v221, v28, s96, v221
  v_dot2_f32_bf16 v222, v29, s95, v222
  v_dot2_f32_bf16 v223, v29, s96, v223
  v_dot2_f32_bf16 v224, v30, s95, v224
  v_dot2_f32_bf16 v225, v30, s96, v225
  v_dot2_f32_bf16 v226, v31, s95, v226
  v_dot2_f32_bf16 v227, v31, s96, v227
  s_waitcnt vmcnt(9)
  v_dot2_f32_bf16 v220, v32, s95, v220
  v_dot2_f32_bf16 v221, v32, s96, v221
  v_dot2_f32_bf16 v222, v33, s95, v222
  v_dot2_f32_bf16 v223, v33, s96, v223
  v_dot2_f32_bf16 v224, v34, s95, v224
  v_dot2_f32_bf16 v225, v34, s96, v225
  v_dot2_f32_bf16 v226, v35, s95, v226
  v_dot2_f32_bf16 v227, v35, s96, v227
  s_waitcnt vmcnt(8)
  v_dot2_f32_bf16 v220, v36, s95, v220
  v_dot2_f32_bf16 v221, v36, s96, v221
  v_dot2_f32_bf16 v222, v37, s95, v222
  v_dot2_f32_bf16 v223, v37, s96, v223
  v_dot2_f32_bf16 v224, v38, s95, v224
  v_dot2_f32_bf16 v225, v38, s96, v225
  v_dot2_f32_bf16 v226, v39, s95, v226
  v_dot2_f32_bf16 v227, v39, s96, v227
  s_waitcnt vmcnt(7)
  v_dot2_f32_bf16 v220, v40, s95, v220
  v_dot2_f32_bf16 v221, v40, s96, v221
  v_dot2_f32_bf16 v222, v41, s95, v222
  v_dot2_f32_bf16 v223, v41, s96, v223
  v_dot2_f32_bf16 v224, v42, s95, v224
  v_dot2_f32_bf16 v225, v42, s96, v225
  v_dot2_f32_bf16 v226, v43, s95, v226
  v_dot2_f32_bf16 v227, v43, s96, v227
  v_cvt_pk_bf16_f32 v220, v220, v221
  v_cvt_pk_bf16_f32 v221, v222, v223
  v_cvt_pk_bf16_f32 v222, v224, v225
  v_cvt_pk_bf16_f32 v223, v226, v227
  buffer_store_dwordx2 v[236:237], v254, s[56:59], s39 offen offset:0
  buffer_store_dwordx4 v[220:223], v252, s[56:59], s38 offen offset:0
  v_dot2_f32_bf16 v228, v76, s95, v228
  v_dot2_f32_bf16 v229, v76, s96, v229
  v_dot2_f32_bf16 v230, v77, s95, v230
  v_dot2_f32_bf16 v231, v77, s96, v231
  v_dot2_f32_bf16 v232, v78, s95, v232
  v_dot2_f32_bf16 v233, v78, s96, v233
  v_dot2_f32_bf16 v234, v79, s95, v234
  v_dot2_f32_bf16 v235, v79, s96, v235
  s_waitcnt vmcnt(8)
  v_dot2_f32_bf16 v228, v48, s95, v228
  v_dot2_f32_bf16 v229, v48, s96, v229
  v_dot2_f32_bf16 v230, v49, s95, v230
  v_dot2_f32_bf16 v231, v49, s96, v231
  v_dot2_f32_bf16 v232, v50, s95, v232
  v_dot2_f32_bf16 v233, v50, s96, v233
  v_dot2_f32_bf16 v234, v51, s95, v234
  v_dot2_f32_bf16 v235, v51, s96, v235
  s_waitcnt vmcnt(7)
  v_dot2_f32_bf16 v228, v52, s95, v228
  v_dot2_f32_bf16 v229, v52, s96, v229
  v_dot2_f32_bf16 v230, v53, s95, v230
  v_dot2_f32_bf16 v231, v53, s96, v231
  v_dot2_f32_bf16 v232, v54, s95, v232
  v_dot2_f32_bf16 v233, v54, s96, v233
  v_dot2_f32_bf16 v234, v55, s95, v234
  v_dot2_f32_bf16 v235, v55, s96, v235
  s_waitcnt vmcnt(6)
  v_dot2_f32_bf16 v228, v56, s95, v228
  v_dot2_f32_bf16 v229, v56, s96, v229
  v_dot2_f32_bf16 v230, v57, s95, v230
  v_dot2_f32_bf16 v231, v57, s96, v231
  v_dot2_f32_bf16 v232, v58, s95, v232
  v_dot2_f32_bf16 v233, v58, s96, v233
  v_dot2_f32_bf16 v234, v59, s95, v234
  v_dot2_f32_bf16 v235, v59, s96, v235
  s_waitcnt vmcnt(5)
  v_dot2_f32_bf16 v228, v60, s95, v228
  v_dot2_f32_bf16 v229, v60, s96, v229
  v_dot2_f32_bf16 v230, v61, s95, v230
  v_dot2_f32_bf16 v231, v61, s96, v231
  v_dot2_f32_bf16 v232, v62, s95, v232
  v_dot2_f32_bf16 v233, v62, s96, v233
  v_dot2_f32_bf16 v234, v63, s95, v234
  v_dot2_f32_bf16 v235, v63, s96, v235
  s_waitcnt vmcnt(4)
  v_dot2_f32_bf16 v228, v64, s95, v228
  v_dot2_f32_bf16 v229, v64, s96, v229
  v_dot2_f32_bf16 v230, v65, s95, v230
  v_dot2_f32_bf16 v231, v65, s96, v231
  v_dot2_f32_bf16 v232, v66, s95, v232
  v_dot2_f32_bf16 v233, v66, s96, v233
  v_dot2_f32_bf16 v234, v67, s95, v234
  v_dot2_f32_bf16 v235, v67, s96, v235
  s_waitcnt vmcnt(3)
  v_dot2_f32_bf16 v228, v68, s95, v228
  v_dot2_f32_bf16 v229, v68, s96, v229
  v_dot2_f32_bf16 v230, v69, s95, v230
  v_dot2_f32_bf16 v231, v69, s96, v231
  v_dot2_f32_bf16 v232, v70, s95, v232
  v_dot2_f32_bf16 v233, v70, s96, v233
  v_dot2_f32_bf16 v234, v71, s95, v234
  v_dot2_f32_bf16 v235, v71, s96, v235
  s_waitcnt vmcnt(2)
  v_dot2_f32_bf16 v228, v72, s95, v228
  v_dot2_f32_bf16 v229, v72, s96, v229
  v_dot2_f32_bf16 v230, v73, s95, v230
  v_dot2_f32_bf16 v231, v73, s96, v231
  v_dot2_f32_bf16 v232, v74, s95, v232
  v_dot2_f32_bf16 v233, v74, s96, v233
  v_dot2_f32_bf16 v234, v75, s95, v234
  v_dot2_f32_bf16 v235, v75, s96, v235
  v_cvt_pk_bf16_f32 v228, v228, v229
  v_cvt_pk_bf16_f32 v229, v230, v231
  v_cvt_pk_bf16_f32 v230, v232, v233
  v_cvt_pk_bf16_f32 v231, v234, v235
  buffer_store_dwordx4 v[228:231], v252, s[56:59], s38 offen offset:128
L_end:
  s_endpgm
L_slow1:
  s_mov_b32 s97, 0
L_poll1:
  buffer_load_dword v14, v15, s[60:63], 0 offen sc1
  s_add_u32 s97, s97, 1
  s_waitcnt vmcnt(0)
  v_cmp_ne_u32 vcc, s73, v14
  s_cmp_gt_u32 s97, 400000
  s_cbranch_scc1 L_back1
  s_cbranch_vccnz L_poll1
  s_branch L_back1
L_slow2:
  s_mov_b32 s97, 0
L_poll2:
  buffer_load_dword v46, v15, s[60:63], 0 offen sc1
  s_add_u32 s97, s97, 1
  s_waitcnt vmcnt(0)
  v_cmp_ne_u32 vcc, s73, v46
  s_cmp_gt_u32 s97, 400000
  s_cbranch_scc1 L_back2
  s_cbranch_vccnz L_poll2
  s_branch L_back2
L_epoch:
  s_waitcnt vmcnt(0)
  v_lshrrev_b32 v16, 5, v1
  v_lshlrev_b32 v16, 12, v16
  v_and_b32 v17, 31, v1
  v_lshl_add_u32 v16, v17, 2, v16
  v_add_u32 v16, 65536, v16
  v_add_u32 v17, 8192, v16
  v_add_u32 v18, 16384, v16
  v_add_u32 v19, 24576, v16
  s_mov_b32 s97, 0
L_epoch_poll:
  buffer_load_dword v20, v16, s[60:63], 0 offen sc1
  buffer_load_dword v21, v17, s[60:63], 0 offen sc1
  buffer_load_dword v22, v18, s[60:63], 0 offen sc1
  buffer_load_dword v23, v19, s[60:63], 0 offen sc1
  s_add_u32 s97, s97, 1
  s_waitcnt vmcnt(0)
  v_xor_b32 v20, s73, v20
  v_xor_b32 v21, s73, v21
  v_xor_b32 v22, s73, v22
  v_xor_b32 v23, s73, v23
  v_or_b32 v20, v20, v21
  v_or3_b32 v20, v20, v22, v23
  v_cmp_ne_u32 vcc, 0, v20
  s_cmp_gt_u32 s97, 400000
  s_cbranch_scc1 L_epoch_set
  s_cbranch_vccnz L_epoch_poll
L_epoch_set:
  v_mov_b32 v16, 0
  v_mov_b32 v17, s73
  s_mov_b64 exec, 1
  buffer_store_dword v17, v16, s[60:63], 0 offen sc1
  s_mov_b64 exec, -1
  s_waitcnt vmcnt(0)
  s_branch L_epoch_back
L_slow3:
  s_mov_b32 s97, 0
L_poll3:
  buffer_load_dword v46, v15, s[60:63], 0 offen sc1
  s_add_u32 s97, s97, 1
  s_waitcnt vmcnt(0)
  v_cmp_ne_u32 vcc, s73, v46
  s_cmp_gt_u32 s97, 400000
  s_cbranch_scc1 L_back3
  s_cbranch_vccnz L_poll3
  s_branch L_back3
L_slow4:
  s_mov_b32 s97, 0
L_poll4:
  buffer_load_dword v249, v15, s[60:63], 0 offen sc1
  s_add_u32 s97, s97, 1
  s_waitcnt vmcnt(0)
  v_cmp_ne_u32 vcc, s73, v249
  s_cmp_gt_u32 s97, 400000
  s_cbranch_scc1 L_back4
  s_cbranch_vccnz L_poll4
  s_branch L_back4
L_slow5:
  s_mov_b32 s97, 0
L_poll5:
  buffer_load_dword v249, v243, s[60:63], 0 offen sc1
  s_add_u32 s97, s97, 1
  s_waitcnt vmcnt(0)
  v_cmp_ne_u32 vcc, s73, v249
  s_cmp_gt_u32 s97, 400000
  s_cbranch_scc1 L_back5
  s_cbranch_vccnz L_poll5
  s_branch L_back5
L_slow6:
  s_mov_b32 s97, 0
L_poll6:
  buffer_load_dword v249, v243, s[60:63], 0 offen sc1
  s_add_u32 s97, s97, 1
  s_waitcnt vmcnt(0)
  v_cmp_ne_u32 vcc, s73, v249
  s_cmp_gt_u32 s97, 400000
  s_cbranch_scc1 L_back6
  s_cbranch_vccnz L_poll6
  s_branch L_back6
L_code_end:
.section .rodata,"a"
.p2align 6
.amdhsa_kernel sequential_preLN__sliding_local_dilated__dense_activation_squared_relu__prompt_kernel
  .amdhsa_next_free_vgpr 512
  .amdhsa_next_free_sgpr 102
  .amdhsa_accum_offset 256
  .amdhsa_group_segment_fixed_size 0
  .amdhsa_kernarg_size 88
  .amdhsa_user_sgpr_count 2
  .amdhsa_user_sgpr_kernarg_segment_ptr 1
  .amdhsa_system_sgpr_workgroup_id_x 1
.end_amdhsa_kernel
```
